```python
import torch

def _softmax(x, axis=-1):
    return torch.softmax(x, dim=axis)
def _gelu(x):
    return torch.nn.functional.gelu(x, approximate="tanh")
def _silu(x):
    return torch.nn.functional.silu(x)
def _sigmoid(x):
    return torch.sigmoid(x)
def _layernorm(x, axis=-1, eps=1e-5):
    m = x.mean(dim=axis, keepdim=True)
    v = x.var(dim=axis, keepdim=True, unbiased=False)
    return (x - m) / torch.sqrt(v + eps)
def _scatter_add(tgt, idx, src, axis=0):
    return tgt.clone().index_add_(axis, idx, src)
def _segment_sum(src, seg, n):
    out = torch.zeros((n,) + src.shape[1:], dtype=src.dtype)
    return out.index_add_(0, seg, src)
def _pad(x, pw):
    flat = tuple(v for pair in reversed(pw) for v in pair)
    return torch.nn.functional.pad(x, flat)

kernel_name = 'concat_heads__linear_kernel_hedgehog__ssm_conv_h3__prompt'

def setup_inputs():

    _w = (lambda a: (lambda t: t.to(torch.bfloat16) if t.is_floating_point() else t)(torch.as_tensor(a)))
    def _A_setup():
        B, S, D, H = 1, 2048, 640, 32
        Dh = D // H
        return {
            "x": _w((lambda *s: torch.randn(*s, dtype=torch.bfloat16) * 0.4)(B, S, D)),
            "wqkv": _w((lambda *s: torch.randn(*s, dtype=torch.bfloat16) * 0.4)(D, 3 * D)),
            "w_phi": _w((lambda *s: torch.randn(*s, dtype=torch.bfloat16) * 0.4)(H, Dh, Dh) * (Dh ** -0.5)),
            "wo": _w((lambda *s: torch.randn(*s, dtype=torch.bfloat16) * 0.05)(D, D)),
        }
    _A_in = _A_setup()

    def _B_setup():
        B, S, D = 1, 2048, 640
        ks = 4
        return {
            "q": _w((lambda *s: torch.randn(*s, dtype=torch.bfloat16) * 0.05)(B, S, D)),
            "k": _w((lambda *s: torch.randn(*s, dtype=torch.bfloat16) * 0.8)(B, S, D)),
            "v": _w((lambda *s: torch.randn(*s, dtype=torch.bfloat16) * 0.8)(B, S, D)),
            "shift_k": _w((lambda *s: torch.randn(*s, dtype=torch.bfloat16) * 0.8)(D, ks) * 0.5),
            "ssm_k": _w((lambda *s: torch.randn(*s, dtype=torch.bfloat16) * 0.8)(D, S) * (1.0 / S ** 0.5)),
            "ssm_D": _w((lambda *s: torch.randn(*s, dtype=torch.bfloat16) * 0.8)(D)),
        }
    _B_in = _B_setup()

    return {
        "A_x": _A_in["x"],
        "A_wqkv": _A_in["wqkv"],
        "A_w_phi": _A_in["w_phi"],
        "A_wo": _A_in["wo"],
        "B_q": _B_in["q"],
        "B_k": _B_in["k"],
        "B_v": _B_in["v"],
        "B_shift_k": _B_in["shift_k"],
        "B_ssm_k": _B_in["ssm_k"],
        "B_ssm_D": _B_in["ssm_D"],
    }

def reference(A_x, A_wqkv, A_w_phi, A_wo, B_q, B_k, B_v, B_shift_k, B_ssm_k, B_ssm_D):
    def _A_ref(x, wqkv, w_phi, wo):
        B, S, D = x.shape
        H = 32; Dh = D // H
        qkv = (lambda x, *d: x.permute(*d))((x @ wqkv).reshape(B, S, 3, H, Dh), 2, 0, 3, 1, 4)
        q, k, v = qkv[0], qkv[1], qkv[2]
        pq = torch.einsum("bhsd,hdf->bhsf", q, w_phi)
        pk = torch.einsum("bhsd,hdf->bhsf", k, w_phi)
        phi_q = torch.concatenate([_softmax(pq, axis=-1), _softmax(-pq, axis=-1)], axis=-1)
        phi_k = torch.concatenate([_softmax(pk, axis=-1), _softmax(-pk, axis=-1)], axis=-1)
        kv = torch.einsum("bhsf,bhsd->bhfd", phi_k, v)
        z  = torch.einsum("bhsf->bhf", phi_k)
        num = torch.einsum("bhqf,bhfd->bhqd", phi_q, kv)
        den = torch.einsum("bhqf,bhf->bhq", phi_q, z)[..., None] + 1e-6
        o = num / den
        return (lambda x, *d: x.permute(*d))(o, 0, 2, 1, 3).reshape(B, S, D) @ wo

    def _B_ref(q, k, v, shift_k, ssm_k, ssm_D):
        B, S, D = q.shape
        ks = shift_k.shape[-1]
        k_pad = _pad(k, ((0, 0), (ks - 1, 0), (0, 0)))
        k_shift = torch.zeros_like(k)
        for t in range(ks):
            k_shift = k_shift + k_pad[:, t:t + S, :] * shift_k[:, ks - 1 - t][None, None, :]
        kv = k_shift * v
        L = 2 * S
        kv_pad = _pad(kv, ((0, 0), (0, S), (0, 0)))
        kf_pad = _pad(ssm_k, ((0, 0), (0, S)))
        kv_f = (lambda x, axes=(-2,-1): torch.fft.rfft2(x.float(), dim=axes))(kv_pad[:, None, :, :], axes=(1, 2))
        kf_f = (lambda x, axes=(-2,-1): torch.fft.rfft2(x.float(), dim=axes))(kf_pad[:, None, :], axes=(1, 2))
        kf_f = (lambda x, *d: x.permute(*d))(kf_f, 1, 2, 0)
        y_f = kv_f * kf_f[None, :, :, :]
        y = (lambda x, s, axes=(-2,-1): torch.fft.irfft2(x, s=s, dim=axes).to(torch.bfloat16))(y_f, (1, L), axes=(1, 2))[:, 0, :S, :]
        y = y + kv * ssm_D[None, None, :]
        return q * y

    a = _A_ref(A_x, A_wqkv, A_w_phi, A_wo)
    b = _B_ref(B_q, B_k, B_v, B_shift_k, B_ssm_k, B_ssm_D)
    return torch.concatenate([a, b], axis=-1)
```

```asm
; @launch grid=(256,1,1) block=(512,1,1) lds=163840
.amdgcn_target "amdgcn-amd-amdhsa--gfx950"
.text
.globl concat_heads__linear_kernel_hedgehog__ssm_conv_h3__prompt_kernel
.p2align 8
.type concat_heads__linear_kernel_hedgehog__ssm_conv_h3__prompt_kernel,@function
concat_heads__linear_kernel_hedgehog__ssm_conv_h3__prompt_kernel:
    s_load_dwordx16 s[4:19], s[0:1], 0
    s_load_dwordx8 s[20:27], s[0:1], 64
    s_load_dwordx2 s[28:29], s[0:1], 96
    v_lshrrev_b32 v2, 6, v0
    v_and_b32 v1, 63, v0
    v_readfirstlane_b32 s100, v2
    s_and_b32 s98, s2, 7
    s_lshr_b32 s99, s2, 3
    s_cmp_ge_u32 s2, 192
    s_cbranch_scc1 L_b
    s_and_b32 s49, s2, 3
    s_lshl_b32 s49, s49, 2
    s_and_b32 s50, s99, 3
    s_add_u32 s49, s49, s50
    s_bfe_u32 s52, s2, 0x10002
    s_lshr_b32 s53, s2, 5
    s_lshl_b32 s54, s52, 1
    s_add_u32 s54, s54, s53
    s_lshl_b32 s55, s52, 2
    s_add_u32 s55, s55, s53
    s_sub_u32 s55, s55, 2
    s_cmp_lt_u32 s2, 64
    s_cselect_b32 s50, s54, s55
    s_cselect_b32 s51, 1, 0
    s_and_b32 s48, s100, 3
    s_cmp_ge_u32 s100, 4
    s_cbranch_scc1 L_c
    s_setprio 1
    v_lshrrev_b32 v11, 3, v1
    v_mul_u32_u24 v11, 1280, v11
    v_lshrrev_b32 v12, 4, v1
    v_and_b32 v13, 7, v1
    v_xor_b32 v12, v12, v13
    v_xor_b32 v13, 4, v12
    v_lshl_add_u32 v24, v12, 4, v11
    v_lshl_add_u32 v25, v13, 4, v11
    v_add_u32 v26, 18432, v24
    v_add_u32 v27, 27648, v25
    v_add_u32 v25, 9216, v25
    s_lshl_b32 s60, s49, 2
    s_add_u32 s60, s60, s48
    s_mul_i32 s60, s60, 40960
    s_lshr_b32 s30, s99, 2
    s_lshr_b32 s30, 0x32, s30
    s_xor_b32 s30, s30, s49
    s_and_b32 s30, s30, 1
    s_mul_i32 s31, s30, 640
    s_add_u32 s60, s60, s31
    s_lshl_b32 s62, s48, 12
    s_mov_b32 m0, s62
    s_mov_b32 s34, 0x280000
    s_mov_b32 s35, 0x20000
    s_waitcnt lgkmcnt(0)
    s_mov_b64 s[32:33], s[4:5]
    buffer_load_dwordx4 v24, s[32:35], s60 offen offset:0 lds
    buffer_load_dwordx4 v25, s[32:35], s60 offen offset:1024 lds
    buffer_load_dwordx4 v26, s[32:35], s60 offen offset:2048 lds
    buffer_load_dwordx4 v27, s[32:35], s60 offen offset:3072 lds
    s_cmp_eq_u32 s51, 0
    s_cselect_b32 s56, 1120, 0
    s_add_u32 s58, s51, 1
    v_xor_b32 v15, s58, v1
    v_cmp_gt_u32 vcc, 32, v1
    s_movk_i32 s57, 3520
    s_nop 0
    v_cndmask_b32 v16, v15, v1, vcc
    v_add_u32 v13, 0, v1
    v_mul_u32_u24 v13, 6554, v13
    v_lshlrev_b32 v14, 4, v1
    v_lshrrev_b32_e64 v11, 17, v13
    v_bfe_u32 v12, v13, 16, 1
    v_mad_u32_u24 v11, v11, s57, v14
    v_mad_u32_u24 v28, v12, s56, v11
    v_add_u32 v13, 64, v1
    v_mul_u32_u24 v13, 6554, v13
    v_lshlrev_b32 v14, 4, v1
    v_lshrrev_b32_e64 v11, 17, v13
    v_bfe_u32 v12, v13, 16, 1
    v_mad_u32_u24 v11, v11, s57, v14
    v_mad_u32_u24 v29, v12, s56, v11
    v_add_u32 v13, 128, v16
    v_mul_u32_u24 v13, 6554, v13
    v_lshlrev_b32 v14, 4, v16
    v_lshrrev_b32 v11, 17, v13
    v_bfe_u32 v12, v13, 16, 1
    v_mad_u32_u24 v11, v11, s57, v14
    v_mad_u32_u24 v30, v12, s56, v11
    v_add_u32 v13, 192, v15
    v_mul_u32_u24 v13, 6554, v13
    v_lshlrev_b32 v14, 4, v15
    v_lshrrev_b32 v11, 17, v13
    v_bfe_u32 v12, v13, 16, 1
    v_mad_u32_u24 v11, v11, s57, v14
    v_mad_u32_u24 v31, v12, s56, v11
    v_add_u32 v13, 256, v15
    v_mul_u32_u24 v13, 6554, v13
    v_lshlrev_b32 v14, 4, v15
    v_lshrrev_b32 v11, 17, v13
    v_bfe_u32 v12, v13, 16, 1
    v_mad_u32_u24 v11, v11, s57, v14
    v_mad_u32_u24 v32, v12, s56, v11
    v_lshlrev_b32_e64 v14, 4, v1
    v_add_u32 v32, 4096, v32
    s_mul_i32 s61, s48, 61440
    s_mul_i32 s57, s50, 160
    s_add_u32 s58, s57, 1280
    s_lshl_b32 s57, s57, 1
    s_cmp_eq_u32 s51, 0
    s_cselect_b32 s57, s58, s57
    s_add_u32 s61, s61, s57
    s_mul_i32 s96, s30, 1228800
    s_add_u32 s61, s61, s96
    s_mul_i32 s63, s48, 5120
    s_add_u32 s63, s63, 16384
    s_mov_b32 s36, s6
    s_mov_b32 s37, s7
    s_mov_b32 s38, 0x258000
    s_mov_b32 s39, 0x20000
    s_add_u32 m0, s63, 0
    s_nop 0
    buffer_load_dwordx4 v28, s[36:39], s61 offen offset:0 lds
    buffer_load_dwordx4 v29, s[36:39], s61 offen offset:1024 lds
    buffer_load_dwordx4 v30, s[36:39], s61 offen offset:2048 lds
    buffer_load_dwordx4 v31, s[36:39], s61 offen offset:3072 lds
    s_add_u32 m0, s63, 4096
    s_nop 0
    buffer_load_dwordx4 v32, s[36:39], s61 offen lds
    s_add_u32 s60, s60, 128
    s_add_u32 s61, s61, 245760
    s_lshl_b32 s96, s96, 1
    s_sub_u32 s96, 245760, s96
    s_lshl_b32 s97, s31, 1
    s_sub_u32 s97, 128, s97
    s_mul_i32 s57, s50, 3200
    s_lshl_b32 s57, s57, s51
    s_lshl_b32 s58, s48, 11
    s_add_u32 s57, s57, s58
    s_mov_b32 s40, s8
    s_mov_b32 s41, s9
    s_mov_b32 s42, 0x6400
    s_mov_b32 s43, 0x20000
    s_add_u32 m0, s58, 147456
    s_nop 0
    buffer_load_dwordx4 v14, s[40:43], s57 offen lds
    buffer_load_dwordx4 v14, s[40:43], s57 offen offset:1024 lds
    s_mov_b32 s44, s28
    s_mov_b32 s45, s29
    s_mov_b32 s46, 0x1100000
    s_mov_b32 s47, 0x20000
    s_cmp_eq_u32 s51, 0
    s_cbranch_scc1 L_noh_1
    s_mul_i32 s49, s98, 80
    s_lshl_b32 s50, s99, 2
    s_add_u32 s49, s49, s50
    s_add_u32 s49, s49, s48
    s_add_u32 s49, s49, 48
    s_mul_i32 s56, s48, 8768
    s_add_u32 s56, s56, 110592
    s_lshl_b32 s50, s49, 12
L_noh_1:
    s_add_u32 m0, s62, 36864
    s_nop 0
    buffer_load_dwordx4 v24, s[32:35], s60 offen offset:0 lds
    buffer_load_dwordx4 v25, s[32:35], s60 offen offset:1024 lds
    buffer_load_dwordx4 v26, s[32:35], s60 offen offset:2048 lds
    buffer_load_dwordx4 v27, s[32:35], s60 offen offset:3072 lds
    s_add_u32 m0, s63, 36864
    s_nop 0
    buffer_load_dwordx4 v28, s[36:39], s61 offen offset:0 lds
    buffer_load_dwordx4 v29, s[36:39], s61 offen offset:1024 lds
    buffer_load_dwordx4 v30, s[36:39], s61 offen offset:2048 lds
    buffer_load_dwordx4 v31, s[36:39], s61 offen offset:3072 lds
    s_add_u32 m0, s63, 40960
    s_nop 0
    buffer_load_dwordx4 v32, s[36:39], s61 offen lds
    s_add_u32 s60, s60, 128
    s_add_u32 s61, s61, 245760
    s_cmp_ge_u32 s99, 8
    s_cbranch_scc1 L_nosetup_2
    v_lshlrev_b32_e64 v2, 4, v1
    s_lshl_b32 s52, s49, 1
    s_and_b32 s52, s52, 0xfffffffc
    s_load_dword s55, s[22:23], s52
    s_load_dword s54, s[20:21], s50
    s_mul_i32 s51, s49, 4352
    s_add_u32 s51, s51, 0x740000
    v_mov_b32 v4, 0
    v_mov_b32 v5, 0
    v_mov_b32 v6, 0
    v_mov_b32 v7, 0
    v_add_u32 v3, s56, v2
    s_mov_b64 exec, 0xf
    ds_write_b128 v3, v[4:7]
    s_mov_b32 exec_lo, -1
    ds_write_b128 v3, v[4:7] offset:4160
    s_mov_b64 exec, -1
    v_and_b32 v11, 3, v1
    v_lshrrev_b32 v10, 4, v1
    v_bfe_u32 v12, v1, 2, 2
    v_lshlrev_b32 v8, 4, v11
    v_lshl_add_u32 v8, v10, 6, v8
    v_lshlrev_b32 v9, 3, v12
    v_sub_u32 v8, v8, v9
    s_add_u32 s57, s56, 32
    v_add_u32 v8, s57, v8
    v_sub_u32 v9, v11, v10
    v_lshlrev_b32_e64 v9, 6, v9
    v_lshl_add_u32 v9, v12, 4, v9
    s_add_u32 s57, s56, 4672
    v_add_u32 v9, s57, v9
    v_mov_b32 v13, 0xffff
    v_cmp_eq_u32 vcc, 0, v1
    s_nop 1
    v_cndmask_b32 v16, 0, v13, vcc
    v_cmp_eq_u32 vcc, 4, v1
    s_nop 1
    v_cndmask_b32 v17, 0, v13, vcc
    v_cmp_eq_u32 vcc, 8, v1
    s_nop 1
    v_cndmask_b32 v18, 0, v13, vcc
    v_cmp_eq_u32 vcc, 12, v1
    s_nop 1
    v_cndmask_b32 v19, 0, v13, vcc
    v_add_u32 v13, 3, v11
    v_and_b32 v13, 3, v13
    v_lshl_add_u32 v13, v12, 2, v13
    v_add_u32 v13, 48, v13
    v_subrev_u32 v14, 16, v1
    v_cmp_gt_u32 vcc, 16, v1
    s_nop 1
    v_cndmask_b32 v14, v14, v13, vcc
    v_lshlrev_b32 v14, 2, v14
    s_mov_b32 s58, 0x1111
    s_mov_b32 s59, 0
    s_lshr_b32 s52, s49, 6
    s_mul_i32 s52, s52, 419431
    s_lshr_b32 s52, s52, 16
    s_lshr_b32 s53, s49, 6
    s_mul_i32 s53, s53, 419431
    s_add_u32 s53, s53, 406324
    s_lshr_b32 s53, s53, 16
    v_lshrrev_b32 v12, 2, v1
    v_add_u32 v12, s52, v12
    v_min_u32 v12, s53, v12
    v_lshlrev_b32 v12, 7, v12
    s_mov_b32 s52, 0xf30000
L_nosetup_2:
    s_waitcnt vmcnt(9)
    s_barrier
    s_add_u32 m0, s62, 73728
    s_nop 0
    buffer_load_dwordx4 v24, s[32:35], s60 offen offset:0 lds
    buffer_load_dwordx4 v25, s[32:35], s60 offen offset:1024 lds
    buffer_load_dwordx4 v26, s[32:35], s60 offen offset:2048 lds
    buffer_load_dwordx4 v27, s[32:35], s60 offen offset:3072 lds
    s_add_u32 m0, s63, 73728
    s_nop 0
    buffer_load_dwordx4 v28, s[36:39], s61 offen offset:0 lds
    buffer_load_dwordx4 v29, s[36:39], s61 offen offset:1024 lds
    buffer_load_dwordx4 v30, s[36:39], s61 offen offset:2048 lds
    buffer_load_dwordx4 v31, s[36:39], s61 offen offset:3072 lds
    s_add_u32 m0, s63, 77824
    s_nop 0
    buffer_load_dwordx4 v32, s[36:39], s61 offen lds
    s_add_u32 s60, s60, 128
    s_add_u32 s61, s61, 245760
    s_waitcnt vmcnt(9)
    s_barrier
    s_add_u32 m0, s62, 0
    s_nop 0
    buffer_load_dwordx4 v24, s[32:35], s60 offen offset:0 lds
    buffer_load_dwordx4 v25, s[32:35], s60 offen offset:1024 lds
    buffer_load_dwordx4 v26, s[32:35], s60 offen offset:2048 lds
    buffer_load_dwordx4 v27, s[32:35], s60 offen offset:3072 lds
    s_add_u32 m0, s63, 0
    s_nop 0
    buffer_load_dwordx4 v28, s[36:39], s61 offen offset:0 lds
    buffer_load_dwordx4 v29, s[36:39], s61 offen offset:1024 lds
    buffer_load_dwordx4 v30, s[36:39], s61 offen offset:2048 lds
    buffer_load_dwordx4 v31, s[36:39], s61 offen offset:3072 lds
    s_add_u32 m0, s63, 4096
    s_nop 0
    buffer_load_dwordx4 v32, s[36:39], s61 offen lds
    s_add_u32 s60, s60, 128
    s_add_u32 s61, s61, 245760
    s_waitcnt vmcnt(9)
    s_barrier
    s_add_u32 m0, s62, 36864
    s_nop 0
    buffer_load_dwordx4 v24, s[32:35], s60 offen offset:0 lds
    buffer_load_dwordx4 v25, s[32:35], s60 offen offset:1024 lds
    buffer_load_dwordx4 v26, s[32:35], s60 offen offset:2048 lds
    buffer_load_dwordx4 v27, s[32:35], s60 offen offset:3072 lds
    s_add_u32 m0, s63, 36864
    s_nop 0
    buffer_load_dwordx4 v28, s[36:39], s61 offen offset:0 lds
    buffer_load_dwordx4 v29, s[36:39], s61 offen offset:1024 lds
    buffer_load_dwordx4 v30, s[36:39], s61 offen offset:2048 lds
    buffer_load_dwordx4 v31, s[36:39], s61 offen offset:3072 lds
    s_add_u32 m0, s63, 40960
    s_nop 0
    buffer_load_dwordx4 v32, s[36:39], s61 offen lds
    s_add_u32 s60, s60, s97
    s_add_u32 s61, s61, s96
    s_waitcnt vmcnt(9)
    s_barrier
    s_add_u32 m0, s62, 73728
    s_nop 0
    buffer_load_dwordx4 v24, s[32:35], s60 offen offset:0 lds
    buffer_load_dwordx4 v25, s[32:35], s60 offen offset:1024 lds
    buffer_load_dwordx4 v26, s[32:35], s60 offen offset:2048 lds
    buffer_load_dwordx4 v27, s[32:35], s60 offen offset:3072 lds
    s_add_u32 m0, s63, 73728
    s_nop 0
    buffer_load_dwordx4 v28, s[36:39], s61 offen offset:0 lds
    buffer_load_dwordx4 v29, s[36:39], s61 offen offset:1024 lds
    buffer_load_dwordx4 v30, s[36:39], s61 offen offset:2048 lds
    buffer_load_dwordx4 v31, s[36:39], s61 offen offset:3072 lds
    s_add_u32 m0, s63, 77824
    s_nop 0
    buffer_load_dwordx4 v32, s[36:39], s61 offen lds
    s_add_u32 s60, s60, 128
    s_add_u32 s61, s61, 245760
    s_waitcnt vmcnt(9)
    s_barrier
    s_add_u32 m0, s62, 0
    s_nop 0
    buffer_load_dwordx4 v24, s[32:35], s60 offen offset:0 lds
    buffer_load_dwordx4 v25, s[32:35], s60 offen offset:1024 lds
    buffer_load_dwordx4 v26, s[32:35], s60 offen offset:2048 lds
    buffer_load_dwordx4 v27, s[32:35], s60 offen offset:3072 lds
    s_add_u32 m0, s63, 0
    s_nop 0
    buffer_load_dwordx4 v28, s[36:39], s61 offen offset:0 lds
    buffer_load_dwordx4 v29, s[36:39], s61 offen offset:1024 lds
    buffer_load_dwordx4 v30, s[36:39], s61 offen offset:2048 lds
    buffer_load_dwordx4 v31, s[36:39], s61 offen offset:3072 lds
    s_add_u32 m0, s63, 4096
    s_nop 0
    buffer_load_dwordx4 v32, s[36:39], s61 offen lds
    s_add_u32 s60, s60, 128
    s_add_u32 s61, s61, 245760
    s_waitcnt vmcnt(9)
    s_barrier
    s_add_u32 m0, s62, 36864
    s_nop 0
    buffer_load_dwordx4 v24, s[32:35], s60 offen offset:0 lds
    buffer_load_dwordx4 v25, s[32:35], s60 offen offset:1024 lds
    buffer_load_dwordx4 v26, s[32:35], s60 offen offset:2048 lds
    buffer_load_dwordx4 v27, s[32:35], s60 offen offset:3072 lds
    s_add_u32 m0, s63, 36864
    s_nop 0
    buffer_load_dwordx4 v28, s[36:39], s61 offen offset:0 lds
    buffer_load_dwordx4 v29, s[36:39], s61 offen offset:1024 lds
    buffer_load_dwordx4 v30, s[36:39], s61 offen offset:2048 lds
    buffer_load_dwordx4 v31, s[36:39], s61 offen offset:3072 lds
    s_add_u32 m0, s63, 40960
    s_nop 0
    buffer_load_dwordx4 v32, s[36:39], s61 offen lds
    s_add_u32 s60, s60, 128
    s_add_u32 s61, s61, 245760
    s_load_dwordx2 s[30:31], s[26:27], 0
    s_waitcnt vmcnt(9)
    s_barrier
    s_add_u32 m0, s62, 73728
    s_nop 0
    buffer_load_dwordx4 v24, s[32:35], s60 offen offset:0 lds
    buffer_load_dwordx4 v25, s[32:35], s60 offen offset:1024 lds
    buffer_load_dwordx4 v26, s[32:35], s60 offen offset:2048 lds
    buffer_load_dwordx4 v27, s[32:35], s60 offen offset:3072 lds
    s_add_u32 m0, s63, 73728
    s_nop 0
    buffer_load_dwordx4 v28, s[36:39], s61 offen offset:0 lds
    buffer_load_dwordx4 v29, s[36:39], s61 offen offset:1024 lds
    buffer_load_dwordx4 v30, s[36:39], s61 offen offset:2048 lds
    buffer_load_dwordx4 v31, s[36:39], s61 offen offset:3072 lds
    s_add_u32 m0, s63, 77824
    s_nop 0
    buffer_load_dwordx4 v32, s[36:39], s61 offen lds
    s_add_u32 s60, s60, 128
    s_add_u32 s61, s61, 245760
    s_waitcnt vmcnt(9)
    s_barrier
    s_add_u32 m0, s62, 0
    s_nop 0
    buffer_load_dwordx4 v24, s[32:35], s60 offen offset:0 lds
    buffer_load_dwordx4 v25, s[32:35], s60 offen offset:1024 lds
    buffer_load_dwordx4 v26, s[32:35], s60 offen offset:2048 lds
    buffer_load_dwordx4 v27, s[32:35], s60 offen offset:3072 lds
    s_add_u32 m0, s63, 0
    s_nop 0
    buffer_load_dwordx4 v28, s[36:39], s61 offen offset:0 lds
    buffer_load_dwordx4 v29, s[36:39], s61 offen offset:1024 lds
    buffer_load_dwordx4 v30, s[36:39], s61 offen offset:2048 lds
    buffer_load_dwordx4 v31, s[36:39], s61 offen offset:3072 lds
    s_add_u32 m0, s63, 4096
    s_nop 0
    buffer_load_dwordx4 v32, s[36:39], s61 offen lds
    s_waitcnt vmcnt(9)
    s_barrier
    s_cmp_lt_u32 s99, 8
    s_cbranch_scc1 L_nofw_3
    s_lshr_b32 s50, s99, 2
    s_sub_u32 s50, s50, 1
    s_max_i32 s50, s50, 0
    s_lshl_b32 s50, s50, 2
    s_add_u32 s50, s50, s48
    s_lshl_b32 s52, s50, 6
    s_mul_i32 s51, s50, 40960
    s_add_u32 s51, s51, 0x280000
    s_lshl_b32 s54, s50, 10
    s_add_u32 s54, s54, 0xf40000
    v_lshlrev_b32 v18, 4, v1
    s_add_u32 s42, s28, s54
    s_addc_u32 s43, s29, 0
    s_load_dwordx2 s[4:5], s[42:43], 0
    s_load_dwordx2 s[6:7], s[42:43], 128
    s_load_dwordx2 s[8:9], s[42:43], 256
    s_load_dwordx2 s[10:11], s[42:43], 384
    s_load_dwordx2 s[12:13], s[42:43], 512
    s_load_dwordx2 s[14:15], s[42:43], 640
    s_load_dwordx2 s[16:17], s[42:43], 768
    s_load_dwordx2 s[18:19], s[42:43], 896
L_nofw_3:
    s_waitcnt vmcnt(0)
    s_barrier
    s_cmp_lt_u32 s99, 8
    s_cbranch_scc1 L_q9
    s_waitcnt lgkmcnt(0)
    s_mov_b32 s3, 0
    s_cmp_eq_u64 s[4:5], s[30:31]
    s_addc_u32 s3, s3, 0
    s_cmp_eq_u64 s[6:7], s[30:31]
    s_addc_u32 s3, s3, 0
    s_cmp_eq_u64 s[8:9], s[30:31]
    s_addc_u32 s3, s3, 0
    s_cmp_eq_u64 s[10:11], s[30:31]
    s_addc_u32 s3, s3, 0
    s_cmp_eq_u64 s[12:13], s[30:31]
    s_addc_u32 s3, s3, 0
    s_cmp_eq_u64 s[14:15], s[30:31]
    s_addc_u32 s3, s3, 0
    s_cmp_eq_u64 s[16:17], s[30:31]
    s_addc_u32 s3, s3, 0
    s_cmp_eq_u64 s[18:19], s[30:31]
    s_addc_u32 s3, s3, 0
    s_cmp_lg_u32 s30, s31
    s_addc_u32 s3, s3, 0
    s_cmp_eq_u32 s3, 9
    s_cbranch_scc0 L_q9
    s_add_u32 s53, s51, 0
    buffer_load_dwordx4 v[64:67], v18, s[44:47], s53 offen offset:0 sc1
    buffer_load_dwordx4 v[68:71], v18, s[44:47], s53 offen offset:1024 sc1
    buffer_load_dwordx4 v[72:75], v18, s[44:47], s53 offen offset:2048 sc1
    buffer_load_dwordx4 v[76:79], v18, s[44:47], s53 offen offset:3072 sc1
    s_add_u32 s53, s51, 4096
    buffer_load_dwordx4 v[80:83], v18, s[44:47], s53 offen offset:0 sc1
    buffer_load_dwordx4 v[84:87], v18, s[44:47], s53 offen offset:1024 sc1
    s_barrier
    s_branch L_wrest
L_q9:
    s_setprio 0
    s_cmp_lt_u32 s99, 8
    s_cbranch_scc1 L_conv
L_wo:
    s_setprio 0
    s_lshr_b32 s50, s99, 2
    s_sub_u32 s50, s50, 1
    s_max_i32 s50, s50, 0
    s_lshl_b32 s50, s50, 2
    s_add_u32 s50, s50, s48
    s_lshl_b32 s52, s50, 6
    s_mul_i32 s51, s50, 40960
    s_add_u32 s51, s51, 0x280000
    s_lshl_b32 s54, s50, 10
    s_add_u32 s54, s54, 0xf40000
    v_lshlrev_b32 v18, 4, v1
    v_lshrrev_b32 v15, 3, v1
    v_lshlrev_b32 v15, 7, v15
    v_lshlrev_b32 v18, 4, v1
    s_waitcnt lgkmcnt(0)
    s_cmp_lg_u32 s30, s31
    s_cbranch_scc1 L_hsd_5
    s_mov_b32 s101, 0x10000
    v_mov_b32 v22, 0
L_hs_4:
    global_load_dwordx2 v[20:21], v22, s[26:27] sc1
    s_waitcnt vmcnt(0)
    v_readfirstlane_b32 s30, v20
    v_readfirstlane_b32 s31, v21
    s_nop 3
    s_cmp_lg_u32 s30, s31
    s_cbranch_scc1 L_hsd_5
    s_sleep 8
    s_sub_u32 s101, s101, 1
    s_cmp_eq_u32 s101, 0
    s_cbranch_scc0 L_hs_4
    s_endpgm
L_hsd_5:
    buffer_load_dwordx2 v[16:17], v15, s[44:47], s54 offen sc1
    s_cmp_lt_u32 s99, 8
    s_cbranch_scc1 L_woj_6
    s_barrier
L_woj_6:
    s_waitcnt vmcnt(0)
    v_cmp_eq_u64 vcc, s[30:31], v[16:17]
    s_nop 0
    s_cmp_eq_u64 vcc, -1
    s_cbranch_scc1 L_wok_7
    s_mov_b32 s101, 0x10000
L_poll_8:
    buffer_load_dwordx2 v[16:17], v15, s[44:47], s54 offen sc1
    s_waitcnt vmcnt(0)
    v_cmp_eq_u64 vcc, s[30:31], v[16:17]
    s_nop 0
    s_cmp_eq_u64 vcc, -1
    s_cbranch_scc1 L_polld_9
    s_sleep 8
    s_sub_u32 s101, s101, 1
    s_cmp_eq_u32 s101, 0
    s_cbranch_scc0 L_poll_8
    s_endpgm
L_polld_9:
L_wok_7:
    s_add_u32 s53, s51, 0
    buffer_load_dwordx4 v[64:67], v18, s[44:47], s53 offen offset:0 sc1
    buffer_load_dwordx4 v[68:71], v18, s[44:47], s53 offen offset:1024 sc1
    buffer_load_dwordx4 v[72:75], v18, s[44:47], s53 offen offset:2048 sc1
    buffer_load_dwordx4 v[76:79], v18, s[44:47], s53 offen offset:3072 sc1
    s_add_u32 s53, s51, 4096
    buffer_load_dwordx4 v[80:83], v18, s[44:47], s53 offen offset:0 sc1
    buffer_load_dwordx4 v[84:87], v18, s[44:47], s53 offen offset:1024 sc1
L_wrest:
    s_setprio 0
    s_add_u32 s53, s51, 4096
    buffer_load_dwordx4 v[88:91], v18, s[44:47], s53 offen offset:2048 sc1
    buffer_load_dwordx4 v[92:95], v18, s[44:47], s53 offen offset:3072 sc1
    s_add_u32 s53, s51, 8192
    buffer_load_dwordx4 v[96:99], v18, s[44:47], s53 offen offset:0 sc1
    buffer_load_dwordx4 v[100:103], v18, s[44:47], s53 offen offset:1024 sc1
    buffer_load_dwordx4 v[104:107], v18, s[44:47], s53 offen offset:2048 sc1
    buffer_load_dwordx4 v[108:111], v18, s[44:47], s53 offen offset:3072 sc1
    s_add_u32 s53, s51, 12288
    buffer_load_dwordx4 v[112:115], v18, s[44:47], s53 offen offset:0 sc1
    buffer_load_dwordx4 v[116:119], v18, s[44:47], s53 offen offset:1024 sc1
    buffer_load_dwordx4 v[120:123], v18, s[44:47], s53 offen offset:2048 sc1
    buffer_load_dwordx4 v[124:127], v18, s[44:47], s53 offen offset:3072 sc1
    s_add_u32 s53, s51, 16384
    buffer_load_dwordx4 v[128:131], v18, s[44:47], s53 offen offset:0 sc1
    buffer_load_dwordx4 v[132:135], v18, s[44:47], s53 offen offset:1024 sc1
    buffer_load_dwordx4 v[136:139], v18, s[44:47], s53 offen offset:2048 sc1
    buffer_load_dwordx4 v[140:143], v18, s[44:47], s53 offen offset:3072 sc1
    s_add_u32 s53, s51, 20480
    buffer_load_dwordx4 v[144:147], v18, s[44:47], s53 offen offset:0 sc1
    buffer_load_dwordx4 v[148:151], v18, s[44:47], s53 offen offset:1024 sc1
    v_lshrrev_b32 v2, 2, v1
    v_and_b32_e64 v3, 3, v1
    s_mul_i32 s58, s48, 20480
    s_add_u32 s58, s58, 69632
    v_lshrrev_b32 v11, 5, v1
    v_and_b32 v9, 31, v1
    v_lshrrev_b32 v15, 4, v1
    v_lshlrev_b32 v15, 7, v15
    s_sub_u32 s63, s99, 8
    s_lshr_b32 s62, s63, 2
    s_lshl_b32 s3, s98, 2
    s_add_u32 s62, s62, s3
    s_and_b32 s63, s63, 3
    s_lshl_b32 s63, s63, 2
    s_add_u32 s63, s63, s48
    s_cmp_lt_u32 s99, 8
    s_cbranch_scc1 L_woq_11
    s_lshr_b32 s54, s62, 2
    s_lshl_b32 s54, s54, 4
    s_add_u32 s54, s54, s63
    s_lshl_b32 s54, s54, 8
    v_lshlrev_b32 v19, 7, v11
    s_add_u32 s54, s54, 0xf10000
    s_lshl_b32 s55, s62, 4
    s_add_u32 s55, s55, s63
    s_mul_i32 s55, s55, 5120
    buffer_load_dwordx2 v[16:17], v19, s[44:47], s54 offen sc1
    s_add_u32 s53, s51, 20480
    buffer_load_dwordx4 v[152:155], v18, s[44:47], s53 offen offset:2048 sc1
    buffer_load_dwordx4 v[156:159], v18, s[44:47], s53 offen offset:3072 sc1
    s_add_u32 s53, s51, 24576
    buffer_load_dwordx4 v[160:163], v18, s[44:47], s53 offen offset:0 sc1
    buffer_load_dwordx4 v[164:167], v18, s[44:47], s53 offen offset:1024 sc1
    s_waitcnt vmcnt(4)
    v_cmp_eq_u64 vcc, s[30:31], v[16:17]
    s_nop 0
    s_cmp_eq_u64 vcc, -1
    s_cbranch_scc0 L_pqs_12
    s_mov_b32 m0, s58
    s_add_u32 s56, s55, 4096
    buffer_load_dwordx4 v18, s[44:47], s55 offen offset:0 sc1 lds
    buffer_load_dwordx4 v18, s[44:47], s55 offen offset:1024 sc1 lds
    buffer_load_dwordx4 v18, s[44:47], s55 offen offset:2048 sc1 lds
    buffer_load_dwordx4 v18, s[44:47], s55 offen offset:3072 sc1 lds
    s_add_u32 m0, s58, 4096
    s_nop 0
    buffer_load_dwordx4 v18, s[44:47], s56 offen sc1 lds
    s_waitcnt vmcnt(0)
    s_branch L_pqj_13
L_pqs_12:
    s_mov_b32 s101, 0x10000
L_poll_14:
    buffer_load_dwordx2 v[16:17], v19, s[44:47], s54 offen sc1
    s_waitcnt vmcnt(0)
    v_cmp_eq_u64 vcc, s[30:31], v[16:17]
    s_nop 0
    s_cmp_eq_u64 vcc, -1
    s_cbranch_scc1 L_polld_15
    s_sleep 4
    s_sub_u32 s101, s101, 1
    s_cmp_eq_u32 s101, 0
    s_cbranch_scc0 L_poll_14
    s_endpgm
L_polld_15:
    s_mov_b32 m0, s58
    s_add_u32 s56, s55, 4096
    buffer_load_dwordx4 v18, s[44:47], s55 offen offset:0 sc1 lds
    buffer_load_dwordx4 v18, s[44:47], s55 offen offset:1024 sc1 lds
    buffer_load_dwordx4 v18, s[44:47], s55 offen offset:2048 sc1 lds
    buffer_load_dwordx4 v18, s[44:47], s55 offen offset:3072 sc1 lds
    s_add_u32 m0, s58, 4096
    s_nop 0
    buffer_load_dwordx4 v18, s[44:47], s56 offen sc1 lds
    s_waitcnt vmcnt(0)
L_pqj_13:
    s_lshl_b32 s54, s48, 2
    s_add_u32 s54, s54, 159760
    v_mov_b32 v16, s54
    v_mov_b32 v17, 1
    s_waitcnt lgkmcnt(0)
    s_mov_b64 exec, 1
    ds_add_u32 v16, v17
    s_mov_b64 exec, -1
    s_lshl_b32 s54, s62, 2
    s_add_u32 s54, s54, s48
    s_mul_i32 s55, s54, 10240
    s_add_u32 s55, s55, 0x380000
    s_lshl_b32 s54, s54, 9
    s_add_u32 s54, s54, 0xf00000
    v_min_u32 v19, 20, v9
    v_and_b32 v20, 32, v1
    v_add_u32 v19, v19, v20
    v_lshlrev_b32 v20, 3, v19
    v_lshlrev_b32 v19, 4, v19
    s_mul_i32 s57, s48, 5120
    v_add_u32_e64 v21, s57, v18
    s_mov_b32 s59, 0xffff0000
    v_mov_b32 v16, 159748
    s_mov_b32 s101, 0x200000
L_lw_16:
    ds_read_b32 v17, v16
    s_waitcnt lgkmcnt(0)
    v_cmp_le_u32 vcc, 4, v17
    s_cbranch_vccnz L_lwd_17
    s_sleep 2
    s_sub_u32 s101, s101, 1
    s_cmp_eq_u32 s101, 0
    s_cbranch_scc0 L_lw_16
    s_endpgm
L_lwd_17:
    s_add_u32 s53, s51, 24576
    buffer_load_dwordx4 v[168:171], v18, s[44:47], s53 offen offset:2048 sc1
    buffer_load_dwordx4 v[172:175], v18, s[44:47], s53 offen offset:3072 sc1
    s_add_u32 s53, s51, 28672
    buffer_load_dwordx4 v[176:179], v18, s[44:47], s53 offen offset:0 sc1
    buffer_load_dwordx4 v[180:183], v18, s[44:47], s53 offen offset:1024 sc1
    buffer_load_dwordx4 v[184:187], v18, s[44:47], s53 offen offset:2048 sc1
    buffer_load_dwordx4 v[188:191], v18, s[44:47], s53 offen offset:3072 sc1
    s_add_u32 s41, s55, 2560
    s_add_u32 s42, s55, 5120
    s_add_u32 s43, s55, 7680
    s_mov_b64 s[56:57], 0
    s_mov_b32 s101, 0x10000
L_pg_18:
    buffer_load_dwordx2 v[16:17], v15, s[44:47], s54 offen sc1
    s_waitcnt vmcnt(0)
    v_cmp_eq_u64 vcc, s[30:31], v[16:17]
    s_nop 0
    s_andn2_b64 s[96:97], vcc, s[56:57]
    s_mov_b64 s[56:57], vcc
    s_bitcmp1_b64 s[96:97], 0
    s_cbranch_scc0 L_pgs_20
    buffer_load_dwordx4 v[24:27], v19, s[44:47], s55 offen sc1
    buffer_load_dwordx4 v[28:31], v19, s[44:47], s55 offen offset:1024 sc1
    buffer_load_dwordx2 v[32:33], v20, s[44:47], s55 offen offset:2048 sc1
L_pgs_20:
    s_bitcmp1_b64 s[96:97], 16
    s_cbranch_scc0 L_pgs_21
    buffer_load_dwordx4 v[34:37], v19, s[44:47], s41 offen sc1
    buffer_load_dwordx4 v[38:41], v19, s[44:47], s41 offen offset:1024 sc1
    buffer_load_dwordx2 v[42:43], v20, s[44:47], s41 offen offset:2048 sc1
L_pgs_21:
    s_bitcmp1_b64 s[96:97], 32
    s_cbranch_scc0 L_pgs_22
    buffer_load_dwordx4 v[44:47], v19, s[44:47], s42 offen sc1
    buffer_load_dwordx4 v[48:51], v19, s[44:47], s42 offen offset:1024 sc1
    buffer_load_dwordx2 v[52:53], v20, s[44:47], s42 offen offset:2048 sc1
L_pgs_22:
    s_bitcmp1_b64 s[96:97], 48
    s_cbranch_scc0 L_pgs_23
    buffer_load_dwordx4 v[54:57], v19, s[44:47], s43 offen sc1
    buffer_load_dwordx4 v[58:61], v19, s[44:47], s43 offen offset:1024 sc1
    buffer_load_dwordx2 v[62:63], v20, s[44:47], s43 offen offset:2048 sc1
L_pgs_23:
    s_cmp_eq_u64 s[56:57], -1
    s_cbranch_scc1 L_pgd_19
    s_sleep 2
    s_sub_u32 s101, s101, 1
    s_cbranch_scc0 L_pg_18
    s_endpgm
L_pgd_19:
    s_waitcnt vmcnt(0)
    s_setprio 3
    s_waitcnt vmcnt(9)
    v_lshlrev_b32 v224, 16, v24
    v_and_b32 v225, s59, v24
    v_lshlrev_b32 v226, 16, v25
    v_and_b32 v227, s59, v25
    v_lshlrev_b32 v228, 16, v26
    v_and_b32 v229, s59, v26
    v_lshlrev_b32 v230, 16, v27
    v_and_b32 v231, s59, v27
    v_lshlrev_b32 v232, 16, v28
    v_and_b32 v233, s59, v28
    v_lshlrev_b32 v234, 16, v29
    v_and_b32 v235, s59, v29
    v_lshlrev_b32 v236, 16, v30
    v_and_b32 v237, s59, v30
    v_lshlrev_b32 v238, 16, v31
    v_and_b32 v239, s59, v31
    v_lshlrev_b32 v240, 16, v32
    v_and_b32 v241, s59, v32
    v_lshlrev_b32 v242, 16, v33
    v_and_b32 v243, s59, v33
    s_waitcnt vmcnt(6)
    v_lshlrev_b32 v244, 16, v34
    v_and_b32 v245, s59, v34
    v_pk_add_f32 v[224:225], v[224:225], v[244:245]
    v_lshlrev_b32 v246, 16, v35
    v_and_b32 v247, s59, v35
    v_pk_add_f32 v[226:227], v[226:227], v[246:247]
    v_lshlrev_b32 v248, 16, v36
    v_and_b32 v249, s59, v36
    v_pk_add_f32 v[228:229], v[228:229], v[248:249]
    v_lshlrev_b32 v250, 16, v37
    v_and_b32 v251, s59, v37
    v_pk_add_f32 v[230:231], v[230:231], v[250:251]
    v_lshlrev_b32 v252, 16, v38
    v_and_b32 v253, s59, v38
    v_pk_add_f32 v[232:233], v[232:233], v[252:253]
    v_lshlrev_b32 v244, 16, v39
    v_and_b32 v245, s59, v39
    v_pk_add_f32 v[234:235], v[234:235], v[244:245]
    v_lshlrev_b32 v246, 16, v40
    v_and_b32 v247, s59, v40
    v_pk_add_f32 v[236:237], v[236:237], v[246:247]
    v_lshlrev_b32 v248, 16, v41
    v_and_b32 v249, s59, v41
    v_pk_add_f32 v[238:239], v[238:239], v[248:249]
    v_lshlrev_b32 v250, 16, v42
    v_and_b32 v251, s59, v42
    v_pk_add_f32 v[240:241], v[240:241], v[250:251]
    v_lshlrev_b32 v252, 16, v43
    v_and_b32 v253, s59, v43
    v_pk_add_f32 v[242:243], v[242:243], v[252:253]
    s_waitcnt vmcnt(3)
    v_lshlrev_b32 v244, 16, v44
    v_and_b32 v245, s59, v44
    v_pk_add_f32 v[224:225], v[224:225], v[244:245]
    v_lshlrev_b32 v246, 16, v45
    v_and_b32 v247, s59, v45
    v_pk_add_f32 v[226:227], v[226:227], v[246:247]
    v_lshlrev_b32 v248, 16, v46
    v_and_b32 v249, s59, v46
    v_pk_add_f32 v[228:229], v[228:229], v[248:249]
    v_lshlrev_b32 v250, 16, v47
    v_and_b32 v251, s59, v47
    v_pk_add_f32 v[230:231], v[230:231], v[250:251]
    v_lshlrev_b32 v252, 16, v48
    v_and_b32 v253, s59, v48
    v_pk_add_f32 v[232:233], v[232:233], v[252:253]
    v_lshlrev_b32 v244, 16, v49
    v_and_b32 v245, s59, v49
    v_pk_add_f32 v[234:235], v[234:235], v[244:245]
    v_lshlrev_b32 v246, 16, v50
    v_and_b32 v247, s59, v50
    v_pk_add_f32 v[236:237], v[236:237], v[246:247]
    v_lshlrev_b32 v248, 16, v51
    v_and_b32 v249, s59, v51
    v_pk_add_f32 v[238:239], v[238:239], v[248:249]
    v_lshlrev_b32 v250, 16, v52
    v_and_b32 v251, s59, v52
    v_pk_add_f32 v[240:241], v[240:241], v[250:251]
    v_lshlrev_b32 v252, 16, v53
    v_and_b32 v253, s59, v53
    v_pk_add_f32 v[242:243], v[242:243], v[252:253]
    s_waitcnt vmcnt(0)
    v_lshlrev_b32 v244, 16, v54
    v_and_b32 v245, s59, v54
    v_pk_add_f32 v[224:225], v[224:225], v[244:245]
    v_lshlrev_b32 v246, 16, v55
    v_and_b32 v247, s59, v55
    v_pk_add_f32 v[226:227], v[226:227], v[246:247]
    v_lshlrev_b32 v248, 16, v56
    v_and_b32 v249, s59, v56
    v_pk_add_f32 v[228:229], v[228:229], v[248:249]
    v_lshlrev_b32 v250, 16, v57
    v_and_b32 v251, s59, v57
    v_pk_add_f32 v[230:231], v[230:231], v[250:251]
    v_lshlrev_b32 v252, 16, v58
    v_and_b32 v253, s59, v58
    v_pk_add_f32 v[232:233], v[232:233], v[252:253]
    v_lshlrev_b32 v244, 16, v59
    v_and_b32 v245, s59, v59
    v_pk_add_f32 v[234:235], v[234:235], v[244:245]
    v_lshlrev_b32 v246, 16, v60
    v_and_b32 v247, s59, v60
    v_pk_add_f32 v[236:237], v[236:237], v[246:247]
    v_lshlrev_b32 v248, 16, v61
    v_and_b32 v249, s59, v61
    v_pk_add_f32 v[238:239], v[238:239], v[248:249]
    v_lshlrev_b32 v250, 16, v62
    v_and_b32 v251, s59, v62
    v_pk_add_f32 v[240:241], v[240:241], v[250:251]
    v_lshlrev_b32 v252, 16, v63
    v_and_b32 v253, s59, v63
    v_pk_add_f32 v[242:243], v[242:243], v[252:253]
    ds_write_b128 v21, v[224:227] offset:0
    ds_write_b128 v21, v[228:231] offset:1024
    ds_write_b128 v21, v[232:235] offset:2048
    ds_write_b128 v21, v[236:239] offset:3072
    ds_write_b128 v21, v[240:243] offset:4096
    v_mov_b32 v16, 159752
    v_mov_b32 v17, 1
    s_waitcnt lgkmcnt(0)
    s_mov_b64 exec, 1
    ds_add_u32 v16, v17
    s_mov_b64 exec, -1
    s_setprio 0
    s_branch L_woq_24
L_woq_11:
    s_add_u32 s53, s51, 20480
    buffer_load_dwordx4 v[152:155], v18, s[44:47], s53 offen offset:2048 sc1
    buffer_load_dwordx4 v[156:159], v18, s[44:47], s53 offen offset:3072 sc1
    s_add_u32 s53, s51, 24576
    buffer_load_dwordx4 v[160:163], v18, s[44:47], s53 offen offset:0 sc1
    buffer_load_dwordx4 v[164:167], v18, s[44:47], s53 offen offset:1024 sc1
    buffer_load_dwordx4 v[168:171], v18, s[44:47], s53 offen offset:2048 sc1
    buffer_load_dwordx4 v[172:175], v18, s[44:47], s53 offen offset:3072 sc1
    s_add_u32 s53, s51, 28672
    buffer_load_dwordx4 v[176:179], v18, s[44:47], s53 offen offset:0 sc1
    buffer_load_dwordx4 v[180:183], v18, s[44:47], s53 offen offset:1024 sc1
    buffer_load_dwordx4 v[184:187], v18, s[44:47], s53 offen offset:2048 sc1
    buffer_load_dwordx4 v[188:191], v18, s[44:47], s53 offen offset:3072 sc1
L_woq_24:
    s_add_u32 s53, s51, 32768
    buffer_load_dwordx4 v[192:195], v18, s[44:47], s53 offen offset:0 sc1
    buffer_load_dwordx4 v[196:199], v18, s[44:47], s53 offen offset:1024 sc1
    buffer_load_dwordx4 v[200:203], v18, s[44:47], s53 offen offset:2048 sc1
    buffer_load_dwordx4 v[204:207], v18, s[44:47], s53 offen offset:3072 sc1
    s_add_u32 s53, s51, 36864
    buffer_load_dwordx4 v[208:211], v18, s[44:47], s53 offen offset:0 sc1
    buffer_load_dwordx4 v[212:215], v18, s[44:47], s53 offen offset:1024 sc1
    buffer_load_dwordx4 v[216:219], v18, s[44:47], s53 offen offset:2048 sc1
    buffer_load_dwordx4 v[220:223], v18, s[44:47], s53 offen offset:3072 sc1
    s_mov_b32 s32, s24
    s_mov_b32 s33, s25
    s_mov_b32 s34, 0x500000
    s_mov_b32 s35, 0x20000
    s_and_b32 s54, s99, 3
    s_lshl_b32 s55, s98, 2
    s_add_u32 s54, s54, s55
    s_lshr_b32 s55, s54, 1
    s_lshl_b32 s55, s55, 12
    s_add_u32 s55, s55, 0xf20000
    s_lshl_b32 s57, s48, 10
    s_add_u32 s55, s55, s57
    v_lshrrev_b32 v15, 3, v1
    v_lshlrev_b32_e64 v15, 7, v15
    s_mul_i32 s57, s54, 81920
    s_add_u32 s57, s57, 0x4c0000
    s_lshl_b32 s58, s48, 10
    s_add_u32 s57, s57, s58
    s_add_u32 s58, s58, 65536
    v_mov_b32_e64 v5, v18
    v_add_u32 v6, 65536, v5
    v_add_u32 v7, 106496, v5
    v_lshlrev_b32_e64 v10, 3, v9
    v_lshl_add_u32 v10, v11, 9, v10
    v_add_u32 v10, 98304, v10
    s_lshl_b32 s56, s48, 6
    s_waitcnt lgkmcnt(0)
    v_mul_u32_u24 v12, 272, v9
    v_lshl_add_u32 v12, v11, 5, v12
    v_add_u32 v12, s56, v12
    v_lshrrev_b32 v2, 4, v1
    v_and_b32_e64 v3, 15, v1
    v_mul_u32_u24 v13, 272, v2
    v_lshl_add_u32 v13, v3, 4, v13
    s_mul_i32 s59, s48, 2176
    v_add_u32_e64 v13, s59, v13
    v_mul_u32_u24 v14, 2560, v2
    v_lshl_add_u32 v14, v3, 4, v14
    s_lshl_b32 s59, s54, 3
    s_add_u32 s59, s59, s48
    s_mul_i32 s59, s59, 20480
    s_add_u32 s59, s59, s52
    s_sub_u32 s59, s59, s56
    v_mov_b32 v16, 159756
    s_mov_b32 s101, 0x200000
L_lw_25:
    ds_read_b32 v17, v16
    s_waitcnt lgkmcnt(0)
    v_cmp_le_u32 vcc, 4, v17
    s_cbranch_vccnz L_lwd_26
    s_sleep 2
    s_sub_u32 s101, s101, 1
    s_cmp_eq_u32 s101, 0
    s_cbranch_scc0 L_lw_25
    s_endpgm
L_lwd_26:
    s_mov_b32 s101, 0x10000
L_poll_27:
    buffer_load_dwordx2 v[48:49], v15, s[44:47], s55 offen sc1
    s_waitcnt vmcnt(0)
    v_cmp_eq_u64 vcc, s[30:31], v[48:49]
    s_nop 0
    s_cmp_eq_u64 vcc, -1
    s_cbranch_scc1 L_polld_28
    s_sleep 2
    s_sub_u32 s101, s101, 1
    s_cmp_eq_u32 s101, 0
    s_cbranch_scc0 L_poll_27
    s_endpgm
L_polld_28:
    s_barrier
    s_add_u32 m0, s58, 0
    s_nop 0
    buffer_load_dwordx4 v5, s[44:47], s57 offen sc1 lds
    s_add_u32 s57, s57, 4096
    s_add_u32 m0, s58, 4096
    s_nop 0
    buffer_load_dwordx4 v5, s[44:47], s57 offen sc1 lds
    s_add_u32 s57, s57, 4096
    s_add_u32 m0, s58, 8192
    s_nop 0
    buffer_load_dwordx4 v5, s[44:47], s57 offen sc1 lds
    s_add_u32 s57, s57, 4096
    s_add_u32 m0, s58, 12288
    s_nop 0
    buffer_load_dwordx4 v5, s[44:47], s57 offen sc1 lds
    s_add_u32 s57, s57, 4096
    s_add_u32 m0, s58, 16384
    s_nop 0
    buffer_load_dwordx4 v5, s[44:47], s57 offen sc1 lds
    s_add_u32 s57, s57, 4096
    s_add_u32 m0, s58, 20480
    s_nop 0
    buffer_load_dwordx4 v5, s[44:47], s57 offen sc1 lds
    s_add_u32 s57, s57, 4096
    s_add_u32 m0, s58, 24576
    s_nop 0
    buffer_load_dwordx4 v5, s[44:47], s57 offen sc1 lds
    s_add_u32 s57, s57, 4096
    s_add_u32 m0, s58, 28672
    s_nop 0
    buffer_load_dwordx4 v5, s[44:47], s57 offen sc1 lds
    s_add_u32 s57, s57, 4096
    s_add_u32 m0, s58, 32768
    s_nop 0
    buffer_load_dwordx4 v5, s[44:47], s57 offen sc1 lds
    s_add_u32 s57, s57, 4096
    s_add_u32 m0, s58, 36864
    s_nop 0
    buffer_load_dwordx4 v5, s[44:47], s57 offen sc1 lds
    s_add_u32 s57, s57, 4096
    s_waitcnt vmcnt(8)
    s_barrier
    ds_read_b128 v[224:227], v6 offset:0
    ds_read_b128 v[228:231], v6 offset:1024
    ds_read_b128 v[232:235], v6 offset:2048
    ds_read_b128 v[236:239], v6 offset:3072
    ds_read_b128 v[240:243], v6 offset:4096
    ds_read_b128 v[244:247], v6 offset:5120
    s_waitcnt lgkmcnt(5)
    v_mfma_f32_32x32x16_bf16 v[16:31], v[64:67], v[224:227], 0
    s_add_u32 m0, s58, 40960
    s_nop 0
    buffer_load_dwordx4 v5, s[44:47], s57 offen sc1 lds
    s_add_u32 s57, s57, 4096
    ds_read_b128 v[248:251], v6 offset:6144
    s_waitcnt lgkmcnt(5)
    v_mfma_f32_32x32x16_bf16 v[16:31], v[68:71], v[228:231], v[16:31]
    s_add_u32 m0, s58, 45056
    s_nop 0
    buffer_load_dwordx4 v5, s[44:47], s57 offen sc1 lds
    s_add_u32 s57, s57, 4096
    ds_read_b128 v[252:255], v6 offset:7168
    s_waitcnt lgkmcnt(5)
    v_mfma_f32_32x32x16_bf16 v[16:31], v[72:75], v[232:235], v[16:31]
    s_add_u32 m0, s58, 49152
    s_nop 0
    buffer_load_dwordx4 v5, s[44:47], s57 offen sc1 lds
    s_add_u32 s57, s57, 4096
    s_waitcnt vmcnt(9)
    s_barrier
    ds_read_b128 v[224:227], v6 offset:8192
    s_waitcnt lgkmcnt(5)
    v_mfma_f32_32x32x16_bf16 v[16:31], v[76:79], v[236:239], v[16:31]
    s_add_u32 m0, s58, 53248
    s_nop 0
    buffer_load_dwordx4 v5, s[44:47], s57 offen sc1 lds
    s_add_u32 s57, s57, 4096
    ds_read_b128 v[228:231], v6 offset:9216
    s_waitcnt lgkmcnt(5)
    v_mfma_f32_32x32x16_bf16 v[16:31], v[80:83], v[240:243], v[16:31]
    s_add_u32 m0, s58, 57344
    s_nop 0
    buffer_load_dwordx4 v5, s[44:47], s57 offen sc1 lds
    s_add_u32 s57, s57, 4096
    ds_read_b128 v[232:235], v6 offset:10240
    s_waitcnt lgkmcnt(5)
    v_mfma_f32_32x32x16_bf16 v[16:31], v[84:87], v[244:247], v[16:31]
    s_add_u32 m0, s58, 61440
    s_nop 0
    buffer_load_dwordx4 v5, s[44:47], s57 offen sc1 lds
    s_add_u32 s57, s57, 4096
    ds_read_b128 v[236:239], v6 offset:11264
    s_waitcnt lgkmcnt(5)
    v_mfma_f32_32x32x16_bf16 v[16:31], v[88:91], v[248:251], v[16:31]
    s_add_u32 m0, s58, 65536
    s_nop 0
    buffer_load_dwordx4 v5, s[44:47], s57 offen sc1 lds
    s_add_u32 s57, s57, 4096
    ds_read_b128 v[240:243], v6 offset:12288
    s_waitcnt lgkmcnt(5)
    v_mfma_f32_32x32x16_bf16 v[16:31], v[92:95], v[252:255], v[16:31]
    s_add_u32 m0, s58, 69632
    s_nop 0
    buffer_load_dwordx4 v5, s[44:47], s57 offen sc1 lds
    s_add_u32 s57, s57, 4096
    ds_read_b128 v[244:247], v6 offset:13312
    s_waitcnt lgkmcnt(5)
    v_mfma_f32_32x32x16_bf16 v[16:31], v[96:99], v[224:227], v[16:31]
    s_add_u32 m0, s58, 73728
    s_nop 0
    buffer_load_dwordx4 v5, s[44:47], s57 offen sc1 lds
    s_add_u32 s57, s57, 4096
    ds_read_b128 v[248:251], v6 offset:14336
    s_waitcnt lgkmcnt(5)
    v_mfma_f32_32x32x16_bf16 v[16:31], v[100:103], v[228:231], v[16:31]
    s_add_u32 m0, s58, 77824
    s_nop 0
    buffer_load_dwordx4 v5, s[44:47], s57 offen sc1 lds
    ds_read_b128 v[252:255], v6 offset:15360
    s_waitcnt lgkmcnt(5)
    v_mfma_f32_32x32x16_bf16 v[16:31], v[104:107], v[232:235], v[16:31]
    s_waitcnt vmcnt(12)
    s_barrier
    ds_read_b128 v[224:227], v6 offset:16384
    s_waitcnt lgkmcnt(5)
    v_mfma_f32_32x32x16_bf16 v[16:31], v[108:111], v[236:239], v[16:31]
    ds_read_b128 v[228:231], v6 offset:17408
    s_waitcnt lgkmcnt(5)
    v_mfma_f32_32x32x16_bf16 v[16:31], v[112:115], v[240:243], v[16:31]
    ds_read_b128 v[232:235], v6 offset:18432
    s_waitcnt lgkmcnt(5)
    v_mfma_f32_32x32x16_bf16 v[16:31], v[116:119], v[244:247], v[16:31]
    ds_read_b128 v[236:239], v6 offset:19456
    s_waitcnt lgkmcnt(5)
    v_mfma_f32_32x32x16_bf16 v[16:31], v[120:123], v[248:251], v[16:31]
    ds_read_b128 v[240:243], v6 offset:20480
    s_waitcnt lgkmcnt(5)
    v_mfma_f32_32x32x16_bf16 v[16:31], v[124:127], v[252:255], v[16:31]
    ds_read_b128 v[244:247], v6 offset:21504
    s_waitcnt lgkmcnt(5)
    v_mfma_f32_32x32x16_bf16 v[16:31], v[128:131], v[224:227], v[16:31]
    ds_read_b128 v[248:251], v6 offset:22528
    s_waitcnt lgkmcnt(5)
    v_mfma_f32_32x32x16_bf16 v[16:31], v[132:135], v[228:231], v[16:31]
    ds_read_b128 v[252:255], v6 offset:23552
    s_waitcnt lgkmcnt(5)
    v_mfma_f32_32x32x16_bf16 v[16:31], v[136:139], v[232:235], v[16:31]
    ds_read_b128 v[224:227], v6 offset:24576
    s_waitcnt lgkmcnt(5)
    v_mfma_f32_32x32x16_bf16 v[16:31], v[140:143], v[236:239], v[16:31]
    ds_read_b128 v[228:231], v6 offset:25600
    s_waitcnt lgkmcnt(5)
    v_mfma_f32_32x32x16_bf16 v[16:31], v[144:147], v[240:243], v[16:31]
    ds_read_b128 v[232:235], v6 offset:26624
    s_waitcnt lgkmcnt(5)
    v_mfma_f32_32x32x16_bf16 v[16:31], v[148:151], v[244:247], v[16:31]
    ds_read_b128 v[236:239], v6 offset:27648
    s_waitcnt lgkmcnt(5)
    v_mfma_f32_32x32x16_bf16 v[16:31], v[152:155], v[248:251], v[16:31]
    ds_read_b128 v[240:243], v6 offset:28672
    s_waitcnt lgkmcnt(5)
    v_mfma_f32_32x32x16_bf16 v[16:31], v[156:159], v[252:255], v[16:31]
    ds_read_b128 v[244:247], v6 offset:29696
    s_waitcnt lgkmcnt(5)
    v_mfma_f32_32x32x16_bf16 v[16:31], v[160:163], v[224:227], v[16:31]
    ds_read_b128 v[248:251], v6 offset:30720
    s_waitcnt lgkmcnt(5)
    v_mfma_f32_32x32x16_bf16 v[16:31], v[164:167], v[228:231], v[16:31]
    ds_read_b128 v[252:255], v6 offset:31744
    s_waitcnt lgkmcnt(5)
    v_mfma_f32_32x32x16_bf16 v[16:31], v[168:171], v[232:235], v[16:31]
    s_waitcnt vmcnt(8)
    s_barrier
    ds_read_b64 v[224:225], v10 offset:0
    ds_read_b64 v[226:227], v10 offset:256
    s_waitcnt lgkmcnt(6)
    v_mfma_f32_32x32x16_bf16 v[16:31], v[172:175], v[236:239], v[16:31]
    ds_read_b64 v[228:229], v10 offset:1024
    ds_read_b64 v[230:231], v10 offset:1280
    s_waitcnt lgkmcnt(7)
    v_mfma_f32_32x32x16_bf16 v[16:31], v[176:179], v[240:243], v[16:31]
    ds_read_b64 v[232:233], v10 offset:2048
    ds_read_b64 v[234:235], v10 offset:2304
    s_waitcnt lgkmcnt(8)
    v_mfma_f32_32x32x16_bf16 v[16:31], v[180:183], v[244:247], v[16:31]
    ds_read_b64 v[236:237], v10 offset:3072
    ds_read_b64 v[238:239], v10 offset:3328
    s_waitcnt lgkmcnt(9)
    v_mfma_f32_32x32x16_bf16 v[16:31], v[184:187], v[248:251], v[16:31]
    ds_read_b64 v[240:241], v10 offset:4096
    ds_read_b64 v[242:243], v10 offset:4352
    s_waitcnt lgkmcnt(10)
    v_mfma_f32_32x32x16_bf16 v[16:31], v[188:191], v[252:255], v[16:31]
    ds_read_b64 v[244:245], v10 offset:5120
    ds_read_b64 v[246:247], v10 offset:5376
    s_waitcnt lgkmcnt(10)
    v_mfma_f32_32x32x16_bf16 v[16:31], v[192:195], v[224:227], v[16:31]
    ds_read_b64 v[248:249], v10 offset:6144
    ds_read_b64 v[250:251], v10 offset:6400
    s_waitcnt lgkmcnt(10)
    v_mfma_f32_32x32x16_bf16 v[16:31], v[196:199], v[228:231], v[16:31]
    ds_read_b64 v[252:253], v10 offset:7168
    ds_read_b64 v[254:255], v10 offset:7424
    s_waitcnt lgkmcnt(10)
    v_mfma_f32_32x32x16_bf16 v[16:31], v[200:203], v[232:235], v[16:31]
    ds_read_b128 v[224:227], v7 offset:0
    s_waitcnt lgkmcnt(9)
    v_mfma_f32_32x32x16_bf16 v[16:31], v[204:207], v[236:239], v[16:31]
    ds_read_b128 v[228:231], v7 offset:1024
    s_waitcnt lgkmcnt(8)
    v_mfma_f32_32x32x16_bf16 v[16:31], v[208:211], v[240:243], v[16:31]
    ds_read_b128 v[232:235], v7 offset:2048
    s_waitcnt lgkmcnt(7)
    v_mfma_f32_32x32x16_bf16 v[16:31], v[212:215], v[244:247], v[16:31]
    ds_read_b128 v[236:239], v7 offset:3072
    s_waitcnt lgkmcnt(6)
    v_mfma_f32_32x32x16_bf16 v[16:31], v[216:219], v[248:251], v[16:31]
    ds_read_b128 v[240:243], v7 offset:4096
    s_waitcnt lgkmcnt(5)
    v_mfma_f32_32x32x16_bf16 v[16:31], v[220:223], v[252:255], v[16:31]
    ds_read_b128 v[244:247], v7 offset:5120
    s_waitcnt lgkmcnt(5)
    v_mfma_f32_32x32x16_bf16 v[32:47], v[64:67], v[224:227], 0
    ds_read_b128 v[248:251], v7 offset:6144
    s_waitcnt lgkmcnt(5)
    v_mfma_f32_32x32x16_bf16 v[32:47], v[68:71], v[228:231], v[32:47]
    ds_read_b128 v[252:255], v7 offset:7168
    s_waitcnt lgkmcnt(5)
    v_mfma_f32_32x32x16_bf16 v[32:47], v[72:75], v[232:235], v[32:47]
    s_waitcnt vmcnt(4)
    s_barrier
    ds_read_b128 v[224:227], v7 offset:8192
    s_waitcnt lgkmcnt(5)
    v_mfma_f32_32x32x16_bf16 v[32:47], v[76:79], v[236:239], v[32:47]
    ds_read_b128 v[228:231], v7 offset:9216
    s_waitcnt lgkmcnt(5)
    v_mfma_f32_32x32x16_bf16 v[32:47], v[80:83], v[240:243], v[32:47]
    ds_read_b128 v[232:235], v7 offset:10240
    v_cvt_pk_bf16_f32 v48, v16, v17
    v_cvt_pk_bf16_f32 v49, v18, v19
    s_waitcnt lgkmcnt(5)
    v_mfma_f32_32x32x16_bf16 v[32:47], v[84:87], v[244:247], v[32:47]
    ds_read_b128 v[236:239], v7 offset:11264
    v_cvt_pk_bf16_f32 v50, v20, v21
    v_cvt_pk_bf16_f32 v51, v22, v23
    s_waitcnt lgkmcnt(5)
    v_mfma_f32_32x32x16_bf16 v[32:47], v[88:91], v[248:251], v[32:47]
    ds_read_b128 v[240:243], v7 offset:12288
    ds_write_b128 v12, v[48:51] offset:0
    v_cvt_pk_bf16_f32 v52, v24, v25
    s_waitcnt lgkmcnt(6)
    v_mfma_f32_32x32x16_bf16 v[32:47], v[92:95], v[252:255], v[32:47]
    ds_read_b128 v[244:247], v7 offset:13312
    v_cvt_pk_bf16_f32 v53, v26, v27
    v_cvt_pk_bf16_f32 v54, v28, v29
    s_waitcnt lgkmcnt(6)
    v_mfma_f32_32x32x16_bf16 v[32:47], v[96:99], v[224:227], v[32:47]
    ds_read_b128 v[248:251], v7 offset:14336
    v_cvt_pk_bf16_f32 v55, v30, v31
    ds_write_b128 v12, v[52:55] offset:16
    s_waitcnt lgkmcnt(7)
    v_mfma_f32_32x32x16_bf16 v[32:47], v[100:103], v[228:231], v[32:47]
    ds_read_b128 v[252:255], v7 offset:15360
    s_waitcnt lgkmcnt(7)
    v_mfma_f32_32x32x16_bf16 v[32:47], v[104:107], v[232:235], v[32:47]
    ds_read_b128 v[224:227], v7 offset:16384
    s_waitcnt lgkmcnt(7)
    v_mfma_f32_32x32x16_bf16 v[32:47], v[108:111], v[236:239], v[32:47]
    ds_read_b128 v[228:231], v7 offset:17408
    s_waitcnt lgkmcnt(7)
    v_mfma_f32_32x32x16_bf16 v[32:47], v[112:115], v[240:243], v[32:47]
    ds_read_b128 v[232:235], v7 offset:18432
    s_waitcnt lgkmcnt(6)
    v_mfma_f32_32x32x16_bf16 v[32:47], v[116:119], v[244:247], v[32:47]
    ds_read_b128 v[236:239], v7 offset:19456
    s_waitcnt lgkmcnt(6)
    v_mfma_f32_32x32x16_bf16 v[32:47], v[120:123], v[248:251], v[32:47]
    ds_read_b128 v[240:243], v7 offset:20480
    s_waitcnt lgkmcnt(5)
    v_mfma_f32_32x32x16_bf16 v[32:47], v[124:127], v[252:255], v[32:47]
    ds_read_b128 v[244:247], v7 offset:21504
    s_waitcnt lgkmcnt(5)
    v_mfma_f32_32x32x16_bf16 v[32:47], v[128:131], v[224:227], v[32:47]
    ds_read_b128 v[248:251], v7 offset:22528
    s_waitcnt lgkmcnt(5)
    v_mfma_f32_32x32x16_bf16 v[32:47], v[132:135], v[228:231], v[32:47]
    ds_read_b128 v[252:255], v7 offset:23552
    s_waitcnt lgkmcnt(5)
    v_mfma_f32_32x32x16_bf16 v[32:47], v[136:139], v[232:235], v[32:47]
    s_waitcnt vmcnt(0)
    s_barrier
    ds_read_b128 v[224:227], v7 offset:24576
    ds_read_b128 v[56:59], v13 offset:0
    s_waitcnt lgkmcnt(6)
    v_mfma_f32_32x32x16_bf16 v[32:47], v[140:143], v[236:239], v[32:47]
    ds_read_b128 v[228:231], v7 offset:25600
    ds_read_b128 v[60:63], v13 offset:1088
    s_waitcnt lgkmcnt(7)
    v_mfma_f32_32x32x16_bf16 v[32:47], v[144:147], v[240:243], v[32:47]
    ds_read_b128 v[232:235], v7 offset:26624
    s_waitcnt lgkmcnt(7)
    v_mfma_f32_32x32x16_bf16 v[32:47], v[148:151], v[244:247], v[32:47]
    ds_read_b128 v[236:239], v7 offset:27648
    s_waitcnt lgkmcnt(7)
    v_mfma_f32_32x32x16_bf16 v[32:47], v[152:155], v[248:251], v[32:47]
    ds_read_b128 v[240:243], v7 offset:28672
    s_waitcnt lgkmcnt(5)
    v_mfma_f32_32x32x16_bf16 v[32:47], v[156:159], v[252:255], v[32:47]
    ds_read_b128 v[244:247], v7 offset:29696
    buffer_store_dwordx4 v[56:59], v14, s[32:35], s59 offen sc1 nt
    v_mfma_f32_32x32x16_bf16 v[32:47], v[160:163], v[224:227], v[32:47]
    ds_read_b128 v[248:251], v7 offset:30720
    s_add_u32 s59, s59, 10240
    s_waitcnt lgkmcnt(6)
    v_mfma_f32_32x32x16_bf16 v[32:47], v[164:167], v[228:231], v[32:47]
    ds_read_b128 v[252:255], v7 offset:31744
    s_waitcnt lgkmcnt(6)
    s_waitcnt lgkmcnt(5)
    v_mfma_f32_32x32x16_bf16 v[32:47], v[168:171], v[232:235], v[32:47]
    ds_read_b64 v[224:225], v10 offset:40960
    ds_read_b64 v[226:227], v10 offset:41216
    buffer_store_dwordx4 v[60:63], v14, s[32:35], s59 offen sc1 nt
    s_waitcnt lgkmcnt(6)
    v_mfma_f32_32x32x16_bf16 v[32:47], v[172:175], v[236:239], v[32:47]
    ds_read_b64 v[228:229], v10 offset:41984
    ds_read_b64 v[230:231], v10 offset:42240
    s_add_u32 s59, s59, 71680
    s_waitcnt lgkmcnt(7)
    v_mfma_f32_32x32x16_bf16 v[32:47], v[176:179], v[240:243], v[32:47]
    ds_read_b64 v[232:233], v10 offset:43008
    ds_read_b64 v[234:235], v10 offset:43264
    s_waitcnt lgkmcnt(8)
    v_mfma_f32_32x32x16_bf16 v[32:47], v[180:183], v[244:247], v[32:47]
    ds_read_b64 v[236:237], v10 offset:44032
    ds_read_b64 v[238:239], v10 offset:44288
    s_waitcnt lgkmcnt(9)
    v_mfma_f32_32x32x16_bf16 v[32:47], v[184:187], v[248:251], v[32:47]
    ds_read_b64 v[240:241], v10 offset:45056
    ds_read_b64 v[242:243], v10 offset:45312
    s_waitcnt lgkmcnt(10)
    v_mfma_f32_32x32x16_bf16 v[32:47], v[188:191], v[252:255], v[32:47]
    ds_read_b64 v[244:245], v10 offset:46080
    ds_read_b64 v[246:247], v10 offset:46336
    s_waitcnt lgkmcnt(10)
    v_mfma_f32_32x32x16_bf16 v[32:47], v[192:195], v[224:227], v[32:47]
    ds_read_b64 v[248:249], v10 offset:47104
    ds_read_b64 v[250:251], v10 offset:47360
    s_waitcnt lgkmcnt(10)
    v_mfma_f32_32x32x16_bf16 v[32:47], v[196:199], v[228:231], v[32:47]
    ds_read_b64 v[252:253], v10 offset:48128
    ds_read_b64 v[254:255], v10 offset:48384
    s_waitcnt lgkmcnt(10)
    v_mfma_f32_32x32x16_bf16 v[32:47], v[200:203], v[232:235], v[32:47]
    s_waitcnt lgkmcnt(8)
    v_mfma_f32_32x32x16_bf16 v[32:47], v[204:207], v[236:239], v[32:47]
    s_waitcnt lgkmcnt(6)
    v_mfma_f32_32x32x16_bf16 v[32:47], v[208:211], v[240:243], v[32:47]
    s_waitcnt lgkmcnt(4)
    v_mfma_f32_32x32x16_bf16 v[32:47], v[212:215], v[244:247], v[32:47]
    s_waitcnt lgkmcnt(2)
    v_mfma_f32_32x32x16_bf16 v[32:47], v[216:219], v[248:251], v[32:47]
    s_waitcnt lgkmcnt(0)
    v_mfma_f32_32x32x16_bf16 v[32:47], v[220:223], v[252:255], v[32:47]
    s_nop 11
    s_nop 0
    v_cvt_pk_bf16_f32 v48, v32, v33
    v_cvt_pk_bf16_f32 v49, v34, v35
    v_cvt_pk_bf16_f32 v50, v36, v37
    v_cvt_pk_bf16_f32 v51, v38, v39
    ds_write_b128 v12, v[48:51] offset:8704
    v_cvt_pk_bf16_f32 v52, v40, v41
    v_cvt_pk_bf16_f32 v53, v42, v43
    v_cvt_pk_bf16_f32 v54, v44, v45
    v_cvt_pk_bf16_f32 v55, v46, v47
    ds_write_b128 v12, v[52:55] offset:8720
    s_waitcnt lgkmcnt(0)
    s_barrier
    ds_read_b128 v[56:59], v13 offset:8704
    ds_read_b128 v[60:63], v13 offset:9792
    s_waitcnt lgkmcnt(1)
    buffer_store_dwordx4 v[56:59], v14, s[32:35], s59 offen sc1 nt
    s_add_u32 s59, s59, 10240
    s_waitcnt lgkmcnt(0)
    buffer_store_dwordx4 v[60:63], v14, s[32:35], s59 offen sc1 nt
    s_add_u32 s59, s59, 71680
    s_endpgm
L_c:
    v_mov_b32 v16, 0
    v_mov_b32 v17, 0
    v_mov_b32 v18, 0
    v_mov_b32 v19, 0
    v_mov_b32 v20, 0
    v_mov_b32 v21, 0
    v_mov_b32 v22, 0
    v_mov_b32 v23, 0
    v_mov_b32 v24, 0
    v_mov_b32 v25, 0
    v_mov_b32 v26, 0
    v_mov_b32 v27, 0
    v_mov_b32 v28, 0
    v_mov_b32 v29, 0
    v_mov_b32 v30, 0
    v_mov_b32 v31, 0
    v_mov_b32 v32, 0
    v_mov_b32 v33, 0
    v_mov_b32 v34, 0
    v_mov_b32 v35, 0
    v_mov_b32 v36, 0
    v_mov_b32 v37, 0
    v_mov_b32 v38, 0
    v_mov_b32 v39, 0
    v_mov_b32 v40, 0
    v_mov_b32 v41, 0
    v_mov_b32 v42, 0
    v_mov_b32 v43, 0
    v_mov_b32 v44, 0
    v_mov_b32 v45, 0
    v_mov_b32 v46, 0
    v_mov_b32 v47, 0
    v_mov_b32 v48, 0
    v_mov_b32 v49, 0
    v_mov_b32 v50, 0
    v_mov_b32 v51, 0
    v_mov_b32 v52, 0
    v_mov_b32 v53, 0
    v_mov_b32 v54, 0
    v_mov_b32 v55, 0
    v_mov_b32 v56, 0
    v_mov_b32 v57, 0
    v_mov_b32 v58, 0
    v_mov_b32 v59, 0
    v_mov_b32 v60, 0
    v_mov_b32 v61, 0
    v_mov_b32 v62, 0
    v_mov_b32 v63, 0
    v_mov_b32 v64, 0
    v_mov_b32 v65, 0
    v_mov_b32 v66, 0
    v_mov_b32 v67, 0
    v_mov_b32 v68, 0
    v_mov_b32 v69, 0
    v_mov_b32 v70, 0
    v_mov_b32 v71, 0
    v_mov_b32 v72, 0
    v_mov_b32 v73, 0
    v_mov_b32 v74, 0
    v_mov_b32 v75, 0
    v_mov_b32 v76, 0
    v_mov_b32 v77, 0
    v_mov_b32 v78, 0
    v_mov_b32 v79, 0
    v_mov_b32 v80, 0
    v_mov_b32 v81, 0
    v_mov_b32 v82, 0
    v_mov_b32 v83, 0
    v_mov_b32 v84, 0
    v_mov_b32 v85, 0
    v_mov_b32 v86, 0
    v_mov_b32 v87, 0
    v_mov_b32 v88, 0
    v_mov_b32 v89, 0
    v_mov_b32 v90, 0
    v_mov_b32 v91, 0
    v_mov_b32 v92, 0
    v_mov_b32 v93, 0
    v_mov_b32 v94, 0
    v_mov_b32 v95, 0
    v_and_b32 v11, 255, v0
    v_lshlrev_b32 v11, 4, v11
    v_add_u32 v11, 155648, v11
    ds_write_b128 v11, v[16:19]
    ds_write_b128 v11, v[16:19] offset:64
    s_lshr_b32 s52, s48, 1
    s_and_b32 s53, s48, 1
    v_and_b32 v183, 15, v1
    v_lshrrev_b32 v184, 4, v1
    v_bfe_u32 v185, v1, 2, 2
    v_and_b32 v186, 3, v1
    v_bfe_u32 v13, v1, 1, 3
    v_xor_b32 v13, v13, v184
    v_lshlrev_b32 v13, 4, v13
    v_lshl_add_u32 v13, v183, 7, v13
    s_lshl_b32 s54, s52, 13
    v_add_u32 v168, s54, v13
    v_xor_b32 v169, 64, v168
    v_add_u32 v170, 73728, v168
    v_add_u32 v171, 73728, v169
    s_cmp_eq_u32 s51, 0
    s_cselect_b32 s55, 80, 0
    s_mul_i32 s56, s53, 80
    s_lshl_b32 s56, s56, s51
    v_lshrrev_b32 v11, 1, v186
    v_mul_u32_u24 v11, s55, v11
    v_mad_u32_u24 v11, v186, 40, v11
    v_add_u32 v11, s56, v11
    v_and_b32 v12, 1, v184
    s_add_u32 s57, s51, 4
    v_lshlrev_b32 v12, s57, v12
    v_lshl_add_u32 v13, v184, 3, v185
    v_mul_u32_u24 v13, 320, v13
    v_add_u32 v13, 16384, v13
    v_add_u32 v14, 0, v11
    v_xor_b32 v14, v14, v12
    v_add_u32 v172, v13, v14
    v_add_u32 v177, 73728, v172
    v_add_u32 v14, 8, v11
    v_xor_b32 v14, v14, v12
    v_add_u32 v173, v13, v14
    v_add_u32 v178, 73728, v173
    v_add_u32 v14, 16, v11
    v_xor_b32 v14, v14, v12
    v_add_u32 v174, v13, v14
    v_add_u32 v179, 73728, v174
    v_add_u32 v14, 24, v11
    v_xor_b32 v14, v14, v12
    v_add_u32 v175, v13, v14
    v_add_u32 v180, 73728, v175
    v_add_u32 v14, 32, v11
    v_xor_b32 v14, v14, v12
    v_add_u32 v176, v13, v14
    v_add_u32 v181, 73728, v176
    s_cmp_eq_u32 s51, 0
    s_cselect_b32 s55, 1, 3
    s_add_u32 s57, s51, 1
    s_lshl_b32 s56, s53, s57
    v_and_b32 v187, s55, v184
    v_add_u32_e64 v187, s56, v187
    v_mul_u32_u24 v11, 800, v187
    v_mad_u32_u24 v11, v185, 40, v11
    v_add_u32 v11, 147456, v11
    v_mov_b32 v12, 155648
    v_cmp_eq_u32 vcc, v186, v184
    s_nop 1
    v_cndmask_b32 v182, v12, v11, vcc
    v_lshrrev_b32 v11, 5, v1
    v_lshl_add_u32 v11, v11, 4, v183
    s_lshl_b32 s57, s52, 6
    v_add_u32 v11, s57, v11
    v_mul_u32_u24 v12, 208, v11
    v_mad_u32_u24 v2, v187, 48, v12
    v_add_u32 v2, 43008, v2
    v_mul_u32_u24 v14, 80, v187
    v_mul_u32_u24 v13, 336, v11
    v_add_u32 v3, v14, v13
    v_lshrrev_b32 v12, 5, v1
    v_lshl_add_u32 v9, v12, 3, v185
    v_bfe_u32 v13, v1, 4, 1
    v_bfe_u32 v14, v1, 1, 1
    v_lshl_add_u32 v10, v13, 1, v14
    v_and_b32_e64 v15, 1, v1
    v_mul_u32_u24 v11, 336, v9
    v_mad_u32_u24 v12, v15, 5, v10
    v_lshl_add_u32 v11, v12, 3, v11
    s_mul_i32 s57, s48, 80
    v_add_u32 v6, s57, v11
    v_lshl_add_u32 v11, v10, 1, v15
    s_mul_i32 s57, s48, 6
    v_min_u32 v12, 5, v11
    v_add_u32 v12, s57, v12
    v_mul_u32_u24 v11, 208, v9
    v_lshl_add_u32 v11, v12, 3, v11
    v_add_u32 v7, 43008, v11
    v_mov_b32 v198, 0
    v_mov_b32 v199, 0
    v_mov_b32 v210, 0
    v_mov_b32 v211, 0
    v_mov_b32 v222, 0
    v_mov_b32 v223, 0
    v_mov_b32 v234, 0
    v_mov_b32 v235, 0
    v_mov_b32 v246, 0
    v_mov_b32 v247, 0
    s_mov_b32 s60, 0x3fb8aa3b
    s_mov_b32 s61, 0x3fb8aa3b
    s_waitcnt lgkmcnt(0)
    s_mov_b32 s44, s28
    s_mov_b32 s45, s29
    s_mov_b32 s46, 0x1100000
    s_mov_b32 s47, 0x20000
    s_sub_u32 s63, s99, 8
    s_lshr_b32 s62, s63, 2
    s_lshl_b32 s3, s98, 2
    s_add_u32 s62, s62, s3
    s_and_b32 s63, s63, 3
    s_lshl_b32 s63, s63, 2
    s_add_u32 s63, s63, s48
    s_lshl_b32 s54, s62, 2
    s_add_u32 s54, s54, s48
    s_lshl_b32 s54, s54, 2
    s_lshr_b32 s55, s62, 2
    s_lshl_b32 s55, s55, 4
    s_add_u32 s55, s55, s63
    s_lshl_b32 s55, s55, 1
    s_add_u32 s55, s55, 508
    s_and_b32 s56, s99, 2
    s_lshl_b32 s57, s98, 2
    s_add_u32 s56, s56, s57
    s_lshl_b32 s56, s56, 4
    s_lshl_b32 s57, s48, 3
    s_add_u32 s56, s56, s57
    s_add_u32 s56, s56, 1016
    v_mov_b32 v11, s54
    v_mov_b32 v12, s55
    v_mov_b32 v13, s56
    v_cmp_gt_u32 vcc, 16, v1
    s_nop 1
    v_cndmask_b32 v12, v12, v11, vcc
    v_cmp_gt_u32 vcc, 32, v1
    s_nop 1
    v_cndmask_b32 v12, v13, v12, vcc
    v_lshrrev_b32 v11, 2, v1
    v_add_u32 v11, v11, v12
    v_and_b32 v11, 2047, v11
    v_lshlrev_b32_e64 v11, 7, v11
    s_mov_b32 s54, 0xf00000
    buffer_load_dword v4, v11, s[44:47], s54 offen sc1
    s_setprio 2
    s_barrier
    ds_read_b64_tr_b16 v[96:97], v172 offset:0
    ds_read_b64_tr_b16 v[98:99], v172 offset:1280
    ds_read_b128 v[136:139], v168 offset:0
    ds_read_b128 v[140:143], v168 offset:2048
    ds_read_b128 v[144:147], v168 offset:4096
    ds_read_b128 v[148:151], v168 offset:6144
    ds_read_b64_tr_b16 v[100:101], v173 offset:0
    ds_read_b64_tr_b16 v[102:103], v173 offset:1280
    ds_read_b64_tr_b16 v[104:105], v174 offset:0
    ds_read_b64_tr_b16 v[106:107], v174 offset:1280
    ds_read_b64_tr_b16 v[108:109], v175 offset:0
    ds_read_b64_tr_b16 v[110:111], v175 offset:1280
    ds_read_b64_tr_b16 v[112:113], v176 offset:0
    ds_read_b64_tr_b16 v[114:115], v176 offset:1280
    s_waitcnt lgkmcnt(11)
    v_mfma_f32_16x16x32_bf16 v[16:19], v[96:99], v[136:139], v[16:19]
    ds_read_b64_tr_b16 v[116:117], v172 offset:10240
    s_waitcnt lgkmcnt(11)
    v_mfma_f32_16x16x32_bf16 v[36:39], v[96:99], v[140:143], v[36:39]
    ds_read_b64_tr_b16 v[118:119], v172 offset:11520
    s_waitcnt lgkmcnt(11)
    v_mfma_f32_16x16x32_bf16 v[56:59], v[96:99], v[144:147], v[56:59]
    ds_read_b128 v[152:155], v169 offset:0
    s_waitcnt lgkmcnt(11)
    v_mfma_f32_16x16x32_bf16 v[76:79], v[96:99], v[148:151], v[76:79]
    ds_read_b128 v[156:159], v169 offset:2048
    s_waitcnt lgkmcnt(10)
    v_mfma_f32_16x16x32_bf16 v[20:23], v[100:103], v[136:139], v[20:23]
    ds_read_b128 v[160:163], v169 offset:4096
    v_mfma_f32_16x16x32_bf16 v[40:43], v[100:103], v[140:143], v[40:43]
    ds_read_b128 v[164:167], v169 offset:6144
    v_mfma_f32_16x16x32_bf16 v[60:63], v[100:103], v[144:147], v[60:63]
    ds_read_b64_tr_b16 v[120:121], v173 offset:10240
    v_mfma_f32_16x16x32_bf16 v[80:83], v[100:103], v[148:151], v[80:83]
    ds_read_b64_tr_b16 v[122:123], v173 offset:11520
    s_waitcnt lgkmcnt(12)
    v_mfma_f32_16x16x32_bf16 v[24:27], v[104:107], v[136:139], v[24:27]
    ds_read_b64_tr_b16 v[124:125], v174 offset:10240
    v_mfma_f32_16x16x32_bf16 v[44:47], v[104:107], v[140:143], v[44:47]
    ds_read_b64_tr_b16 v[126:127], v174 offset:11520
    v_mfma_f32_16x16x32_bf16 v[64:67], v[104:107], v[144:147], v[64:67]
    ds_read_b64_tr_b16 v[128:129], v175 offset:10240
    v_mfma_f32_16x16x32_bf16 v[84:87], v[104:107], v[148:151], v[84:87]
    ds_read_b64_tr_b16 v[130:131], v175 offset:11520
    s_waitcnt lgkmcnt(14)
    v_mfma_f32_16x16x32_bf16 v[28:31], v[108:111], v[136:139], v[28:31]
    ds_read_b64_tr_b16 v[132:133], v176 offset:10240
    v_mfma_f32_16x16x32_bf16 v[48:51], v[108:111], v[140:143], v[48:51]
    ds_read_b64_tr_b16 v[134:135], v176 offset:11520
    v_mfma_f32_16x16x32_bf16 v[68:71], v[108:111], v[144:147], v[68:71]
    ds_read_b64_tr_b16 v[188:189], v182 offset:0
    v_mfma_f32_16x16x32_bf16 v[88:91], v[108:111], v[148:151], v[88:91]
    ds_read_b64_tr_b16 v[190:191], v182 offset:160
    s_waitcnt lgkmcnt(15)
    v_mfma_f32_16x16x32_bf16 v[32:35], v[112:115], v[136:139], v[32:35]
    ds_read_b64_tr_b16 v[192:193], v182 offset:320
    v_mfma_f32_16x16x32_bf16 v[52:55], v[112:115], v[140:143], v[52:55]
    ds_read_b64_tr_b16 v[194:195], v182 offset:480
    v_mfma_f32_16x16x32_bf16 v[72:75], v[112:115], v[144:147], v[72:75]
    ds_read_b64_tr_b16 v[196:197], v182 offset:640
    v_mfma_f32_16x16x32_bf16 v[92:95], v[112:115], v[148:151], v[92:95]
    s_waitcnt lgkmcnt(15)
    v_mfma_f32_16x16x32_bf16 v[16:19], v[116:119], v[152:155], v[16:19]
    v_mfma_f32_16x16x32_bf16 v[36:39], v[116:119], v[156:159], v[36:39]
    s_waitcnt lgkmcnt(14)
    v_mfma_f32_16x16x32_bf16 v[56:59], v[116:119], v[160:163], v[56:59]
    s_waitcnt lgkmcnt(13)
    v_mfma_f32_16x16x32_bf16 v[76:79], v[116:119], v[164:167], v[76:79]
    s_waitcnt lgkmcnt(11)
    v_mfma_f32_16x16x32_bf16 v[20:23], v[120:123], v[152:155], v[20:23]
    s_waitcnt lgkmcnt(0)
    s_barrier
    ds_read_b64_tr_b16 v[96:97], v172 offset:36864
    v_mfma_f32_16x16x32_bf16 v[40:43], v[120:123], v[156:159], v[40:43]
    ds_read_b64_tr_b16 v[98:99], v172 offset:38144
    v_mfma_f32_16x16x32_bf16 v[60:63], v[120:123], v[160:163], v[60:63]
    ds_read_b128 v[136:139], v168 offset:36864
    v_mfma_f32_16x16x32_bf16 v[80:83], v[120:123], v[164:167], v[80:83]
    ds_read_b128 v[140:143], v168 offset:38912
    v_mfma_f32_16x16x32_bf16 v[24:27], v[124:127], v[152:155], v[24:27]
    ds_read_b128 v[144:147], v168 offset:40960
    v_mfma_f32_16x16x32_bf16 v[44:47], v[124:127], v[156:159], v[44:47]
    ds_read_b128 v[148:151], v168 offset:43008
    v_mfma_f32_16x16x32_bf16 v[64:67], v[124:127], v[160:163], v[64:67]
    ds_read_b64_tr_b16 v[100:101], v173 offset:36864
    v_mfma_f32_16x16x32_bf16 v[84:87], v[124:127], v[164:167], v[84:87]
    ds_read_b64_tr_b16 v[102:103], v173 offset:38144
    v_mfma_f32_16x16x32_bf16 v[28:31], v[128:131], v[152:155], v[28:31]
    ds_read_b64_tr_b16 v[104:105], v174 offset:36864
    v_mfma_f32_16x16x32_bf16 v[48:51], v[128:131], v[156:159], v[48:51]
    ds_read_b64_tr_b16 v[106:107], v174 offset:38144
    v_mfma_f32_16x16x32_bf16 v[68:71], v[128:131], v[160:163], v[68:71]
    ds_read_b64_tr_b16 v[108:109], v175 offset:36864
    v_mfma_f32_16x16x32_bf16 v[88:91], v[128:131], v[164:167], v[88:91]
    ds_read_b64_tr_b16 v[110:111], v175 offset:38144
    v_mfma_f32_16x16x32_bf16 v[32:35], v[132:135], v[152:155], v[32:35]
    ds_read_b64_tr_b16 v[112:113], v176 offset:36864
    v_mfma_f32_16x16x32_bf16 v[52:55], v[132:135], v[156:159], v[52:55]
    ds_read_b64_tr_b16 v[114:115], v176 offset:38144
    v_mfma_f32_16x16x32_bf16 v[72:75], v[132:135], v[160:163], v[72:75]
    v_mfma_f32_16x16x32_bf16 v[92:95], v[132:135], v[164:167], v[92:95]
    s_waitcnt lgkmcnt(11)
    v_mfma_f32_16x16x32_bf16 v[16:19], v[96:99], v[136:139], v[16:19]
    ds_read_b64_tr_b16 v[116:117], v172 offset:47104
    s_waitcnt lgkmcnt(11)
    v_mfma_f32_16x16x32_bf16 v[36:39], v[96:99], v[140:143], v[36:39]
    ds_read_b64_tr_b16 v[118:119], v172 offset:48384
    s_waitcnt lgkmcnt(11)
    v_mfma_f32_16x16x32_bf16 v[56:59], v[96:99], v[144:147], v[56:59]
    ds_read_b128 v[152:155], v169 offset:36864
    s_waitcnt lgkmcnt(11)
    v_mfma_f32_16x16x32_bf16 v[76:79], v[96:99], v[148:151], v[76:79]
    ds_read_b128 v[156:159], v169 offset:38912
    s_waitcnt lgkmcnt(10)
    v_mfma_f32_16x16x32_bf16 v[20:23], v[100:103], v[136:139], v[20:23]
    ds_read_b128 v[160:163], v169 offset:40960
    v_mfma_f32_16x16x32_bf16 v[40:43], v[100:103], v[140:143], v[40:43]
    ds_read_b128 v[164:167], v169 offset:43008
    v_mfma_f32_16x16x32_bf16 v[60:63], v[100:103], v[144:147], v[60:63]
    ds_read_b64_tr_b16 v[120:121], v173 offset:47104
    v_mfma_f32_16x16x32_bf16 v[80:83], v[100:103], v[148:151], v[80:83]
    ds_read_b64_tr_b16 v[122:123], v173 offset:48384
    s_waitcnt lgkmcnt(12)
    v_mfma_f32_16x16x32_bf16 v[24:27], v[104:107], v[136:139], v[24:27]
    ds_read_b64_tr_b16 v[124:125], v174 offset:47104
    v_mfma_f32_16x16x32_bf16 v[44:47], v[104:107], v[140:143], v[44:47]
    ds_read_b64_tr_b16 v[126:127], v174 offset:48384
    v_mfma_f32_16x16x32_bf16 v[64:67], v[104:107], v[144:147], v[64:67]
    ds_read_b64_tr_b16 v[128:129], v175 offset:47104
    v_mfma_f32_16x16x32_bf16 v[84:87], v[104:107], v[148:151], v[84:87]
    ds_read_b64_tr_b16 v[130:131], v175 offset:48384
    s_waitcnt lgkmcnt(14)
    v_mfma_f32_16x16x32_bf16 v[28:31], v[108:111], v[136:139], v[28:31]
    ds_read_b64_tr_b16 v[132:133], v176 offset:47104
    v_mfma_f32_16x16x32_bf16 v[48:51], v[108:111], v[140:143], v[48:51]
    ds_read_b64_tr_b16 v[134:135], v176 offset:48384
    v_mfma_f32_16x16x32_bf16 v[68:71], v[108:111], v[144:147], v[68:71]
    ds_read_b64_tr_b16 v[200:201], v182 offset:8
    v_mfma_f32_16x16x32_bf16 v[88:91], v[108:111], v[148:151], v[88:91]
    ds_read_b64_tr_b16 v[202:203], v182 offset:168
    s_waitcnt lgkmcnt(15)
    v_mfma_f32_16x16x32_bf16 v[32:35], v[112:115], v[136:139], v[32:35]
    ds_read_b64_tr_b16 v[204:205], v182 offset:328
    v_mfma_f32_16x16x32_bf16 v[52:55], v[112:115], v[140:143], v[52:55]
    ds_read_b64_tr_b16 v[206:207], v182 offset:488
    v_mfma_f32_16x16x32_bf16 v[72:75], v[112:115], v[144:147], v[72:75]
    ds_read_b64_tr_b16 v[208:209], v182 offset:648
    v_mfma_f32_16x16x32_bf16 v[92:95], v[112:115], v[148:151], v[92:95]
    s_waitcnt lgkmcnt(15)
    v_mfma_f32_16x16x32_bf16 v[16:19], v[116:119], v[152:155], v[16:19]
    v_mfma_f32_16x16x32_bf16 v[36:39], v[116:119], v[156:159], v[36:39]
    s_waitcnt lgkmcnt(14)
    v_mfma_f32_16x16x32_bf16 v[56:59], v[116:119], v[160:163], v[56:59]
    s_waitcnt lgkmcnt(13)
    v_mfma_f32_16x16x32_bf16 v[76:79], v[116:119], v[164:167], v[76:79]
    s_waitcnt lgkmcnt(11)
    v_mfma_f32_16x16x32_bf16 v[20:23], v[120:123], v[152:155], v[20:23]
    s_waitcnt lgkmcnt(0)
    s_barrier
    ds_read_b64_tr_b16 v[96:97], v177 offset:0
    v_mfma_f32_16x16x32_bf16 v[40:43], v[120:123], v[156:159], v[40:43]
    ds_read_b64_tr_b16 v[98:99], v177 offset:1280
    v_mfma_f32_16x16x32_bf16 v[60:63], v[120:123], v[160:163], v[60:63]
    ds_read_b128 v[136:139], v170 offset:0
    v_mfma_f32_16x16x32_bf16 v[80:83], v[120:123], v[164:167], v[80:83]
    ds_read_b128 v[140:143], v170 offset:2048
    v_mfma_f32_16x16x32_bf16 v[24:27], v[124:127], v[152:155], v[24:27]
    ds_read_b128 v[144:147], v170 offset:4096
    v_mfma_f32_16x16x32_bf16 v[44:47], v[124:127], v[156:159], v[44:47]
    ds_read_b128 v[148:151], v170 offset:6144
    v_mfma_f32_16x16x32_bf16 v[64:67], v[124:127], v[160:163], v[64:67]
    ds_read_b64_tr_b16 v[100:101], v178 offset:0
    v_mfma_f32_16x16x32_bf16 v[84:87], v[124:127], v[164:167], v[84:87]
    ds_read_b64_tr_b16 v[102:103], v178 offset:1280
    v_mfma_f32_16x16x32_bf16 v[28:31], v[128:131], v[152:155], v[28:31]
    ds_read_b64_tr_b16 v[104:105], v179 offset:0
    v_mfma_f32_16x16x32_bf16 v[48:51], v[128:131], v[156:159], v[48:51]
    ds_read_b64_tr_b16 v[106:107], v179 offset:1280
    v_mfma_f32_16x16x32_bf16 v[68:71], v[128:131], v[160:163], v[68:71]
    ds_read_b64_tr_b16 v[108:109], v180 offset:0
    v_mfma_f32_16x16x32_bf16 v[88:91], v[128:131], v[164:167], v[88:91]
    ds_read_b64_tr_b16 v[110:111], v180 offset:1280
    v_mfma_f32_16x16x32_bf16 v[32:35], v[132:135], v[152:155], v[32:35]
    ds_read_b64_tr_b16 v[112:113], v181 offset:0
    v_mfma_f32_16x16x32_bf16 v[52:55], v[132:135], v[156:159], v[52:55]
    ds_read_b64_tr_b16 v[114:115], v181 offset:1280
    v_mfma_f32_16x16x32_bf16 v[72:75], v[132:135], v[160:163], v[72:75]
    v_mfma_f32_16x16x32_bf16 v[92:95], v[132:135], v[164:167], v[92:95]
    s_waitcnt lgkmcnt(11)
    v_mfma_f32_16x16x32_bf16 v[16:19], v[96:99], v[136:139], v[16:19]
    ds_read_b64_tr_b16 v[116:117], v177 offset:10240
    s_waitcnt lgkmcnt(11)
    v_mfma_f32_16x16x32_bf16 v[36:39], v[96:99], v[140:143], v[36:39]
    ds_read_b64_tr_b16 v[118:119], v177 offset:11520
    s_waitcnt lgkmcnt(11)
    v_mfma_f32_16x16x32_bf16 v[56:59], v[96:99], v[144:147], v[56:59]
    ds_read_b128 v[152:155], v171 offset:0
    s_waitcnt lgkmcnt(11)
    v_mfma_f32_16x16x32_bf16 v[76:79], v[96:99], v[148:151], v[76:79]
    ds_read_b128 v[156:159], v171 offset:2048
    s_waitcnt lgkmcnt(10)
    v_mfma_f32_16x16x32_bf16 v[20:23], v[100:103], v[136:139], v[20:23]
    ds_read_b128 v[160:163], v171 offset:4096
    v_mfma_f32_16x16x32_bf16 v[40:43], v[100:103], v[140:143], v[40:43]
    ds_read_b128 v[164:167], v171 offset:6144
    v_mfma_f32_16x16x32_bf16 v[60:63], v[100:103], v[144:147], v[60:63]
    ds_read_b64_tr_b16 v[120:121], v178 offset:10240
    v_mfma_f32_16x16x32_bf16 v[80:83], v[100:103], v[148:151], v[80:83]
    ds_read_b64_tr_b16 v[122:123], v178 offset:11520
    s_waitcnt lgkmcnt(12)
    v_mfma_f32_16x16x32_bf16 v[24:27], v[104:107], v[136:139], v[24:27]
    ds_read_b64_tr_b16 v[124:125], v179 offset:10240
    v_mfma_f32_16x16x32_bf16 v[44:47], v[104:107], v[140:143], v[44:47]
    ds_read_b64_tr_b16 v[126:127], v179 offset:11520
    v_mfma_f32_16x16x32_bf16 v[64:67], v[104:107], v[144:147], v[64:67]
    ds_read_b64_tr_b16 v[128:129], v180 offset:10240
    v_mfma_f32_16x16x32_bf16 v[84:87], v[104:107], v[148:151], v[84:87]
    ds_read_b64_tr_b16 v[130:131], v180 offset:11520
    s_waitcnt lgkmcnt(14)
    v_mfma_f32_16x16x32_bf16 v[28:31], v[108:111], v[136:139], v[28:31]
    ds_read_b64_tr_b16 v[132:133], v181 offset:10240
    v_mfma_f32_16x16x32_bf16 v[48:51], v[108:111], v[140:143], v[48:51]
    ds_read_b64_tr_b16 v[134:135], v181 offset:11520
    v_mfma_f32_16x16x32_bf16 v[68:71], v[108:111], v[144:147], v[68:71]
    ds_read_b64_tr_b16 v[212:213], v182 offset:16
    v_mfma_f32_16x16x32_bf16 v[88:91], v[108:111], v[148:151], v[88:91]
    ds_read_b64_tr_b16 v[214:215], v182 offset:176
    s_waitcnt lgkmcnt(15)
    v_mfma_f32_16x16x32_bf16 v[32:35], v[112:115], v[136:139], v[32:35]
    ds_read_b64_tr_b16 v[216:217], v182 offset:336
    v_mfma_f32_16x16x32_bf16 v[52:55], v[112:115], v[140:143], v[52:55]
    ds_read_b64_tr_b16 v[218:219], v182 offset:496
    v_mfma_f32_16x16x32_bf16 v[72:75], v[112:115], v[144:147], v[72:75]
    ds_read_b64_tr_b16 v[220:221], v182 offset:656
    v_mfma_f32_16x16x32_bf16 v[92:95], v[112:115], v[148:151], v[92:95]
    s_waitcnt lgkmcnt(15)
    v_mfma_f32_16x16x32_bf16 v[16:19], v[116:119], v[152:155], v[16:19]
    v_mfma_f32_16x16x32_bf16 v[36:39], v[116:119], v[156:159], v[36:39]
    s_waitcnt lgkmcnt(14)
    v_mfma_f32_16x16x32_bf16 v[56:59], v[116:119], v[160:163], v[56:59]
    s_waitcnt lgkmcnt(13)
    v_mfma_f32_16x16x32_bf16 v[76:79], v[116:119], v[164:167], v[76:79]
    s_waitcnt lgkmcnt(11)
    v_mfma_f32_16x16x32_bf16 v[20:23], v[120:123], v[152:155], v[20:23]
    s_waitcnt lgkmcnt(0)
    s_barrier
    ds_read_b64_tr_b16 v[96:97], v172 offset:0
    v_mfma_f32_16x16x32_bf16 v[40:43], v[120:123], v[156:159], v[40:43]
    ds_read_b64_tr_b16 v[98:99], v172 offset:1280
    v_mfma_f32_16x16x32_bf16 v[60:63], v[120:123], v[160:163], v[60:63]
    ds_read_b128 v[136:139], v168 offset:0
    v_mfma_f32_16x16x32_bf16 v[80:83], v[120:123], v[164:167], v[80:83]
    ds_read_b128 v[140:143], v168 offset:2048
    v_mfma_f32_16x16x32_bf16 v[24:27], v[124:127], v[152:155], v[24:27]
    ds_read_b128 v[144:147], v168 offset:4096
    v_mfma_f32_16x16x32_bf16 v[44:47], v[124:127], v[156:159], v[44:47]
    ds_read_b128 v[148:151], v168 offset:6144
    v_mfma_f32_16x16x32_bf16 v[64:67], v[124:127], v[160:163], v[64:67]
    ds_read_b64_tr_b16 v[100:101], v173 offset:0
    v_mfma_f32_16x16x32_bf16 v[84:87], v[124:127], v[164:167], v[84:87]
    ds_read_b64_tr_b16 v[102:103], v173 offset:1280
    v_mfma_f32_16x16x32_bf16 v[28:31], v[128:131], v[152:155], v[28:31]
    ds_read_b64_tr_b16 v[104:105], v174 offset:0
    v_mfma_f32_16x16x32_bf16 v[48:51], v[128:131], v[156:159], v[48:51]
    ds_read_b64_tr_b16 v[106:107], v174 offset:1280
    v_mfma_f32_16x16x32_bf16 v[68:71], v[128:131], v[160:163], v[68:71]
    ds_read_b64_tr_b16 v[108:109], v175 offset:0
    v_mfma_f32_16x16x32_bf16 v[88:91], v[128:131], v[164:167], v[88:91]
    ds_read_b64_tr_b16 v[110:111], v175 offset:1280
    v_mfma_f32_16x16x32_bf16 v[32:35], v[132:135], v[152:155], v[32:35]
    ds_read_b64_tr_b16 v[112:113], v176 offset:0
    v_mfma_f32_16x16x32_bf16 v[52:55], v[132:135], v[156:159], v[52:55]
    ds_read_b64_tr_b16 v[114:115], v176 offset:1280
    v_mfma_f32_16x16x32_bf16 v[72:75], v[132:135], v[160:163], v[72:75]
    v_mfma_f32_16x16x32_bf16 v[92:95], v[132:135], v[164:167], v[92:95]
    s_waitcnt lgkmcnt(11)
    v_mfma_f32_16x16x32_bf16 v[16:19], v[96:99], v[136:139], v[16:19]
    ds_read_b64_tr_b16 v[116:117], v172 offset:10240
    s_waitcnt lgkmcnt(11)
    v_mfma_f32_16x16x32_bf16 v[36:39], v[96:99], v[140:143], v[36:39]
    ds_read_b64_tr_b16 v[118:119], v172 offset:11520
    s_waitcnt lgkmcnt(11)
    v_mfma_f32_16x16x32_bf16 v[56:59], v[96:99], v[144:147], v[56:59]
    ds_read_b128 v[152:155], v169 offset:0
    s_waitcnt lgkmcnt(11)
    v_mfma_f32_16x16x32_bf16 v[76:79], v[96:99], v[148:151], v[76:79]
    ds_read_b128 v[156:159], v169 offset:2048
    s_waitcnt lgkmcnt(10)
    v_mfma_f32_16x16x32_bf16 v[20:23], v[100:103], v[136:139], v[20:23]
    ds_read_b128 v[160:163], v169 offset:4096
    v_mfma_f32_16x16x32_bf16 v[40:43], v[100:103], v[140:143], v[40:43]
    ds_read_b128 v[164:167], v169 offset:6144
    v_mfma_f32_16x16x32_bf16 v[60:63], v[100:103], v[144:147], v[60:63]
    ds_read_b64_tr_b16 v[120:121], v173 offset:10240
    v_mfma_f32_16x16x32_bf16 v[80:83], v[100:103], v[148:151], v[80:83]
    ds_read_b64_tr_b16 v[122:123], v173 offset:11520
    s_waitcnt lgkmcnt(12)
    v_mfma_f32_16x16x32_bf16 v[24:27], v[104:107], v[136:139], v[24:27]
    ds_read_b64_tr_b16 v[124:125], v174 offset:10240
    v_mfma_f32_16x16x32_bf16 v[44:47], v[104:107], v[140:143], v[44:47]
    ds_read_b64_tr_b16 v[126:127], v174 offset:11520
    v_mfma_f32_16x16x32_bf16 v[64:67], v[104:107], v[144:147], v[64:67]
    ds_read_b64_tr_b16 v[128:129], v175 offset:10240
    v_mfma_f32_16x16x32_bf16 v[84:87], v[104:107], v[148:151], v[84:87]
    ds_read_b64_tr_b16 v[130:131], v175 offset:11520
    s_waitcnt lgkmcnt(14)
    v_mfma_f32_16x16x32_bf16 v[28:31], v[108:111], v[136:139], v[28:31]
    ds_read_b64_tr_b16 v[132:133], v176 offset:10240
    v_mfma_f32_16x16x32_bf16 v[48:51], v[108:111], v[140:143], v[48:51]
    ds_read_b64_tr_b16 v[134:135], v176 offset:11520
    v_mfma_f32_16x16x32_bf16 v[68:71], v[108:111], v[144:147], v[68:71]
    ds_read_b64_tr_b16 v[224:225], v182 offset:24
    v_mfma_f32_16x16x32_bf16 v[88:91], v[108:111], v[148:151], v[88:91]
    ds_read_b64_tr_b16 v[226:227], v182 offset:184
    s_waitcnt lgkmcnt(15)
    v_mfma_f32_16x16x32_bf16 v[32:35], v[112:115], v[136:139], v[32:35]
    ds_read_b64_tr_b16 v[228:229], v182 offset:344
    v_mfma_f32_16x16x32_bf16 v[52:55], v[112:115], v[140:143], v[52:55]
    ds_read_b64_tr_b16 v[230:231], v182 offset:504
    v_mfma_f32_16x16x32_bf16 v[72:75], v[112:115], v[144:147], v[72:75]
    ds_read_b64_tr_b16 v[232:233], v182 offset:664
    v_mfma_f32_16x16x32_bf16 v[92:95], v[112:115], v[148:151], v[92:95]
    s_waitcnt lgkmcnt(15)
    v_mfma_f32_16x16x32_bf16 v[16:19], v[116:119], v[152:155], v[16:19]
    v_mfma_f32_16x16x32_bf16 v[36:39], v[116:119], v[156:159], v[36:39]
    s_waitcnt lgkmcnt(14)
    v_mfma_f32_16x16x32_bf16 v[56:59], v[116:119], v[160:163], v[56:59]
    s_waitcnt lgkmcnt(13)
    v_mfma_f32_16x16x32_bf16 v[76:79], v[116:119], v[164:167], v[76:79]
    s_waitcnt lgkmcnt(11)
    v_mfma_f32_16x16x32_bf16 v[20:23], v[120:123], v[152:155], v[20:23]
    s_waitcnt lgkmcnt(0)
    s_barrier
    ds_read_b64_tr_b16 v[96:97], v172 offset:36864
    v_mfma_f32_16x16x32_bf16 v[40:43], v[120:123], v[156:159], v[40:43]
    ds_read_b64_tr_b16 v[98:99], v172 offset:38144
    v_mfma_f32_16x16x32_bf16 v[60:63], v[120:123], v[160:163], v[60:63]
    ds_read_b128 v[136:139], v168 offset:36864
    v_mfma_f32_16x16x32_bf16 v[80:83], v[120:123], v[164:167], v[80:83]
    ds_read_b128 v[140:143], v168 offset:38912
    v_mfma_f32_16x16x32_bf16 v[24:27], v[124:127], v[152:155], v[24:27]
    ds_read_b128 v[144:147], v168 offset:40960
    v_mfma_f32_16x16x32_bf16 v[44:47], v[124:127], v[156:159], v[44:47]
    ds_read_b128 v[148:151], v168 offset:43008
    v_mfma_f32_16x16x32_bf16 v[64:67], v[124:127], v[160:163], v[64:67]
    ds_read_b64_tr_b16 v[100:101], v173 offset:36864
    v_mfma_f32_16x16x32_bf16 v[84:87], v[124:127], v[164:167], v[84:87]
    ds_read_b64_tr_b16 v[102:103], v173 offset:38144
    v_mfma_f32_16x16x32_bf16 v[28:31], v[128:131], v[152:155], v[28:31]
    ds_read_b64_tr_b16 v[104:105], v174 offset:36864
    v_mfma_f32_16x16x32_bf16 v[48:51], v[128:131], v[156:159], v[48:51]
    ds_read_b64_tr_b16 v[106:107], v174 offset:38144
    v_mfma_f32_16x16x32_bf16 v[68:71], v[128:131], v[160:163], v[68:71]
    ds_read_b64_tr_b16 v[108:109], v175 offset:36864
    v_mfma_f32_16x16x32_bf16 v[88:91], v[128:131], v[164:167], v[88:91]
    ds_read_b64_tr_b16 v[110:111], v175 offset:38144
    v_mfma_f32_16x16x32_bf16 v[32:35], v[132:135], v[152:155], v[32:35]
    ds_read_b64_tr_b16 v[112:113], v176 offset:36864
    v_mfma_f32_16x16x32_bf16 v[52:55], v[132:135], v[156:159], v[52:55]
    ds_read_b64_tr_b16 v[114:115], v176 offset:38144
    v_mfma_f32_16x16x32_bf16 v[72:75], v[132:135], v[160:163], v[72:75]
    v_mfma_f32_16x16x32_bf16 v[92:95], v[132:135], v[164:167], v[92:95]
    s_waitcnt lgkmcnt(11)
    v_mfma_f32_16x16x32_bf16 v[16:19], v[96:99], v[136:139], v[16:19]
    ds_read_b64_tr_b16 v[116:117], v172 offset:47104
    s_waitcnt lgkmcnt(11)
    v_mfma_f32_16x16x32_bf16 v[36:39], v[96:99], v[140:143], v[36:39]
    ds_read_b64_tr_b16 v[118:119], v172 offset:48384
    s_waitcnt lgkmcnt(11)
    v_mfma_f32_16x16x32_bf16 v[56:59], v[96:99], v[144:147], v[56:59]
    ds_read_b128 v[152:155], v169 offset:36864
    s_waitcnt lgkmcnt(11)
    v_mfma_f32_16x16x32_bf16 v[76:79], v[96:99], v[148:151], v[76:79]
    ds_read_b128 v[156:159], v169 offset:38912
    s_waitcnt lgkmcnt(10)
    v_mfma_f32_16x16x32_bf16 v[20:23], v[100:103], v[136:139], v[20:23]
    ds_read_b128 v[160:163], v169 offset:40960
    v_mfma_f32_16x16x32_bf16 v[40:43], v[100:103], v[140:143], v[40:43]
    ds_read_b128 v[164:167], v169 offset:43008
    v_mfma_f32_16x16x32_bf16 v[60:63], v[100:103], v[144:147], v[60:63]
    ds_read_b64_tr_b16 v[120:121], v173 offset:47104
    v_mfma_f32_16x16x32_bf16 v[80:83], v[100:103], v[148:151], v[80:83]
    ds_read_b64_tr_b16 v[122:123], v173 offset:48384
    s_waitcnt lgkmcnt(12)
    v_mfma_f32_16x16x32_bf16 v[24:27], v[104:107], v[136:139], v[24:27]
    ds_read_b64_tr_b16 v[124:125], v174 offset:47104
    v_mfma_f32_16x16x32_bf16 v[44:47], v[104:107], v[140:143], v[44:47]
    ds_read_b64_tr_b16 v[126:127], v174 offset:48384
    v_mfma_f32_16x16x32_bf16 v[64:67], v[104:107], v[144:147], v[64:67]
    ds_read_b64_tr_b16 v[128:129], v175 offset:47104
    v_mfma_f32_16x16x32_bf16 v[84:87], v[104:107], v[148:151], v[84:87]
    ds_read_b64_tr_b16 v[130:131], v175 offset:48384
    s_waitcnt lgkmcnt(14)
    v_mfma_f32_16x16x32_bf16 v[28:31], v[108:111], v[136:139], v[28:31]
    ds_read_b64_tr_b16 v[132:133], v176 offset:47104
    v_mfma_f32_16x16x32_bf16 v[48:51], v[108:111], v[140:143], v[48:51]
    ds_read_b64_tr_b16 v[134:135], v176 offset:48384
    v_mfma_f32_16x16x32_bf16 v[68:71], v[108:111], v[144:147], v[68:71]
    ds_read_b64_tr_b16 v[236:237], v182 offset:32
    v_mfma_f32_16x16x32_bf16 v[88:91], v[108:111], v[148:151], v[88:91]
    ds_read_b64_tr_b16 v[238:239], v182 offset:192
    s_waitcnt lgkmcnt(15)
    v_mfma_f32_16x16x32_bf16 v[32:35], v[112:115], v[136:139], v[32:35]
    ds_read_b64_tr_b16 v[240:241], v182 offset:352
    v_mfma_f32_16x16x32_bf16 v[52:55], v[112:115], v[140:143], v[52:55]
    ds_read_b64_tr_b16 v[242:243], v182 offset:512
    v_mfma_f32_16x16x32_bf16 v[72:75], v[112:115], v[144:147], v[72:75]
    ds_read_b64_tr_b16 v[244:245], v182 offset:672
    v_mfma_f32_16x16x32_bf16 v[92:95], v[112:115], v[148:151], v[92:95]
    s_waitcnt lgkmcnt(15)
    v_mfma_f32_16x16x32_bf16 v[16:19], v[116:119], v[152:155], v[16:19]
    v_mfma_f32_16x16x32_bf16 v[36:39], v[116:119], v[156:159], v[36:39]
    s_waitcnt lgkmcnt(14)
    v_mfma_f32_16x16x32_bf16 v[56:59], v[116:119], v[160:163], v[56:59]
    s_waitcnt lgkmcnt(13)
    v_mfma_f32_16x16x32_bf16 v[76:79], v[116:119], v[164:167], v[76:79]
    s_waitcnt lgkmcnt(11)
    v_mfma_f32_16x16x32_bf16 v[20:23], v[120:123], v[152:155], v[20:23]
    s_waitcnt lgkmcnt(0)
    s_barrier
    ds_read_b64_tr_b16 v[96:97], v177 offset:0
    v_mfma_f32_16x16x32_bf16 v[40:43], v[120:123], v[156:159], v[40:43]
    ds_read_b64_tr_b16 v[98:99], v177 offset:1280
    v_mfma_f32_16x16x32_bf16 v[60:63], v[120:123], v[160:163], v[60:63]
    ds_read_b128 v[136:139], v170 offset:0
    v_mfma_f32_16x16x32_bf16 v[80:83], v[120:123], v[164:167], v[80:83]
    ds_read_b128 v[140:143], v170 offset:2048
    v_mfma_f32_16x16x32_bf16 v[24:27], v[124:127], v[152:155], v[24:27]
    ds_read_b128 v[144:147], v170 offset:4096
    v_mfma_f32_16x16x32_bf16 v[44:47], v[124:127], v[156:159], v[44:47]
    ds_read_b128 v[148:151], v170 offset:6144
    v_mfma_f32_16x16x32_bf16 v[64:67], v[124:127], v[160:163], v[64:67]
    ds_read_b64_tr_b16 v[100:101], v178 offset:0
    v_mfma_f32_16x16x32_bf16 v[84:87], v[124:127], v[164:167], v[84:87]
    ds_read_b64_tr_b16 v[102:103], v178 offset:1280
    v_mfma_f32_16x16x32_bf16 v[28:31], v[128:131], v[152:155], v[28:31]
    ds_read_b64_tr_b16 v[104:105], v179 offset:0
    v_mfma_f32_16x16x32_bf16 v[48:51], v[128:131], v[156:159], v[48:51]
    ds_read_b64_tr_b16 v[106:107], v179 offset:1280
    v_mfma_f32_16x16x32_bf16 v[68:71], v[128:131], v[160:163], v[68:71]
    ds_read_b64_tr_b16 v[108:109], v180 offset:0
    v_mfma_f32_16x16x32_bf16 v[88:91], v[128:131], v[164:167], v[88:91]
    ds_read_b64_tr_b16 v[110:111], v180 offset:1280
    v_mfma_f32_16x16x32_bf16 v[32:35], v[132:135], v[152:155], v[32:35]
    ds_read_b64_tr_b16 v[112:113], v181 offset:0
    v_mfma_f32_16x16x32_bf16 v[52:55], v[132:135], v[156:159], v[52:55]
    ds_read_b64_tr_b16 v[114:115], v181 offset:1280
    v_mfma_f32_16x16x32_bf16 v[72:75], v[132:135], v[160:163], v[72:75]
    v_mfma_f32_16x16x32_bf16 v[92:95], v[132:135], v[164:167], v[92:95]
    s_waitcnt lgkmcnt(11)
    v_mfma_f32_16x16x32_bf16 v[16:19], v[96:99], v[136:139], v[16:19]
    ds_read_b64_tr_b16 v[116:117], v177 offset:10240
    s_waitcnt lgkmcnt(11)
    v_mfma_f32_16x16x32_bf16 v[36:39], v[96:99], v[140:143], v[36:39]
    ds_read_b64_tr_b16 v[118:119], v177 offset:11520
    s_waitcnt lgkmcnt(11)
    v_mfma_f32_16x16x32_bf16 v[56:59], v[96:99], v[144:147], v[56:59]
    ds_read_b128 v[152:155], v171 offset:0
    s_waitcnt lgkmcnt(11)
    v_mfma_f32_16x16x32_bf16 v[76:79], v[96:99], v[148:151], v[76:79]
    ds_read_b128 v[156:159], v171 offset:2048
    s_waitcnt lgkmcnt(10)
    v_mfma_f32_16x16x32_bf16 v[20:23], v[100:103], v[136:139], v[20:23]
    ds_read_b128 v[160:163], v171 offset:4096
    v_mfma_f32_16x16x32_bf16 v[40:43], v[100:103], v[140:143], v[40:43]
    ds_read_b128 v[164:167], v171 offset:6144
    v_mfma_f32_16x16x32_bf16 v[60:63], v[100:103], v[144:147], v[60:63]
    ds_read_b64_tr_b16 v[120:121], v178 offset:10240
    v_mfma_f32_16x16x32_bf16 v[80:83], v[100:103], v[148:151], v[80:83]
    ds_read_b64_tr_b16 v[122:123], v178 offset:11520
    s_waitcnt lgkmcnt(12)
    v_mfma_f32_16x16x32_bf16 v[24:27], v[104:107], v[136:139], v[24:27]
    ds_read_b64_tr_b16 v[124:125], v179 offset:10240
    v_mfma_f32_16x16x32_bf16 v[44:47], v[104:107], v[140:143], v[44:47]
    ds_read_b64_tr_b16 v[126:127], v179 offset:11520
    v_mfma_f32_16x16x32_bf16 v[64:67], v[104:107], v[144:147], v[64:67]
    ds_read_b64_tr_b16 v[128:129], v180 offset:10240
    v_mfma_f32_16x16x32_bf16 v[84:87], v[104:107], v[148:151], v[84:87]
    ds_read_b64_tr_b16 v[130:131], v180 offset:11520
    s_waitcnt lgkmcnt(14)
    v_mfma_f32_16x16x32_bf16 v[28:31], v[108:111], v[136:139], v[28:31]
    ds_read_b64_tr_b16 v[132:133], v181 offset:10240
    v_mfma_f32_16x16x32_bf16 v[48:51], v[108:111], v[140:143], v[48:51]
    ds_read_b64_tr_b16 v[134:135], v181 offset:11520
    v_mfma_f32_16x16x32_bf16 v[68:71], v[108:111], v[144:147], v[68:71]
    v_mfma_f32_16x16x32_bf16 v[88:91], v[108:111], v[148:151], v[88:91]
    s_waitcnt lgkmcnt(14)
    v_mfma_f32_16x16x32_bf16 v[32:35], v[112:115], v[136:139], v[32:35]
    v_mfma_f32_16x16x32_bf16 v[52:55], v[112:115], v[140:143], v[52:55]
    v_mfma_f32_16x16x32_bf16 v[72:75], v[112:115], v[144:147], v[72:75]
    v_mfma_f32_16x16x32_bf16 v[92:95], v[112:115], v[148:151], v[92:95]
    s_waitcnt lgkmcnt(11)
    v_mfma_f32_16x16x32_bf16 v[16:19], v[116:119], v[152:155], v[16:19]
    s_waitcnt lgkmcnt(10)
    v_mfma_f32_16x16x32_bf16 v[36:39], v[116:119], v[156:159], v[36:39]
    s_waitcnt lgkmcnt(9)
    v_mfma_f32_16x16x32_bf16 v[56:59], v[116:119], v[160:163], v[56:59]
    s_waitcnt lgkmcnt(8)
    v_mfma_f32_16x16x32_bf16 v[76:79], v[116:119], v[164:167], v[76:79]
    s_waitcnt lgkmcnt(6)
    v_mfma_f32_16x16x32_bf16 v[20:23], v[120:123], v[152:155], v[20:23]
    s_waitcnt lgkmcnt(0)
    s_barrier
    ds_read_b64_tr_b16 v[96:97], v172 offset:0
    v_mfma_f32_16x16x32_bf16 v[40:43], v[120:123], v[156:159], v[40:43]
    ds_read_b64_tr_b16 v[98:99], v172 offset:1280
    v_mfma_f32_16x16x32_bf16 v[60:63], v[120:123], v[160:163], v[60:63]
    ds_read_b128 v[136:139], v168 offset:0
    v_mfma_f32_16x16x32_bf16 v[80:83], v[120:123], v[164:167], v[80:83]
    ds_read_b128 v[140:143], v168 offset:2048
    v_mfma_f32_16x16x32_bf16 v[24:27], v[124:127], v[152:155], v[24:27]
    ds_read_b128 v[144:147], v168 offset:4096
    v_mfma_f32_16x16x32_bf16 v[44:47], v[124:127], v[156:159], v[44:47]
    ds_read_b128 v[148:151], v168 offset:6144
    v_mfma_f32_16x16x32_bf16 v[64:67], v[124:127], v[160:163], v[64:67]
    ds_read_b64_tr_b16 v[100:101], v173 offset:0
    v_mfma_f32_16x16x32_bf16 v[84:87], v[124:127], v[164:167], v[84:87]
    ds_read_b64_tr_b16 v[102:103], v173 offset:1280
    v_mfma_f32_16x16x32_bf16 v[28:31], v[128:131], v[152:155], v[28:31]
    ds_read_b64_tr_b16 v[104:105], v174 offset:0
    v_mfma_f32_16x16x32_bf16 v[48:51], v[128:131], v[156:159], v[48:51]
    ds_read_b64_tr_b16 v[106:107], v174 offset:1280
    v_mfma_f32_16x16x32_bf16 v[68:71], v[128:131], v[160:163], v[68:71]
    ds_read_b64_tr_b16 v[108:109], v175 offset:0
    v_mfma_f32_16x16x32_bf16 v[88:91], v[128:131], v[164:167], v[88:91]
    ds_read_b64_tr_b16 v[110:111], v175 offset:1280
    v_mfma_f32_16x16x32_bf16 v[32:35], v[132:135], v[152:155], v[32:35]
    ds_read_b64_tr_b16 v[112:113], v176 offset:0
    v_mfma_f32_16x16x32_bf16 v[52:55], v[132:135], v[156:159], v[52:55]
    ds_read_b64_tr_b16 v[114:115], v176 offset:1280
    v_mfma_f32_16x16x32_bf16 v[72:75], v[132:135], v[160:163], v[72:75]
    v_mfma_f32_16x16x32_bf16 v[92:95], v[132:135], v[164:167], v[92:95]
    s_waitcnt lgkmcnt(11)
    v_mfma_f32_16x16x32_bf16 v[16:19], v[96:99], v[136:139], v[16:19]
    ds_read_b64_tr_b16 v[116:117], v172 offset:10240
    s_waitcnt lgkmcnt(11)
    v_mfma_f32_16x16x32_bf16 v[36:39], v[96:99], v[140:143], v[36:39]
    ds_read_b64_tr_b16 v[118:119], v172 offset:11520
    s_waitcnt lgkmcnt(11)
    v_mfma_f32_16x16x32_bf16 v[56:59], v[96:99], v[144:147], v[56:59]
    ds_read_b128 v[152:155], v169 offset:0
    s_waitcnt lgkmcnt(11)
    v_mfma_f32_16x16x32_bf16 v[76:79], v[96:99], v[148:151], v[76:79]
    ds_read_b128 v[156:159], v169 offset:2048
    s_waitcnt lgkmcnt(10)
    v_mfma_f32_16x16x32_bf16 v[20:23], v[100:103], v[136:139], v[20:23]
    ds_read_b128 v[160:163], v169 offset:4096
    v_mfma_f32_16x16x32_bf16 v[40:43], v[100:103], v[140:143], v[40:43]
    ds_read_b128 v[164:167], v169 offset:6144
    v_mfma_f32_16x16x32_bf16 v[60:63], v[100:103], v[144:147], v[60:63]
    ds_read_b64_tr_b16 v[120:121], v173 offset:10240
    v_mfma_f32_16x16x32_bf16 v[80:83], v[100:103], v[148:151], v[80:83]
    ds_read_b64_tr_b16 v[122:123], v173 offset:11520
    s_waitcnt lgkmcnt(12)
    v_mfma_f32_16x16x32_bf16 v[24:27], v[104:107], v[136:139], v[24:27]
    ds_read_b64_tr_b16 v[124:125], v174 offset:10240
    v_mfma_f32_16x16x32_bf16 v[44:47], v[104:107], v[140:143], v[44:47]
    ds_read_b64_tr_b16 v[126:127], v174 offset:11520
    v_mfma_f32_16x16x32_bf16 v[64:67], v[104:107], v[144:147], v[64:67]
    ds_read_b64_tr_b16 v[128:129], v175 offset:10240
    v_mfma_f32_16x16x32_bf16 v[84:87], v[104:107], v[148:151], v[84:87]
    ds_read_b64_tr_b16 v[130:131], v175 offset:11520
    s_waitcnt lgkmcnt(14)
    v_mfma_f32_16x16x32_bf16 v[28:31], v[108:111], v[136:139], v[28:31]
    ds_read_b64_tr_b16 v[132:133], v176 offset:10240
    v_mfma_f32_16x16x32_bf16 v[48:51], v[108:111], v[140:143], v[48:51]
    ds_read_b64_tr_b16 v[134:135], v176 offset:11520
    v_mfma_f32_16x16x32_bf16 v[68:71], v[108:111], v[144:147], v[68:71]
    v_mfma_f32_16x16x32_bf16 v[88:91], v[108:111], v[148:151], v[88:91]
    s_waitcnt lgkmcnt(14)
    v_mfma_f32_16x16x32_bf16 v[32:35], v[112:115], v[136:139], v[32:35]
    v_mfma_f32_16x16x32_bf16 v[52:55], v[112:115], v[140:143], v[52:55]
    v_mfma_f32_16x16x32_bf16 v[72:75], v[112:115], v[144:147], v[72:75]
    v_mfma_f32_16x16x32_bf16 v[92:95], v[112:115], v[148:151], v[92:95]
    s_waitcnt lgkmcnt(11)
    v_mfma_f32_16x16x32_bf16 v[16:19], v[116:119], v[152:155], v[16:19]
    s_waitcnt lgkmcnt(10)
    v_mfma_f32_16x16x32_bf16 v[36:39], v[116:119], v[156:159], v[36:39]
    s_waitcnt lgkmcnt(9)
    v_mfma_f32_16x16x32_bf16 v[56:59], v[116:119], v[160:163], v[56:59]
    s_waitcnt lgkmcnt(8)
    v_mfma_f32_16x16x32_bf16 v[76:79], v[116:119], v[164:167], v[76:79]
    s_waitcnt lgkmcnt(6)
    v_mfma_f32_16x16x32_bf16 v[20:23], v[120:123], v[152:155], v[20:23]
    s_waitcnt lgkmcnt(0)
    s_barrier
    ds_read_b64_tr_b16 v[96:97], v172 offset:36864
    v_mfma_f32_16x16x32_bf16 v[40:43], v[120:123], v[156:159], v[40:43]
    ds_read_b64_tr_b16 v[98:99], v172 offset:38144
    v_mfma_f32_16x16x32_bf16 v[60:63], v[120:123], v[160:163], v[60:63]
    ds_read_b128 v[136:139], v168 offset:36864
    v_mfma_f32_16x16x32_bf16 v[80:83], v[120:123], v[164:167], v[80:83]
    ds_read_b128 v[140:143], v168 offset:38912
    v_mfma_f32_16x16x32_bf16 v[24:27], v[124:127], v[152:155], v[24:27]
    ds_read_b128 v[144:147], v168 offset:40960
    v_mfma_f32_16x16x32_bf16 v[44:47], v[124:127], v[156:159], v[44:47]
    ds_read_b128 v[148:151], v168 offset:43008
    v_mfma_f32_16x16x32_bf16 v[64:67], v[124:127], v[160:163], v[64:67]
    ds_read_b64_tr_b16 v[100:101], v173 offset:36864
    v_mfma_f32_16x16x32_bf16 v[84:87], v[124:127], v[164:167], v[84:87]
    ds_read_b64_tr_b16 v[102:103], v173 offset:38144
    v_mfma_f32_16x16x32_bf16 v[28:31], v[128:131], v[152:155], v[28:31]
    ds_read_b64_tr_b16 v[104:105], v174 offset:36864
    v_mfma_f32_16x16x32_bf16 v[48:51], v[128:131], v[156:159], v[48:51]
    ds_read_b64_tr_b16 v[106:107], v174 offset:38144
    v_mfma_f32_16x16x32_bf16 v[68:71], v[128:131], v[160:163], v[68:71]
    ds_read_b64_tr_b16 v[108:109], v175 offset:36864
    v_mfma_f32_16x16x32_bf16 v[88:91], v[128:131], v[164:167], v[88:91]
    ds_read_b64_tr_b16 v[110:111], v175 offset:38144
    v_mfma_f32_16x16x32_bf16 v[32:35], v[132:135], v[152:155], v[32:35]
    ds_read_b64_tr_b16 v[112:113], v176 offset:36864
    v_mfma_f32_16x16x32_bf16 v[52:55], v[132:135], v[156:159], v[52:55]
    ds_read_b64_tr_b16 v[114:115], v176 offset:38144
    v_mfma_f32_16x16x32_bf16 v[72:75], v[132:135], v[160:163], v[72:75]
    v_mfma_f32_16x16x32_bf16 v[92:95], v[132:135], v[164:167], v[92:95]
    s_waitcnt lgkmcnt(11)
    v_mfma_f32_16x16x32_bf16 v[16:19], v[96:99], v[136:139], v[16:19]
    ds_read_b64_tr_b16 v[116:117], v172 offset:47104
    s_waitcnt lgkmcnt(11)
    v_mfma_f32_16x16x32_bf16 v[36:39], v[96:99], v[140:143], v[36:39]
    ds_read_b64_tr_b16 v[118:119], v172 offset:48384
    s_waitcnt lgkmcnt(11)
    v_mfma_f32_16x16x32_bf16 v[56:59], v[96:99], v[144:147], v[56:59]
    ds_read_b128 v[152:155], v169 offset:36864
    s_waitcnt lgkmcnt(11)
    v_mfma_f32_16x16x32_bf16 v[76:79], v[96:99], v[148:151], v[76:79]
    ds_read_b128 v[156:159], v169 offset:38912
    s_waitcnt lgkmcnt(10)
    v_mfma_f32_16x16x32_bf16 v[20:23], v[100:103], v[136:139], v[20:23]
    ds_read_b128 v[160:163], v169 offset:40960
    v_mfma_f32_16x16x32_bf16 v[40:43], v[100:103], v[140:143], v[40:43]
    ds_read_b128 v[164:167], v169 offset:43008
    v_mfma_f32_16x16x32_bf16 v[60:63], v[100:103], v[144:147], v[60:63]
    ds_read_b64_tr_b16 v[120:121], v173 offset:47104
    v_mfma_f32_16x16x32_bf16 v[80:83], v[100:103], v[148:151], v[80:83]
    ds_read_b64_tr_b16 v[122:123], v173 offset:48384
    s_waitcnt lgkmcnt(12)
    v_mfma_f32_16x16x32_bf16 v[24:27], v[104:107], v[136:139], v[24:27]
    ds_read_b64_tr_b16 v[124:125], v174 offset:47104
    v_mfma_f32_16x16x32_bf16 v[44:47], v[104:107], v[140:143], v[44:47]
    ds_read_b64_tr_b16 v[126:127], v174 offset:48384
    v_mfma_f32_16x16x32_bf16 v[64:67], v[104:107], v[144:147], v[64:67]
    ds_read_b64_tr_b16 v[128:129], v175 offset:47104
    v_mfma_f32_16x16x32_bf16 v[84:87], v[104:107], v[148:151], v[84:87]
    ds_read_b64_tr_b16 v[130:131], v175 offset:48384
    s_waitcnt lgkmcnt(14)
    v_mfma_f32_16x16x32_bf16 v[28:31], v[108:111], v[136:139], v[28:31]
    ds_read_b64_tr_b16 v[132:133], v176 offset:47104
    v_mfma_f32_16x16x32_bf16 v[48:51], v[108:111], v[140:143], v[48:51]
    ds_read_b64_tr_b16 v[134:135], v176 offset:48384
    v_mfma_f32_16x16x32_bf16 v[68:71], v[108:111], v[144:147], v[68:71]
    v_mfma_f32_16x16x32_bf16 v[88:91], v[108:111], v[148:151], v[88:91]
    s_waitcnt lgkmcnt(14)
    v_mfma_f32_16x16x32_bf16 v[32:35], v[112:115], v[136:139], v[32:35]
    v_mfma_f32_16x16x32_bf16 v[52:55], v[112:115], v[140:143], v[52:55]
    v_mfma_f32_16x16x32_bf16 v[72:75], v[112:115], v[144:147], v[72:75]
    v_mfma_f32_16x16x32_bf16 v[92:95], v[112:115], v[148:151], v[92:95]
    s_waitcnt lgkmcnt(11)
    v_mfma_f32_16x16x32_bf16 v[16:19], v[116:119], v[152:155], v[16:19]
    s_waitcnt lgkmcnt(10)
    v_mfma_f32_16x16x32_bf16 v[36:39], v[116:119], v[156:159], v[36:39]
    s_waitcnt lgkmcnt(9)
    v_mfma_f32_16x16x32_bf16 v[56:59], v[116:119], v[160:163], v[56:59]
    s_waitcnt lgkmcnt(8)
    v_mfma_f32_16x16x32_bf16 v[76:79], v[116:119], v[164:167], v[76:79]
    s_waitcnt lgkmcnt(6)
    v_mfma_f32_16x16x32_bf16 v[20:23], v[120:123], v[152:155], v[20:23]
    s_waitcnt lgkmcnt(0)
    s_barrier
    ds_read_b64_tr_b16 v[96:97], v177 offset:0
    v_mfma_f32_16x16x32_bf16 v[40:43], v[120:123], v[156:159], v[40:43]
    ds_read_b64_tr_b16 v[98:99], v177 offset:1280
    v_mfma_f32_16x16x32_bf16 v[60:63], v[120:123], v[160:163], v[60:63]
    ds_read_b128 v[136:139], v170 offset:0
    v_mfma_f32_16x16x32_bf16 v[80:83], v[120:123], v[164:167], v[80:83]
    ds_read_b128 v[140:143], v170 offset:2048
    v_mfma_f32_16x16x32_bf16 v[24:27], v[124:127], v[152:155], v[24:27]
    ds_read_b128 v[144:147], v170 offset:4096
    v_mfma_f32_16x16x32_bf16 v[44:47], v[124:127], v[156:159], v[44:47]
    ds_read_b128 v[148:151], v170 offset:6144
    v_mfma_f32_16x16x32_bf16 v[64:67], v[124:127], v[160:163], v[64:67]
    ds_read_b64_tr_b16 v[100:101], v178 offset:0
    v_mfma_f32_16x16x32_bf16 v[84:87], v[124:127], v[164:167], v[84:87]
    ds_read_b64_tr_b16 v[102:103], v178 offset:1280
    v_mfma_f32_16x16x32_bf16 v[28:31], v[128:131], v[152:155], v[28:31]
    ds_read_b64_tr_b16 v[104:105], v179 offset:0
    v_mfma_f32_16x16x32_bf16 v[48:51], v[128:131], v[156:159], v[48:51]
    ds_read_b64_tr_b16 v[106:107], v179 offset:1280
    v_mfma_f32_16x16x32_bf16 v[68:71], v[128:131], v[160:163], v[68:71]
    ds_read_b64_tr_b16 v[108:109], v180 offset:0
    v_mfma_f32_16x16x32_bf16 v[88:91], v[128:131], v[164:167], v[88:91]
    ds_read_b64_tr_b16 v[110:111], v180 offset:1280
    v_mfma_f32_16x16x32_bf16 v[32:35], v[132:135], v[152:155], v[32:35]
    ds_read_b64_tr_b16 v[112:113], v181 offset:0
    v_mfma_f32_16x16x32_bf16 v[52:55], v[132:135], v[156:159], v[52:55]
    ds_read_b64_tr_b16 v[114:115], v181 offset:1280
    v_mfma_f32_16x16x32_bf16 v[72:75], v[132:135], v[160:163], v[72:75]
    v_mfma_f32_16x16x32_bf16 v[92:95], v[132:135], v[164:167], v[92:95]
    s_waitcnt lgkmcnt(11)
    v_mfma_f32_16x16x32_bf16 v[16:19], v[96:99], v[136:139], v[16:19]
    ds_read_b64_tr_b16 v[116:117], v177 offset:10240
    s_waitcnt lgkmcnt(11)
    v_mfma_f32_16x16x32_bf16 v[36:39], v[96:99], v[140:143], v[36:39]
    ds_read_b64_tr_b16 v[118:119], v177 offset:11520
    s_waitcnt lgkmcnt(11)
    v_mfma_f32_16x16x32_bf16 v[56:59], v[96:99], v[144:147], v[56:59]
    ds_read_b128 v[152:155], v171 offset:0
    s_waitcnt lgkmcnt(11)
    v_mfma_f32_16x16x32_bf16 v[76:79], v[96:99], v[148:151], v[76:79]
    ds_read_b128 v[156:159], v171 offset:2048
    s_waitcnt lgkmcnt(10)
    v_mfma_f32_16x16x32_bf16 v[20:23], v[100:103], v[136:139], v[20:23]
    ds_read_b128 v[160:163], v171 offset:4096
    v_mfma_f32_16x16x32_bf16 v[40:43], v[100:103], v[140:143], v[40:43]
    ds_read_b128 v[164:167], v171 offset:6144
    v_mfma_f32_16x16x32_bf16 v[60:63], v[100:103], v[144:147], v[60:63]
    ds_read_b64_tr_b16 v[120:121], v178 offset:10240
    v_mfma_f32_16x16x32_bf16 v[80:83], v[100:103], v[148:151], v[80:83]
    ds_read_b64_tr_b16 v[122:123], v178 offset:11520
    s_waitcnt lgkmcnt(12)
    v_mfma_f32_16x16x32_bf16 v[24:27], v[104:107], v[136:139], v[24:27]
    ds_read_b64_tr_b16 v[124:125], v179 offset:10240
    v_mfma_f32_16x16x32_bf16 v[44:47], v[104:107], v[140:143], v[44:47]
    ds_read_b64_tr_b16 v[126:127], v179 offset:11520
    v_mfma_f32_16x16x32_bf16 v[64:67], v[104:107], v[144:147], v[64:67]
    ds_read_b64_tr_b16 v[128:129], v180 offset:10240
    v_mfma_f32_16x16x32_bf16 v[84:87], v[104:107], v[148:151], v[84:87]
    ds_read_b64_tr_b16 v[130:131], v180 offset:11520
    s_waitcnt lgkmcnt(14)
    v_mfma_f32_16x16x32_bf16 v[28:31], v[108:111], v[136:139], v[28:31]
    ds_read_b64_tr_b16 v[132:133], v181 offset:10240
    v_mfma_f32_16x16x32_bf16 v[48:51], v[108:111], v[140:143], v[48:51]
    ds_read_b64_tr_b16 v[134:135], v181 offset:11520
    v_mfma_f32_16x16x32_bf16 v[68:71], v[108:111], v[144:147], v[68:71]
    v_mfma_f32_16x16x32_bf16 v[88:91], v[108:111], v[148:151], v[88:91]
    s_waitcnt lgkmcnt(14)
    v_mfma_f32_16x16x32_bf16 v[32:35], v[112:115], v[136:139], v[32:35]
    v_mfma_f32_16x16x32_bf16 v[52:55], v[112:115], v[140:143], v[52:55]
    v_mfma_f32_16x16x32_bf16 v[72:75], v[112:115], v[144:147], v[72:75]
    v_mfma_f32_16x16x32_bf16 v[92:95], v[112:115], v[148:151], v[92:95]
    s_waitcnt lgkmcnt(11)
    v_mfma_f32_16x16x32_bf16 v[16:19], v[116:119], v[152:155], v[16:19]
    s_waitcnt lgkmcnt(10)
    v_mfma_f32_16x16x32_bf16 v[36:39], v[116:119], v[156:159], v[36:39]
    s_waitcnt lgkmcnt(9)
    v_mfma_f32_16x16x32_bf16 v[56:59], v[116:119], v[160:163], v[56:59]
    s_waitcnt lgkmcnt(8)
    v_mfma_f32_16x16x32_bf16 v[76:79], v[116:119], v[164:167], v[76:79]
    s_waitcnt lgkmcnt(6)
    v_mfma_f32_16x16x32_bf16 v[20:23], v[120:123], v[152:155], v[20:23]
    s_waitcnt lgkmcnt(0)
    s_barrier
    ds_read_b64_tr_b16 v[96:97], v172 offset:0
    v_mfma_f32_16x16x32_bf16 v[40:43], v[120:123], v[156:159], v[40:43]
    ds_read_b64_tr_b16 v[98:99], v172 offset:1280
    v_mfma_f32_16x16x32_bf16 v[60:63], v[120:123], v[160:163], v[60:63]
    ds_read_b128 v[136:139], v168 offset:0
    v_mfma_f32_16x16x32_bf16 v[80:83], v[120:123], v[164:167], v[80:83]
    ds_read_b128 v[140:143], v168 offset:2048
    v_mfma_f32_16x16x32_bf16 v[24:27], v[124:127], v[152:155], v[24:27]
    ds_read_b128 v[144:147], v168 offset:4096
    v_mfma_f32_16x16x32_bf16 v[44:47], v[124:127], v[156:159], v[44:47]
    ds_read_b128 v[148:151], v168 offset:6144
    v_mfma_f32_16x16x32_bf16 v[64:67], v[124:127], v[160:163], v[64:67]
    ds_read_b64_tr_b16 v[100:101], v173 offset:0
    v_mfma_f32_16x16x32_bf16 v[84:87], v[124:127], v[164:167], v[84:87]
    ds_read_b64_tr_b16 v[102:103], v173 offset:1280
    v_mfma_f32_16x16x32_bf16 v[28:31], v[128:131], v[152:155], v[28:31]
    ds_read_b64_tr_b16 v[104:105], v174 offset:0
    v_mfma_f32_16x16x32_bf16 v[48:51], v[128:131], v[156:159], v[48:51]
    ds_read_b64_tr_b16 v[106:107], v174 offset:1280
    v_mfma_f32_16x16x32_bf16 v[68:71], v[128:131], v[160:163], v[68:71]
    ds_read_b64_tr_b16 v[108:109], v175 offset:0
    v_mfma_f32_16x16x32_bf16 v[88:91], v[128:131], v[164:167], v[88:91]
    ds_read_b64_tr_b16 v[110:111], v175 offset:1280
    v_mfma_f32_16x16x32_bf16 v[32:35], v[132:135], v[152:155], v[32:35]
    ds_read_b64_tr_b16 v[112:113], v176 offset:0
    v_mfma_f32_16x16x32_bf16 v[52:55], v[132:135], v[156:159], v[52:55]
    ds_read_b64_tr_b16 v[114:115], v176 offset:1280
    v_mfma_f32_16x16x32_bf16 v[72:75], v[132:135], v[160:163], v[72:75]
    v_mfma_f32_16x16x32_bf16 v[92:95], v[132:135], v[164:167], v[92:95]
    s_waitcnt lgkmcnt(11)
    v_mfma_f32_16x16x32_bf16 v[16:19], v[96:99], v[136:139], v[16:19]
    ds_read_b64_tr_b16 v[116:117], v172 offset:10240
    s_waitcnt lgkmcnt(11)
    v_mfma_f32_16x16x32_bf16 v[36:39], v[96:99], v[140:143], v[36:39]
    ds_read_b64_tr_b16 v[118:119], v172 offset:11520
    s_waitcnt lgkmcnt(11)
    v_mfma_f32_16x16x32_bf16 v[56:59], v[96:99], v[144:147], v[56:59]
    ds_read_b128 v[152:155], v169 offset:0
    s_waitcnt lgkmcnt(11)
    v_mfma_f32_16x16x32_bf16 v[76:79], v[96:99], v[148:151], v[76:79]
    ds_read_b128 v[156:159], v169 offset:2048
    s_waitcnt lgkmcnt(10)
    v_mfma_f32_16x16x32_bf16 v[20:23], v[100:103], v[136:139], v[20:23]
    ds_read_b128 v[160:163], v169 offset:4096
    v_mfma_f32_16x16x32_bf16 v[40:43], v[100:103], v[140:143], v[40:43]
    ds_read_b128 v[164:167], v169 offset:6144
    v_mfma_f32_16x16x32_bf16 v[60:63], v[100:103], v[144:147], v[60:63]
    ds_read_b64_tr_b16 v[120:121], v173 offset:10240
    v_mfma_f32_16x16x32_bf16 v[80:83], v[100:103], v[148:151], v[80:83]
    ds_read_b64_tr_b16 v[122:123], v173 offset:11520
    s_waitcnt lgkmcnt(12)
    v_mfma_f32_16x16x32_bf16 v[24:27], v[104:107], v[136:139], v[24:27]
    ds_read_b64_tr_b16 v[124:125], v174 offset:10240
    v_mfma_f32_16x16x32_bf16 v[44:47], v[104:107], v[140:143], v[44:47]
    ds_read_b64_tr_b16 v[126:127], v174 offset:11520
    v_mfma_f32_16x16x32_bf16 v[64:67], v[104:107], v[144:147], v[64:67]
    ds_read_b64_tr_b16 v[128:129], v175 offset:10240
    v_mfma_f32_16x16x32_bf16 v[84:87], v[104:107], v[148:151], v[84:87]
    ds_read_b64_tr_b16 v[130:131], v175 offset:11520
    s_waitcnt lgkmcnt(14)
    v_mfma_f32_16x16x32_bf16 v[28:31], v[108:111], v[136:139], v[28:31]
    ds_read_b64_tr_b16 v[132:133], v176 offset:10240
    v_mfma_f32_16x16x32_bf16 v[48:51], v[108:111], v[140:143], v[48:51]
    ds_read_b64_tr_b16 v[134:135], v176 offset:11520
    v_mfma_f32_16x16x32_bf16 v[68:71], v[108:111], v[144:147], v[68:71]
    v_mfma_f32_16x16x32_bf16 v[88:91], v[108:111], v[148:151], v[88:91]
    s_waitcnt lgkmcnt(14)
    v_mfma_f32_16x16x32_bf16 v[32:35], v[112:115], v[136:139], v[32:35]
    v_mfma_f32_16x16x32_bf16 v[52:55], v[112:115], v[140:143], v[52:55]
    v_mfma_f32_16x16x32_bf16 v[72:75], v[112:115], v[144:147], v[72:75]
    v_mfma_f32_16x16x32_bf16 v[92:95], v[112:115], v[148:151], v[92:95]
    s_waitcnt lgkmcnt(11)
    v_mfma_f32_16x16x32_bf16 v[16:19], v[116:119], v[152:155], v[16:19]
    s_waitcnt lgkmcnt(6)
    v_mfma_f32_16x16x32_bf16 v[20:23], v[120:123], v[152:155], v[20:23]
    s_waitcnt lgkmcnt(4)
    v_mfma_f32_16x16x32_bf16 v[24:27], v[124:127], v[152:155], v[24:27]
    s_waitcnt lgkmcnt(2)
    v_mfma_f32_16x16x32_bf16 v[28:31], v[128:131], v[152:155], v[28:31]
    s_waitcnt lgkmcnt(0)
    v_mfma_f32_16x16x32_bf16 v[32:35], v[132:135], v[152:155], v[32:35]
    s_barrier
    v_mfma_f32_16x16x32_bf16 v[36:39], v[116:119], v[156:159], v[36:39]
    v_mfma_f32_16x16x32_bf16 v[40:43], v[120:123], v[156:159], v[40:43]
    v_mfma_f32_16x16x32_bf16 v[44:47], v[124:127], v[156:159], v[44:47]
    v_mfma_f32_16x16x32_bf16 v[48:51], v[128:131], v[156:159], v[48:51]
    v_mfma_f32_16x16x32_bf16 v[52:55], v[132:135], v[156:159], v[52:55]
    v_cvt_pk_bf16_f32 v96, v16, v17
    v_cvt_pk_bf16_f32 v97, v18, v19
    v_mfma_f32_16x16x32_bf16 v[56:59], v[116:119], v[160:163], v[56:59]
    v_cvt_pk_bf16_f32 v98, v20, v21
    v_cvt_pk_bf16_f32 v99, v22, v23
    v_mfma_f32_16x16x32_bf16 v[60:63], v[120:123], v[160:163], v[60:63]
    v_cvt_pk_bf16_f32 v100, v24, v25
    v_cvt_pk_bf16_f32 v101, v26, v27
    v_mfma_f32_16x16x32_bf16 v[64:67], v[124:127], v[160:163], v[64:67]
    v_cvt_pk_bf16_f32 v102, v28, v29
    v_cvt_pk_bf16_f32 v103, v30, v31
    v_mfma_f32_16x16x32_bf16 v[68:71], v[128:131], v[160:163], v[68:71]
    v_cvt_pk_bf16_f32 v104, v32, v33
    v_cvt_pk_bf16_f32 v105, v34, v35
    v_mfma_f32_16x16x32_bf16 v[72:75], v[132:135], v[160:163], v[72:75]
    v_cvt_pk_bf16_f32 v106, v36, v37
    v_cvt_pk_bf16_f32 v107, v38, v39
    v_mfma_f32_16x16x32_bf16 v[76:79], v[116:119], v[164:167], v[76:79]
    v_cvt_pk_bf16_f32 v108, v40, v41
    v_cvt_pk_bf16_f32 v109, v42, v43
    v_mfma_f32_16x16x32_bf16 v[80:83], v[120:123], v[164:167], v[80:83]
    v_cvt_pk_bf16_f32 v110, v44, v45
    v_cvt_pk_bf16_f32 v111, v46, v47
    v_mfma_f32_16x16x32_bf16 v[84:87], v[124:127], v[164:167], v[84:87]
    v_cvt_pk_bf16_f32 v112, v48, v49
    v_cvt_pk_bf16_f32 v113, v50, v51
    v_mfma_f32_16x16x32_bf16 v[88:91], v[128:131], v[164:167], v[88:91]
    v_cvt_pk_bf16_f32 v114, v52, v53
    v_cvt_pk_bf16_f32 v115, v54, v55
    v_mfma_f32_16x16x32_bf16 v[92:95], v[132:135], v[164:167], v[92:95]
    v_mov_b32 v116, 0x3f803f80
    v_mov_b32 v117, 0x3f803f80
    s_waitcnt vmcnt(0)
    s_load_dwordx2 s[30:31], s[26:27], 0
    s_cmp_eq_u32 s51, 0
    s_cbranch_scc0 L_q_29
    v_permlane32_swap_b32 v96, v106
    v_permlane32_swap_b32 v97, v107
    v_permlane32_swap_b32 v98, v108
    v_permlane32_swap_b32 v99, v109
    v_permlane32_swap_b32 v100, v110
    v_permlane32_swap_b32 v101, v111
    v_permlane32_swap_b32 v102, v112
    v_permlane32_swap_b32 v103, v113
    v_permlane32_swap_b32 v104, v114
    v_permlane32_swap_b32 v105, v115
    v_mfma_f32_16x16x32_bf16 v[16:19], v[188:191], v[96:99], 0
    v_cvt_pk_bf16_f32 v118, v56, v57
    v_cvt_pk_bf16_f32 v119, v58, v59
    v_mfma_f32_16x16x32_bf16 v[20:23], v[200:203], v[96:99], 0
    v_cvt_pk_bf16_f32 v120, v60, v61
    v_cvt_pk_bf16_f32 v121, v62, v63
    v_mfma_f32_16x16x32_bf16 v[24:27], v[212:215], v[96:99], 0
    v_cvt_pk_bf16_f32 v122, v64, v65
    v_cvt_pk_bf16_f32 v123, v66, v67
    v_mfma_f32_16x16x32_bf16 v[28:31], v[224:227], v[96:99], 0
    v_cvt_pk_bf16_f32 v124, v68, v69
    v_cvt_pk_bf16_f32 v125, v70, v71
    v_mfma_f32_16x16x32_bf16 v[32:35], v[236:239], v[96:99], 0
    v_cvt_pk_bf16_f32 v126, v72, v73
    v_cvt_pk_bf16_f32 v127, v74, v75
    v_mfma_f32_16x16x32_bf16 v[16:19], v[192:195], v[100:103], v[16:19]
    v_cvt_pk_bf16_f32 v128, v76, v77
    v_cvt_pk_bf16_f32 v129, v78, v79
    v_mfma_f32_16x16x32_bf16 v[20:23], v[204:207], v[100:103], v[20:23]
    v_cvt_pk_bf16_f32 v130, v80, v81
    v_cvt_pk_bf16_f32 v131, v82, v83
    v_mfma_f32_16x16x32_bf16 v[24:27], v[216:219], v[100:103], v[24:27]
    v_cvt_pk_bf16_f32 v132, v84, v85
    v_cvt_pk_bf16_f32 v133, v86, v87
    v_mfma_f32_16x16x32_bf16 v[28:31], v[228:231], v[100:103], v[28:31]
    v_cvt_pk_bf16_f32 v134, v88, v89
    v_cvt_pk_bf16_f32 v135, v90, v91
    v_mfma_f32_16x16x32_bf16 v[32:35], v[240:243], v[100:103], v[32:35]
    v_cvt_pk_bf16_f32 v136, v92, v93
    v_cvt_pk_bf16_f32 v137, v94, v95
    v_mfma_f32_16x16x32_bf16 v[16:19], v[196:199], v[104:107], v[16:19]
    v_mov_b32 v138, 0x3f803f80
    v_mov_b32 v139, 0x3f803f80
    v_mfma_f32_16x16x32_bf16 v[20:23], v[208:211], v[104:107], v[20:23]
    v_permlane32_swap_b32 v118, v128
    v_permlane32_swap_b32 v119, v129
    v_mfma_f32_16x16x32_bf16 v[24:27], v[220:223], v[104:107], v[24:27]
    v_permlane32_swap_b32 v120, v130
    v_permlane32_swap_b32 v121, v131
    v_mfma_f32_16x16x32_bf16 v[28:31], v[232:235], v[104:107], v[28:31]
    v_permlane32_swap_b32 v122, v132
    v_permlane32_swap_b32 v123, v133
    v_mfma_f32_16x16x32_bf16 v[32:35], v[244:247], v[104:107], v[32:35]
    v_permlane32_swap_b32 v124, v134
    v_permlane32_swap_b32 v125, v135
    v_permlane32_swap_b32 v126, v136
    v_permlane32_swap_b32 v127, v137
    v_mfma_f32_16x16x32_bf16 v[36:39], v[188:191], v[118:121], 0
    v_mfma_f32_16x16x32_bf16 v[40:43], v[200:203], v[118:121], 0
    v_mfma_f32_16x16x32_bf16 v[44:47], v[212:215], v[118:121], 0
    v_mfma_f32_16x16x32_bf16 v[48:51], v[224:227], v[118:121], 0
    v_mfma_f32_16x16x32_bf16 v[52:55], v[236:239], v[118:121], 0
    v_max3_f32 v248, v16, v17, v18
    v_min3_f32 v250, v16, v17, v18
    v_mfma_f32_16x16x32_bf16 v[36:39], v[192:195], v[122:125], v[36:39]
    v_max3_f32 v248, v248, v19, v20
    v_min3_f32 v250, v250, v19, v20
    v_mfma_f32_16x16x32_bf16 v[40:43], v[204:207], v[122:125], v[40:43]
    v_max3_f32 v248, v248, v21, v22
    v_min3_f32 v250, v250, v21, v22
    v_mfma_f32_16x16x32_bf16 v[44:47], v[216:219], v[122:125], v[44:47]
    v_max3_f32 v248, v248, v23, v24
    v_min3_f32 v250, v250, v23, v24
    v_mfma_f32_16x16x32_bf16 v[48:51], v[228:231], v[122:125], v[48:51]
    v_max3_f32 v248, v248, v25, v26
    v_min3_f32 v250, v250, v25, v26
    v_mfma_f32_16x16x32_bf16 v[52:55], v[240:243], v[122:125], v[52:55]
    v_max3_f32 v248, v248, v27, v28
    v_min3_f32 v250, v250, v27, v28
    v_mfma_f32_16x16x32_bf16 v[36:39], v[196:199], v[126:129], v[36:39]
    v_max3_f32 v248, v248, v29, v30
    v_min3_f32 v250, v250, v29, v30
    v_mfma_f32_16x16x32_bf16 v[40:43], v[208:211], v[126:129], v[40:43]
    v_max3_f32 v248, v248, v31, v32
    v_min3_f32 v250, v250, v31, v32
    v_mfma_f32_16x16x32_bf16 v[44:47], v[220:223], v[126:129], v[44:47]
    v_max3_f32 v248, v248, v33, v34
    v_min3_f32 v250, v250, v33, v34
    v_mfma_f32_16x16x32_bf16 v[48:51], v[232:235], v[126:129], v[48:51]
    v_max_f32 v248, v248, v35
    v_min_f32 v250, v250, v35
    v_mfma_f32_16x16x32_bf16 v[52:55], v[244:247], v[126:129], v[52:55]
    v_mul_f32 v248, s60, v248
    v_mul_f32_e64 v250, s60, v250
    v_pk_fma_f32 v[140:141], v[16:17], s[60:61], v[248:249] op_sel_hi:[1,1,0] neg_lo:[0,0,1] neg_hi:[0,0,1]
    v_pk_fma_f32 v[160:161], v[16:17], s[60:61], v[250:251] op_sel_hi:[1,1,0] neg_lo:[1,0,0] neg_hi:[1,0,0]
    v_pk_fma_f32 v[142:143], v[18:19], s[60:61], v[248:249] op_sel_hi:[1,1,0] neg_lo:[0,0,1] neg_hi:[0,0,1]
    v_pk_fma_f32 v[162:163], v[18:19], s[60:61], v[250:251] op_sel_hi:[1,1,0] neg_lo:[1,0,0] neg_hi:[1,0,0]
    v_exp_f32 v140, v140
    v_exp_f32 v160, v160
    v_pk_fma_f32 v[144:145], v[20:21], s[60:61], v[248:249] op_sel_hi:[1,1,0] neg_lo:[0,0,1] neg_hi:[0,0,1]
    v_exp_f32 v141, v141
    v_exp_f32 v161, v161
    v_pk_fma_f32 v[164:165], v[20:21], s[60:61], v[250:251] op_sel_hi:[1,1,0] neg_lo:[1,0,0] neg_hi:[1,0,0]
    v_exp_f32 v142, v142
    v_exp_f32 v162, v162
    ds_write_b128 v2, v[106:109] offset:0
    v_pk_fma_f32 v[146:147], v[22:23], s[60:61], v[248:249] op_sel_hi:[1,1,0] neg_lo:[0,0,1] neg_hi:[0,0,1]
    v_exp_f32 v143, v143
    v_exp_f32 v163, v163
    v_pk_fma_f32 v[166:167], v[22:23], s[60:61], v[250:251] op_sel_hi:[1,1,0] neg_lo:[1,0,0] neg_hi:[1,0,0]
    v_exp_f32 v144, v144
    v_exp_f32 v164, v164
    v_pk_fma_f32 v[148:149], v[24:25], s[60:61], v[248:249] op_sel_hi:[1,1,0] neg_lo:[0,0,1] neg_hi:[0,0,1]
    v_exp_f32 v145, v145
    v_exp_f32 v165, v165
    v_pk_fma_f32 v[168:169], v[24:25], s[60:61], v[250:251] op_sel_hi:[1,1,0] neg_lo:[1,0,0] neg_hi:[1,0,0]
    v_pk_add_f32 v[252:253], v[140:141], v[142:143]
    v_pk_add_f32 v[254:255], v[160:161], v[162:163]
    ds_write_b128 v2, v[110:113] offset:16
    v_exp_f32 v146, v146
    v_exp_f32 v166, v166
    v_pk_fma_f32 v[150:151], v[26:27], s[60:61], v[248:249] op_sel_hi:[1,1,0] neg_lo:[0,0,1] neg_hi:[0,0,1]
    v_exp_f32 v147, v147
    v_exp_f32 v167, v167
    v_pk_fma_f32 v[170:171], v[26:27], s[60:61], v[250:251] op_sel_hi:[1,1,0] neg_lo:[1,0,0] neg_hi:[1,0,0]
    v_pk_add_f32 v[252:253], v[252:253], v[144:145]
    v_pk_add_f32 v[254:255], v[254:255], v[164:165]
    v_exp_f32 v148, v148
    v_exp_f32 v168, v168
    v_pk_fma_f32 v[152:153], v[28:29], s[60:61], v[248:249] op_sel_hi:[1,1,0] neg_lo:[0,0,1] neg_hi:[0,0,1]
    v_exp_f32 v149, v149
    ds_write_b128 v2, v[114:117] offset:32
    v_exp_f32 v169, v169
    v_pk_fma_f32 v[172:173], v[28:29], s[60:61], v[250:251] op_sel_hi:[1,1,0] neg_lo:[1,0,0] neg_hi:[1,0,0]
    v_pk_add_f32 v[252:253], v[252:253], v[146:147]
    v_pk_add_f32 v[254:255], v[254:255], v[166:167]
    v_exp_f32 v150, v150
    v_exp_f32 v170, v170
    v_pk_fma_f32 v[154:155], v[30:31], s[60:61], v[248:249] op_sel_hi:[1,1,0] neg_lo:[0,0,1] neg_hi:[0,0,1]
    v_exp_f32 v151, v151
    v_exp_f32 v171, v171
    v_pk_fma_f32 v[174:175], v[30:31], s[60:61], v[250:251] op_sel_hi:[1,1,0] neg_lo:[1,0,0] neg_hi:[1,0,0]
    v_pk_add_f32 v[252:253], v[252:253], v[148:149]
    v_pk_add_f32 v[254:255], v[254:255], v[168:169]
    ds_write_b128 v2, v[128:131] offset:6656
    v_exp_f32 v152, v152
    v_exp_f32 v172, v172
    v_pk_fma_f32 v[156:157], v[32:33], s[60:61], v[248:249] op_sel_hi:[1,1,0] neg_lo:[0,0,1] neg_hi:[0,0,1]
    v_exp_f32 v153, v153
    v_exp_f32 v173, v173
    v_pk_fma_f32 v[176:177], v[32:33], s[60:61], v[250:251] op_sel_hi:[1,1,0] neg_lo:[1,0,0] neg_hi:[1,0,0]
    v_pk_add_f32 v[252:253], v[252:253], v[150:151]
    v_pk_add_f32 v[254:255], v[254:255], v[170:171]
    v_exp_f32 v154, v154
    v_exp_f32 v174, v174
    v_pk_fma_f32 v[158:159], v[34:35], s[60:61], v[248:249] op_sel_hi:[1,1,0] neg_lo:[0,0,1] neg_hi:[0,0,1]
    v_exp_f32 v155, v155
    ds_write_b128 v2, v[132:135] offset:6672
    v_exp_f32 v175, v175
    v_pk_fma_f32 v[178:179], v[34:35], s[60:61], v[250:251] op_sel_hi:[1,1,0] neg_lo:[1,0,0] neg_hi:[1,0,0]
    v_pk_add_f32 v[252:253], v[252:253], v[152:153]
    v_pk_add_f32 v[254:255], v[254:255], v[172:173]
    v_exp_f32 v156, v156
    v_exp_f32 v176, v176
    v_exp_f32 v157, v157
    v_exp_f32 v177, v177
    v_pk_add_f32 v[252:253], v[252:253], v[154:155]
    v_pk_add_f32 v[254:255], v[254:255], v[174:175]
    v_exp_f32 v158, v158
    v_exp_f32 v178, v178
    ds_write_b128 v2, v[136:139] offset:6688
    v_exp_f32 v159, v159
    v_exp_f32 v179, v179
    v_pk_add_f32 v[252:253], v[252:253], v[156:157]
    v_pk_add_f32 v[254:255], v[254:255], v[176:177]
    v_pk_add_f32 v[252:253], v[252:253], v[158:159]
    v_pk_add_f32 v[254:255], v[254:255], v[178:179]
    v_add_f32 v252, v252, v253
    v_add_f32 v254, v254, v255
    v_rcp_f32 v252, v252
    v_rcp_f32 v254, v254
    v_pk_mul_f32 v[140:141], v[140:141], v[252:253] op_sel_hi:[1,0]
    v_pk_mul_f32 v[142:143], v[142:143], v[252:253] op_sel_hi:[1,0]
    v_pk_mul_f32 v[144:145], v[144:145], v[252:253] op_sel_hi:[1,0]
    v_cvt_pk_bf16_f32 v56, v140, v141
    v_pk_mul_f32 v[146:147], v[146:147], v[252:253] op_sel_hi:[1,0]
    v_cvt_pk_bf16_f32 v57, v142, v143
    v_pk_mul_f32 v[148:149], v[148:149], v[252:253] op_sel_hi:[1,0]
    v_cvt_pk_bf16_f32 v58, v144, v145
    v_pk_mul_f32 v[150:151], v[150:151], v[252:253] op_sel_hi:[1,0]
    v_cvt_pk_bf16_f32 v59, v146, v147
    ds_write_b128 v3, v[56:59] offset:0
    v_pk_mul_f32 v[152:153], v[152:153], v[252:253] op_sel_hi:[1,0]
    v_cvt_pk_bf16_f32 v60, v148, v149
    v_pk_mul_f32 v[154:155], v[154:155], v[252:253] op_sel_hi:[1,0]
    v_cvt_pk_bf16_f32 v61, v150, v151
    v_pk_mul_f32 v[156:157], v[156:157], v[252:253] op_sel_hi:[1,0]
    v_cvt_pk_bf16_f32 v62, v152, v153
    v_pk_mul_f32 v[158:159], v[158:159], v[252:253] op_sel_hi:[1,0]
    v_cvt_pk_bf16_f32 v63, v154, v155
    ds_write_b128 v3, v[60:63] offset:16
    v_pk_mul_f32 v[160:161], v[160:161], v[254:255] op_sel_hi:[1,0]
    v_cvt_pk_bf16_f32 v64, v156, v157
    v_pk_mul_f32 v[162:163], v[162:163], v[254:255] op_sel_hi:[1,0]
    v_cvt_pk_bf16_f32 v65, v158, v159
    v_pk_mul_f32 v[164:165], v[164:165], v[254:255] op_sel_hi:[1,0]
    v_cvt_pk_bf16_f32 v66, v160, v161
    v_pk_mul_f32 v[166:167], v[166:167], v[254:255] op_sel_hi:[1,0]
    v_cvt_pk_bf16_f32 v67, v162, v163
    ds_write_b128 v3, v[64:67] offset:32
    v_pk_mul_f32 v[168:169], v[168:169], v[254:255] op_sel_hi:[1,0]
    v_cvt_pk_bf16_f32 v68, v164, v165
    v_pk_mul_f32 v[170:171], v[170:171], v[254:255] op_sel_hi:[1,0]
    v_cvt_pk_bf16_f32 v69, v166, v167
    v_pk_mul_f32 v[172:173], v[172:173], v[254:255] op_sel_hi:[1,0]
    v_cvt_pk_bf16_f32 v70, v168, v169
    v_pk_mul_f32 v[174:175], v[174:175], v[254:255] op_sel_hi:[1,0]
    v_cvt_pk_bf16_f32 v71, v170, v171
    ds_write_b128 v3, v[68:71] offset:48
    v_pk_mul_f32 v[176:177], v[176:177], v[254:255] op_sel_hi:[1,0]
    v_cvt_pk_bf16_f32 v72, v172, v173
    v_pk_mul_f32 v[178:179], v[178:179], v[254:255] op_sel_hi:[1,0]
    v_cvt_pk_bf16_f32 v73, v174, v175
    v_cvt_pk_bf16_f32 v74, v176, v177
    v_cvt_pk_bf16_f32 v75, v178, v179
    ds_write_b128 v3, v[72:75] offset:64
    v_mov_b32 v10, 159744
    v_mov_b32 v11, 1
    s_mov_b64 exec, 1
    ds_add_u32 v10, v11 offset:52
    s_mov_b64 exec, -1
    s_nop 0
    v_max3_f32 v248, v36, v37, v38
    v_min3_f32 v250, v36, v37, v38
    v_max3_f32 v248, v248, v39, v40
    v_min3_f32 v250, v250, v39, v40
    v_max3_f32 v248, v248, v41, v42
    v_min3_f32 v250, v250, v41, v42
    v_max3_f32 v248, v248, v43, v44
    v_min3_f32 v250, v250, v43, v44
    v_max3_f32 v248, v248, v45, v46
    v_min3_f32 v250, v250, v45, v46
    v_max3_f32 v248, v248, v47, v48
    v_min3_f32 v250, v250, v47, v48
    v_max3_f32 v248, v248, v49, v50
    v_min3_f32 v250, v250, v49, v50
    v_max3_f32 v248, v248, v51, v52
    v_min3_f32 v250, v250, v51, v52
    v_max3_f32 v248, v248, v53, v54
    v_min3_f32 v250, v250, v53, v54
    v_max_f32 v248, v248, v55
    v_min_f32 v250, v250, v55
    v_mul_f32 v248, s60, v248
    v_mul_f32 v250, s60, v250
    v_pk_fma_f32 v[140:141], v[36:37], s[60:61], v[248:249] op_sel_hi:[1,1,0] neg_lo:[0,0,1] neg_hi:[0,0,1]
    v_pk_fma_f32 v[160:161], v[36:37], s[60:61], v[250:251] op_sel_hi:[1,1,0] neg_lo:[1,0,0] neg_hi:[1,0,0]
    v_pk_fma_f32 v[142:143], v[38:39], s[60:61], v[248:249] op_sel_hi:[1,1,0] neg_lo:[0,0,1] neg_hi:[0,0,1]
    v_pk_fma_f32 v[162:163], v[38:39], s[60:61], v[250:251] op_sel_hi:[1,1,0] neg_lo:[1,0,0] neg_hi:[1,0,0]
    v_exp_f32 v140, v140
    v_exp_f32 v160, v160
    s_lshl_b32 s57, s50, 2
    v_pk_fma_f32 v[144:145], v[40:41], s[60:61], v[248:249] op_sel_hi:[1,1,0] neg_lo:[0,0,1] neg_hi:[0,0,1]
    v_exp_f32 v141, v141
    v_exp_f32 v161, v161
    v_pk_fma_f32 v[164:165], v[40:41], s[60:61], v[250:251] op_sel_hi:[1,1,0] neg_lo:[1,0,0] neg_hi:[1,0,0]
    v_exp_f32 v142, v142
    v_exp_f32 v162, v162
    s_add_u32 s57, s57, s48
    v_pk_fma_f32 v[146:147], v[42:43], s[60:61], v[248:249] op_sel_hi:[1,1,0] neg_lo:[0,0,1] neg_hi:[0,0,1]
    v_exp_f32 v143, v143
    v_exp_f32 v163, v163
    v_pk_fma_f32 v[166:167], v[42:43], s[60:61], v[250:251] op_sel_hi:[1,1,0] neg_lo:[1,0,0] neg_hi:[1,0,0]
    v_exp_f32 v144, v144
    v_exp_f32 v164, v164
    s_lshl_b32 s57, s57, 4
    v_pk_fma_f32 v[148:149], v[44:45], s[60:61], v[248:249] op_sel_hi:[1,1,0] neg_lo:[0,0,1] neg_hi:[0,0,1]
    v_exp_f32 v145, v145
    v_exp_f32_e64 v165, v165
    v_pk_fma_f32 v[168:169], v[44:45], s[60:61], v[250:251] op_sel_hi:[1,1,0] neg_lo:[1,0,0] neg_hi:[1,0,0]
    v_pk_add_f32 v[252:253], v[140:141], v[142:143]
    v_pk_add_f32 v[254:255], v[160:161], v[162:163]
    s_add_u32 s57, s57, s49
    v_exp_f32 v146, v146
    v_exp_f32 v166, v166
    v_pk_fma_f32 v[150:151], v[46:47], s[60:61], v[248:249] op_sel_hi:[1,1,0] neg_lo:[0,0,1] neg_hi:[0,0,1]
    v_exp_f32 v147, v147
    v_exp_f32 v167, v167
    v_pk_fma_f32 v[170:171], v[46:47], s[60:61], v[250:251] op_sel_hi:[1,1,0] neg_lo:[1,0,0] neg_hi:[1,0,0]
    s_lshl_b32 s59, s57, 7
    v_pk_add_f32 v[252:253], v[252:253], v[144:145]
    v_pk_add_f32 v[254:255], v[254:255], v[164:165]
    v_exp_f32 v148, v148
    v_exp_f32 v168, v168
    v_pk_fma_f32 v[152:153], v[48:49], s[60:61], v[248:249] op_sel_hi:[1,1,0] neg_lo:[0,0,1] neg_hi:[0,0,1]
    v_exp_f32 v149, v149
    s_add_u32 s59, s59, 0xf00000
    v_exp_f32 v169, v169
    v_pk_fma_f32 v[172:173], v[48:49], s[60:61], v[250:251] op_sel_hi:[1,1,0] neg_lo:[1,0,0] neg_hi:[1,0,0]
    v_pk_add_f32 v[252:253], v[252:253], v[146:147]
    v_pk_add_f32 v[254:255], v[254:255], v[166:167]
    v_exp_f32 v150, v150
    v_exp_f32 v170, v170
    s_mul_i32 s57, s57, 2560
    v_pk_fma_f32 v[154:155], v[50:51], s[60:61], v[248:249] op_sel_hi:[1,1,0] neg_lo:[0,0,1] neg_hi:[0,0,1]
    v_exp_f32 v151, v151
    v_exp_f32 v171, v171
    v_pk_fma_f32 v[174:175], v[50:51], s[60:61], v[250:251] op_sel_hi:[1,1,0] neg_lo:[1,0,0] neg_hi:[1,0,0]
    v_pk_add_f32 v[252:253], v[252:253], v[148:149]
    v_pk_add_f32 v[254:255], v[254:255], v[168:169]
    s_add_u32 s57, s57, 0x380000
    v_exp_f32 v152, v152
    v_exp_f32 v172, v172
    v_pk_fma_f32 v[156:157], v[52:53], s[60:61], v[248:249] op_sel_hi:[1,1,0] neg_lo:[0,0,1] neg_hi:[0,0,1]
    v_exp_f32 v153, v153
    v_exp_f32 v173, v173
    v_pk_fma_f32 v[176:177], v[52:53], s[60:61], v[250:251] op_sel_hi:[1,1,0] neg_lo:[1,0,0] neg_hi:[1,0,0]
    v_pk_add_f32 v[252:253], v[252:253], v[150:151]
    v_pk_add_f32 v[254:255], v[254:255], v[170:171]
    v_exp_f32 v154, v154
    v_exp_f32 v174, v174
    v_pk_fma_f32 v[158:159], v[54:55], s[60:61], v[248:249] op_sel_hi:[1,1,0] neg_lo:[0,0,1] neg_hi:[0,0,1]
    v_exp_f32 v155, v155
    ds_read_b32 v12, v10 offset:52
    v_exp_f32 v175, v175
    v_pk_fma_f32 v[178:179], v[54:55], s[60:61], v[250:251] op_sel_hi:[1,1,0] neg_lo:[1,0,0] neg_hi:[1,0,0]
    v_pk_add_f32 v[252:253], v[252:253], v[152:153]
    v_pk_add_f32 v[254:255], v[254:255], v[172:173]
    v_exp_f32 v156, v156
    v_exp_f32 v176, v176
    v_exp_f32 v157, v157
    v_exp_f32 v177, v177
    v_pk_add_f32 v[252:253], v[252:253], v[154:155]
    v_pk_add_f32 v[254:255], v[254:255], v[174:175]
    v_exp_f32 v158, v158
    v_exp_f32 v178, v178
    v_exp_f32 v159, v159
    v_exp_f32 v179, v179
    v_pk_add_f32 v[252:253], v[252:253], v[156:157]
    v_pk_add_f32 v[254:255], v[254:255], v[176:177]
    v_pk_add_f32 v[252:253], v[252:253], v[158:159]
    v_pk_add_f32 v[254:255], v[254:255], v[178:179]
    v_add_f32 v252, v252, v253
    v_add_f32 v254, v254, v255
    v_rcp_f32 v252, v252
    v_rcp_f32 v254, v254
    s_waitcnt lgkmcnt(0)
    s_cmp_lg_u32 s30, s31
    s_cbranch_scc1 L_hsd_31
    s_mov_b32 s101, 0x10000
    v_mov_b32 v16, 0
L_hs_30:
    global_load_dwordx2 v[14:15], v16, s[26:27] sc1
    s_waitcnt vmcnt(0)
    v_readfirstlane_b32 s30, v14
    v_readfirstlane_b32 s31, v15
    s_nop 3
    s_cmp_lg_u32 s30, s31
    s_cbranch_scc1 L_hsd_31
    s_sleep 8
    s_sub_u32 s101, s101, 1
    s_cmp_eq_u32 s101, 0
    s_cbranch_scc0 L_hs_30
    s_endpgm
L_hsd_31:
    v_cmp_le_u32 vcc, 4, v12
    s_cbranch_vccnz L_s0ok_32
    v_mov_b32 v12, 159796
    s_mov_b32 s101, 0x200000
L_lw_33:
    ds_read_b32 v13, v12
    s_waitcnt lgkmcnt(0)
    v_cmp_le_u32 vcc, 4, v13
    s_cbranch_vccnz L_lwd_34
    s_sub_u32 s101, s101, 1
    s_cmp_eq_u32 s101, 0
    s_cbranch_scc0 L_lw_33
    s_endpgm
L_lwd_34:
L_s0ok_32:
    v_pk_mul_f32 v[140:141], v[140:141], v[252:253] op_sel_hi:[1,0]
    v_pk_mul_f32 v[142:143], v[142:143], v[252:253] op_sel_hi:[1,0]
    v_pk_mul_f32 v[144:145], v[144:145], v[252:253] op_sel_hi:[1,0]
    v_cvt_pk_bf16_f32 v76, v140, v141
    v_pk_mul_f32 v[146:147], v[146:147], v[252:253] op_sel_hi:[1,0]
    v_cvt_pk_bf16_f32 v77, v142, v143
    v_pk_mul_f32 v[148:149], v[148:149], v[252:253] op_sel_hi:[1,0]
    v_cvt_pk_bf16_f32 v78, v144, v145
    v_pk_mul_f32 v[150:151], v[150:151], v[252:253] op_sel_hi:[1,0]
    v_cvt_pk_bf16_f32 v79, v146, v147
    ds_write_b128 v3, v[76:79] offset:10752
    v_pk_mul_f32 v[152:153], v[152:153], v[252:253] op_sel_hi:[1,0]
    v_cvt_pk_bf16_f32 v80, v148, v149
    v_pk_mul_f32 v[154:155], v[154:155], v[252:253] op_sel_hi:[1,0]
    v_cvt_pk_bf16_f32 v81, v150, v151
    v_pk_mul_f32 v[156:157], v[156:157], v[252:253] op_sel_hi:[1,0]
    v_cvt_pk_bf16_f32 v82, v152, v153
    v_pk_mul_f32 v[158:159], v[158:159], v[252:253] op_sel_hi:[1,0]
    v_cvt_pk_bf16_f32 v83, v154, v155
    ds_write_b128 v3, v[80:83] offset:10768
    v_pk_mul_f32 v[160:161], v[160:161], v[254:255] op_sel_hi:[1,0]
    v_cvt_pk_bf16_f32 v84, v156, v157
    v_pk_mul_f32 v[162:163], v[162:163], v[254:255] op_sel_hi:[1,0]
    v_cvt_pk_bf16_f32 v85, v158, v159
    v_pk_mul_f32 v[164:165], v[164:165], v[254:255] op_sel_hi:[1,0]
    v_cvt_pk_bf16_f32 v86, v160, v161
    v_pk_mul_f32 v[166:167], v[166:167], v[254:255] op_sel_hi:[1,0]
    v_cvt_pk_bf16_f32 v87, v162, v163
    ds_write_b128 v3, v[84:87] offset:10784
    v_pk_mul_f32 v[168:169], v[168:169], v[254:255] op_sel_hi:[1,0]
    v_cvt_pk_bf16_f32 v88, v164, v165
    v_pk_mul_f32 v[170:171], v[170:171], v[254:255] op_sel_hi:[1,0]
    v_cvt_pk_bf16_f32 v89, v166, v167
    v_pk_mul_f32 v[172:173], v[172:173], v[254:255] op_sel_hi:[1,0]
    v_cvt_pk_bf16_f32 v90, v168, v169
    v_pk_mul_f32 v[174:175], v[174:175], v[254:255] op_sel_hi:[1,0]
    v_cvt_pk_bf16_f32 v91, v170, v171
    ds_write_b128 v3, v[88:91] offset:10800
    v_pk_mul_f32 v[176:177], v[176:177], v[254:255] op_sel_hi:[1,0]
    v_cvt_pk_bf16_f32 v92, v172, v173
    v_pk_mul_f32 v[178:179], v[178:179], v[254:255] op_sel_hi:[1,0]
    v_cvt_pk_bf16_f32 v93, v174, v175
    v_cvt_pk_bf16_f32 v94, v176, v177
    v_cvt_pk_bf16_f32 v95, v178, v179
    ds_write_b128 v3, v[92:95] offset:10816
    s_mov_b64 exec, 1
    ds_add_u32 v10, v11
    s_mov_b64 exec, -1
    ds_read_b64_tr_b16 v[96:97], v7 offset:0
    ds_read_b64_tr_b16 v[98:99], v7 offset:832
    ds_read_b64_tr_b16 v[188:189], v6 offset:0
    ds_read_b64_tr_b16 v[192:193], v6 offset:32
    ds_read_b64_tr_b16 v[190:191], v6 offset:1344
    ds_read_b64_tr_b16 v[194:195], v6 offset:1376
    ds_read_b64_tr_b16 v[100:101], v7 offset:3328
    ds_read_b64_tr_b16 v[102:103], v7 offset:4160
    ds_read_b64_tr_b16 v[196:197], v6 offset:5376
    ds_read_b64_tr_b16 v[200:201], v6 offset:5408
    ds_read_b64_tr_b16 v[198:199], v6 offset:6720
    ds_read_b64_tr_b16 v[202:203], v6 offset:6752
    s_waitcnt lgkmcnt(6)
    v_mfma_f32_32x32x16_bf16 v[16:31], v[188:191], v[96:99], 0
    v_mfma_f32_32x32x16_bf16 v[32:47], v[192:195], v[96:99], 0
    ds_read_b64_tr_b16 v[112:113], v7 offset:13312
    ds_read_b64_tr_b16 v[114:115], v7 offset:14144
    ds_read_b64_tr_b16 v[204:205], v6 offset:21504
    ds_read_b64_tr_b16 v[208:209], v6 offset:21536
    ds_read_b64_tr_b16 v[206:207], v6 offset:22848
    ds_read_b64_tr_b16 v[210:211], v6 offset:22880
    s_waitcnt lgkmcnt(6)
    v_mfma_f32_32x32x16_bf16 v[16:31], v[196:199], v[100:103], v[16:31]
    v_mfma_f32_32x32x16_bf16 v[32:47], v[200:203], v[100:103], v[32:47]
    ds_read_b64_tr_b16 v[116:117], v7 offset:16640
    ds_read_b64_tr_b16 v[118:119], v7 offset:17472
    ds_read_b64_tr_b16 v[212:213], v6 offset:26880
    ds_read_b64_tr_b16 v[216:217], v6 offset:26912
    ds_read_b64_tr_b16 v[214:215], v6 offset:28224
    ds_read_b64_tr_b16 v[218:219], v6 offset:28256
    ds_read_b32 v12, v10
    s_waitcnt lgkmcnt(7)
    v_mfma_f32_32x32x16_bf16 v[16:31], v[204:207], v[112:115], v[16:31]
    v_mfma_f32_32x32x16_bf16 v[32:47], v[208:211], v[112:115], v[32:47]
    ds_read_b64_tr_b16 v[104:105], v7 offset:6656
    ds_read_b64_tr_b16 v[106:107], v7 offset:7488
    ds_read_b64_tr_b16 v[108:109], v7 offset:9984
    ds_read_b64_tr_b16 v[110:111], v7 offset:10816
    ds_read_b64_tr_b16 v[120:121], v7 offset:19968
    ds_read_b64_tr_b16 v[122:123], v7 offset:20800
    ds_read_b64_tr_b16 v[124:125], v7 offset:23296
    ds_read_b64_tr_b16 v[126:127], v7 offset:24128
    v_lshlrev_b32 v2, 4, v1
    v_lshlrev_b32 v3, 3, v1
    s_waitcnt lgkmcnt(8)
    v_cmp_le_u32 vcc, 4, v12
    s_cbranch_vccnz L_s1ok_35
    s_mov_b32 s101, 0x200000
L_lw_36:
    ds_read_b32 v11, v10
    s_waitcnt lgkmcnt(0)
    v_cmp_le_u32 vcc, 4, v11
    s_cbranch_vccnz L_lwd_37
    s_sub_u32 s101, s101, 1
    s_cmp_eq_u32 s101, 0
    s_cbranch_scc0 L_lw_36
    s_endpgm
L_lwd_37:
L_s1ok_35:
    ds_read_b64_tr_b16 v[220:221], v6 offset:10752
    ds_read_b64_tr_b16 v[224:225], v6 offset:10784
    ds_read_b64_tr_b16 v[222:223], v6 offset:12096
    ds_read_b64_tr_b16 v[226:227], v6 offset:12128
    ds_read_b64_tr_b16 v[228:229], v6 offset:16128
    ds_read_b64_tr_b16 v[232:233], v6 offset:16160
    ds_read_b64_tr_b16 v[230:231], v6 offset:17472
    ds_read_b64_tr_b16 v[234:235], v6 offset:17504
    v_mfma_f32_32x32x16_bf16 v[16:31], v[212:215], v[116:119], v[16:31]
    v_mfma_f32_32x32x16_bf16 v[32:47], v[216:219], v[116:119], v[32:47]
    ds_read_b64_tr_b16 v[236:237], v6 offset:32256
    ds_read_b64_tr_b16 v[240:241], v6 offset:32288
    ds_read_b64_tr_b16 v[238:239], v6 offset:33600
    ds_read_b64_tr_b16 v[242:243], v6 offset:33632
    s_waitcnt lgkmcnt(8)
    v_mfma_f32_32x32x16_bf16 v[16:31], v[220:223], v[104:107], v[16:31]
    v_mfma_f32_32x32x16_bf16 v[32:47], v[224:227], v[104:107], v[32:47]
    ds_read_b64_tr_b16 v[128:129], v6 offset:37632
    ds_read_b64_tr_b16 v[132:133], v6 offset:37664
    ds_read_b64_tr_b16 v[130:131], v6 offset:38976
    ds_read_b64_tr_b16 v[134:135], v6 offset:39008
    s_waitcnt lgkmcnt(8)
    v_mfma_f32_32x32x16_bf16 v[16:31], v[228:231], v[108:111], v[16:31]
    v_mfma_f32_32x32x16_bf16 v[32:47], v[232:235], v[108:111], v[32:47]
    s_waitcnt lgkmcnt(4)
    v_mfma_f32_32x32x16_bf16 v[16:31], v[236:239], v[120:123], v[16:31]
    v_mfma_f32_32x32x16_bf16 v[32:47], v[240:243], v[120:123], v[32:47]
    s_waitcnt lgkmcnt(0)
    v_mfma_f32_32x32x16_bf16 v[16:31], v[128:131], v[124:127], v[16:31]
    v_mfma_f32_32x32x16_bf16 v[32:47], v[132:135], v[124:127], v[32:47]
    s_sub_u32 s63, s99, 8
    s_lshr_b32 s62, s63, 2
    s_lshl_b32 s3, s98, 2
    s_add_u32 s62, s62, s3
    s_and_b32 s63, s63, 3
    s_lshl_b32 s63, s63, 2
    s_add_u32 s63, s63, s48
    s_nop 3
    s_nop 0
    v_cvt_pk_bf16_f32 v48, v16, v17
    v_cvt_pk_bf16_f32 v49, v18, v19
    v_cvt_pk_bf16_f32 v50, v20, v21
    v_cvt_pk_bf16_f32 v51, v22, v23
    v_cvt_pk_bf16_f32 v52, v24, v25
    v_cvt_pk_bf16_f32 v53, v26, v27
    v_cvt_pk_bf16_f32 v54, v28, v29
    v_cvt_pk_bf16_f32 v55, v30, v31
    v_cvt_pk_bf16_f32 v56, v32, v33
    v_cvt_pk_bf16_f32 v57, v34, v35
    buffer_store_dwordx2 v[56:57], v3, s[44:47], s57 offen offset:2048 sc1
    s_mov_b32 exec_lo, 0x00ffffff
    s_mov_b32 exec_hi, 0x00ffffff
    buffer_store_dwordx4 v[48:51], v2, s[44:47], s57 offen sc1
    buffer_store_dwordx4 v[52:55], v2, s[44:47], s57 offen offset:1024 sc1
    s_mov_b64 exec, -1
    s_mul_i32 s53, s48, 20480
    s_add_u32 s53, s53, 69632
    v_and_b32 v4, 31, v1
    v_lshl_add_u32 v5, v4, 4, s53
    v_lshl_add_u32 v6, v4, 3, s53
    v_and_b32 v7, 32, v1
    v_lshlrev_b32_e64 v7, 26, v7
    s_lshl_b32 s54, s48, 2
    s_add_u32 s54, s54, 159760
    s_mov_b32 s58, 0xffff0000
    v_mov_b32 v138, 0
    v_mov_b32 v139, 0
    v_mov_b32 v150, 0
    v_mov_b32 v151, 0
    v_mov_b32 v162, 0
    v_mov_b32 v163, 0
    v_mov_b32 v174, 0
    v_mov_b32 v175, 0
    s_mov_b32 s96, s59
    s_mov_b32 s97, 0
    v_mov_b32 v10, s30
    v_mov_b32 v11, s31
    v_lshlrev_b32 v12, 3, v1
    s_waitcnt vmcnt(0)
    s_mov_b64 exec, 0xffff
    buffer_store_dwordx2 v[10:11], v12, s[44:47], s96 offen sc1
    s_mov_b64 exec, -1
    v_mov_b32 v14, 159748
    v_mov_b32 v15, 1
    s_waitcnt lgkmcnt(0)
    s_mov_b64 exec, 1
    ds_add_u32 v14, v15
    s_mov_b64 exec, -1
    s_mov_b32 s97, 1
    v_mov_b32_e64 v14, s54
    s_mov_b32 s101, 0x200000
L_lw_38:
    ds_read_b32 v15, v14
    s_waitcnt lgkmcnt(0)
    v_cmp_le_u32 vcc, 1, v15
    s_cbranch_vccnz L_lwd_39
    s_sub_u32 s101, s101, 1
    s_cmp_eq_u32 s101, 0
    s_cbranch_scc0 L_lw_38
    s_endpgm
L_lwd_39:
    ds_read_b128 v[64:67], v5 offset:0
    ds_read_b128 v[68:71], v5 offset:512
    ds_read_b64 v[72:73], v6 offset:1024
    ds_read_b128 v[74:77], v5 offset:1280
    ds_read_b128 v[78:81], v5 offset:1792
    ds_read_b64 v[82:83], v6 offset:2304
    ds_read_b128 v[84:87], v5 offset:2560
    ds_read_b128 v[88:91], v5 offset:3072
    ds_read_b64 v[92:93], v6 offset:3584
    ds_read_b128 v[94:97], v5 offset:3840
    ds_read_b128 v[98:101], v5 offset:4352
    ds_read_b64 v[102:103], v6 offset:4864
    s_lshl_b32 s57, s63, 2
    s_mul_i32 s54, s57, 40960
    s_add_u32 s54, s54, 0x4c0000
    s_lshl_b32 s59, s62, 8
    s_add_u32 s59, s59, s54
    s_add_u32 s59, s59, 32768
    s_lshl_b32 s57, s62, 10
    s_add_u32 s54, s54, s57
    s_lshl_b32 s50, s63, 5
    s_add_u32 s50, s50, s62
    s_lshl_b32 s50, s50, 7
    s_add_u32 s50, s50, 0xf20000
    s_waitcnt lgkmcnt(9)
    v_lshl_add_u32 v104, v64, 16, v7
    v_bitop3_b32 v105, v64, s58, v7 bitop3:0x6a
    v_lshl_add_u32 v106, v65, 16, v7
    v_bitop3_b32 v107, v65, s58, v7 bitop3:0x6a
    v_lshl_add_u32 v108, v66, 16, v7
    v_bitop3_b32 v109, v66, s58, v7 bitop3:0x6a
    v_lshl_add_u32 v110, v67, 16, v7
    v_bitop3_b32 v111, v67, s58, v7 bitop3:0x6a
    v_lshl_add_u32 v112, v68, 16, v7
    v_bitop3_b32 v113, v68, s58, v7 bitop3:0x6a
    v_lshl_add_u32 v114, v69, 16, v7
    v_bitop3_b32 v115, v69, s58, v7 bitop3:0x6a
    v_lshl_add_u32 v116, v70, 16, v7
    v_bitop3_b32 v117, v70, s58, v7 bitop3:0x6a
    v_lshl_add_u32 v118, v71, 16, v7
    v_bitop3_b32 v119, v71, s58, v7 bitop3:0x6a
    v_lshl_add_u32 v120, v72, 16, v7
    v_bitop3_b32 v121, v72, s58, v7 bitop3:0x6a
    v_lshl_add_u32 v122, v73, 16, v7
    v_bitop3_b32 v123, v73, s58, v7 bitop3:0x6a
    v_max3_f32 v124, v104, v105, v106
    v_max3_f32 v125, v107, v108, v109
    v_max3_f32 v124, v124, v110, v111
    v_max3_f32 v125, v125, v112, v113
    v_max3_f32 v124, v124, v114, v115
    v_max3_f32 v125, v125, v116, v117
    v_max3_f32 v124, v124, v118, v119
    v_max3_f32 v125, v125, v120, v121
    v_max3_f32 v124, v124, v122, v123
    v_max_f32 v124, v124, v125
    v_mul_f32 v124, s60, v124
    v_pk_fma_f32 v[104:105], v[104:105], s[60:61], v[124:125] op_sel_hi:[1,1,0] neg_lo:[0,0,1] neg_hi:[0,0,1]
    v_pk_fma_f32 v[106:107], v[106:107], s[60:61], v[124:125] op_sel_hi:[1,1,0] neg_lo:[0,0,1] neg_hi:[0,0,1]
    v_pk_fma_f32 v[108:109], v[108:109], s[60:61], v[124:125] op_sel_hi:[1,1,0] neg_lo:[0,0,1] neg_hi:[0,0,1]
    v_pk_fma_f32 v[110:111], v[110:111], s[60:61], v[124:125] op_sel_hi:[1,1,0] neg_lo:[0,0,1] neg_hi:[0,0,1]
    v_pk_fma_f32 v[112:113], v[112:113], s[60:61], v[124:125] op_sel_hi:[1,1,0] neg_lo:[0,0,1] neg_hi:[0,0,1]
    v_pk_fma_f32 v[114:115], v[114:115], s[60:61], v[124:125] op_sel_hi:[1,1,0] neg_lo:[0,0,1] neg_hi:[0,0,1]
    v_pk_fma_f32 v[116:117], v[116:117], s[60:61], v[124:125] op_sel_hi:[1,1,0] neg_lo:[0,0,1] neg_hi:[0,0,1]
    v_pk_fma_f32 v[118:119], v[118:119], s[60:61], v[124:125] op_sel_hi:[1,1,0] neg_lo:[0,0,1] neg_hi:[0,0,1]
    v_pk_fma_f32 v[120:121], v[120:121], s[60:61], v[124:125] op_sel_hi:[1,1,0] neg_lo:[0,0,1] neg_hi:[0,0,1]
    v_pk_fma_f32 v[122:123], v[122:123], s[60:61], v[124:125] op_sel_hi:[1,1,0] neg_lo:[0,0,1] neg_hi:[0,0,1]
    v_exp_f32 v104, v104
    v_exp_f32 v105, v105
    v_exp_f32 v106, v106
    v_exp_f32 v107, v107
    v_exp_f32 v108, v108
    v_exp_f32 v109, v109
    v_exp_f32 v110, v110
    v_exp_f32 v111, v111
    v_exp_f32 v112, v112
    v_exp_f32 v113, v113
    v_exp_f32 v114, v114
    v_exp_f32 v115, v115
    v_exp_f32 v116, v116
    v_exp_f32 v117, v117
    v_exp_f32 v118, v118
    v_exp_f32 v119, v119
    v_exp_f32 v120, v120
    v_exp_f32 v121, v121
    v_exp_f32 v122, v122
    v_exp_f32 v123, v123
    v_pk_add_f32 v[126:127], v[104:105], v[106:107]
    v_pk_add_f32 v[124:125], v[108:109], v[110:111]
    v_pk_add_f32 v[126:127], v[126:127], v[112:113]
    v_pk_add_f32 v[124:125], v[124:125], v[114:115]
    v_pk_add_f32 v[126:127], v[126:127], v[116:117]
    v_pk_add_f32 v[124:125], v[124:125], v[118:119]
    v_pk_add_f32 v[126:127], v[126:127], v[120:121]
    v_pk_add_f32 v[124:125], v[124:125], v[122:123]
    v_pk_add_f32 v[126:127], v[126:127], v[124:125]
    v_add_f32 v126, v126, v127
    v_rcp_f32_e64 v126, v126
    s_nop 0
    v_pk_mul_f32 v[104:105], v[104:105], v[126:127] op_sel_hi:[1,0]
    v_pk_mul_f32 v[106:107], v[106:107], v[126:127] op_sel_hi:[1,0]
    v_pk_mul_f32 v[108:109], v[108:109], v[126:127] op_sel_hi:[1,0]
    v_pk_mul_f32 v[110:111], v[110:111], v[126:127] op_sel_hi:[1,0]
    v_pk_mul_f32 v[112:113], v[112:113], v[126:127] op_sel_hi:[1,0]
    v_pk_mul_f32 v[114:115], v[114:115], v[126:127] op_sel_hi:[1,0]
    v_pk_mul_f32 v[116:117], v[116:117], v[126:127] op_sel_hi:[1,0]
    v_pk_mul_f32 v[118:119], v[118:119], v[126:127] op_sel_hi:[1,0]
    v_pk_mul_f32 v[120:121], v[120:121], v[126:127] op_sel_hi:[1,0]
    v_pk_mul_f32 v[122:123], v[122:123], v[126:127] op_sel_hi:[1,0]
    v_cvt_pk_bf16_f32 v128, v104, v105
    v_cvt_pk_bf16_f32 v129, v106, v107
    v_cvt_pk_bf16_f32 v130, v108, v109
    v_cvt_pk_bf16_f32 v131, v110, v111
    v_cvt_pk_bf16_f32 v132, v112, v113
    v_cvt_pk_bf16_f32 v133, v114, v115
    v_cvt_pk_bf16_f32 v134, v116, v117
    v_cvt_pk_bf16_f32 v135, v118, v119
    v_cvt_pk_bf16_f32 v136, v120, v121
    v_cvt_pk_bf16_f32 v137, v122, v123
    s_waitcnt lgkmcnt(6)
    s_nop 0
    v_lshl_add_u32 v104, v74, 16, v7
    v_bitop3_b32 v105, v74, s58, v7 bitop3:0x6a
    v_lshl_add_u32 v106, v75, 16, v7
    v_bitop3_b32 v107, v75, s58, v7 bitop3:0x6a
    v_lshl_add_u32 v108, v76, 16, v7
    v_bitop3_b32 v109, v76, s58, v7 bitop3:0x6a
    v_lshl_add_u32 v110, v77, 16, v7
    v_bitop3_b32 v111, v77, s58, v7 bitop3:0x6a
    v_lshl_add_u32 v112, v78, 16, v7
    v_bitop3_b32 v113, v78, s58, v7 bitop3:0x6a
    v_lshl_add_u32 v114, v79, 16, v7
    v_bitop3_b32 v115, v79, s58, v7 bitop3:0x6a
    v_lshl_add_u32 v116, v80, 16, v7
    v_bitop3_b32 v117, v80, s58, v7 bitop3:0x6a
    v_lshl_add_u32 v118, v81, 16, v7
    v_bitop3_b32 v119, v81, s58, v7 bitop3:0x6a
    v_lshl_add_u32 v120, v82, 16, v7
    v_bitop3_b32 v121, v82, s58, v7 bitop3:0x6a
    v_lshl_add_u32 v122, v83, 16, v7
    v_bitop3_b32 v123, v83, s58, v7 bitop3:0x6a
    v_max3_f32 v124, v104, v105, v106
    v_max3_f32 v125, v107, v108, v109
    v_max3_f32 v124, v124, v110, v111
    v_max3_f32 v125, v125, v112, v113
    v_max3_f32 v124, v124, v114, v115
    v_max3_f32 v125, v125, v116, v117
    v_max3_f32 v124, v124, v118, v119
    v_max3_f32 v125, v125, v120, v121
    v_max3_f32 v124, v124, v122, v123
    v_max_f32 v124, v124, v125
    v_mul_f32 v124, s60, v124
    v_pk_fma_f32 v[104:105], v[104:105], s[60:61], v[124:125] op_sel_hi:[1,1,0] neg_lo:[0,0,1] neg_hi:[0,0,1]
    v_pk_fma_f32 v[106:107], v[106:107], s[60:61], v[124:125] op_sel_hi:[1,1,0] neg_lo:[0,0,1] neg_hi:[0,0,1]
    v_pk_fma_f32 v[108:109], v[108:109], s[60:61], v[124:125] op_sel_hi:[1,1,0] neg_lo:[0,0,1] neg_hi:[0,0,1]
    v_pk_fma_f32 v[110:111], v[110:111], s[60:61], v[124:125] op_sel_hi:[1,1,0] neg_lo:[0,0,1] neg_hi:[0,0,1]
    v_pk_fma_f32 v[112:113], v[112:113], s[60:61], v[124:125] op_sel_hi:[1,1,0] neg_lo:[0,0,1] neg_hi:[0,0,1]
    v_pk_fma_f32 v[114:115], v[114:115], s[60:61], v[124:125] op_sel_hi:[1,1,0] neg_lo:[0,0,1] neg_hi:[0,0,1]
    v_pk_fma_f32 v[116:117], v[116:117], s[60:61], v[124:125] op_sel_hi:[1,1,0] neg_lo:[0,0,1] neg_hi:[0,0,1]
    v_pk_fma_f32 v[118:119], v[118:119], s[60:61], v[124:125] op_sel_hi:[1,1,0] neg_lo:[0,0,1] neg_hi:[0,0,1]
    v_pk_fma_f32 v[120:121], v[120:121], s[60:61], v[124:125] op_sel_hi:[1,1,0] neg_lo:[0,0,1] neg_hi:[0,0,1]
    v_pk_fma_f32 v[122:123], v[122:123], s[60:61], v[124:125] op_sel_hi:[1,1,0] neg_lo:[0,0,1] neg_hi:[0,0,1]
    v_exp_f32 v104, v104
    v_exp_f32 v105, v105
    v_exp_f32 v106, v106
    v_exp_f32 v107, v107
    v_exp_f32 v108, v108
    v_exp_f32 v109, v109
    v_exp_f32 v110, v110
    v_exp_f32 v111, v111
    v_exp_f32 v112, v112
    v_exp_f32 v113, v113
    v_exp_f32 v114, v114
    v_exp_f32 v115, v115
    v_exp_f32 v116, v116
    v_exp_f32 v117, v117
    v_exp_f32 v118, v118
    v_exp_f32 v119, v119
    v_exp_f32 v120, v120
    v_exp_f32 v121, v121
    v_exp_f32 v122, v122
    v_exp_f32 v123, v123
    v_pk_add_f32 v[126:127], v[104:105], v[106:107]
    v_pk_add_f32 v[124:125], v[108:109], v[110:111]
    v_pk_add_f32 v[126:127], v[126:127], v[112:113]
    v_pk_add_f32 v[124:125], v[124:125], v[114:115]
    v_pk_add_f32 v[126:127], v[126:127], v[116:117]
    v_pk_add_f32 v[124:125], v[124:125], v[118:119]
    v_pk_add_f32 v[126:127], v[126:127], v[120:121]
    v_pk_add_f32 v[124:125], v[124:125], v[122:123]
    v_pk_add_f32 v[126:127], v[126:127], v[124:125]
    v_add_f32 v126, v126, v127
    v_rcp_f32_e64 v126, v126
    s_nop 0
    v_pk_mul_f32 v[104:105], v[104:105], v[126:127] op_sel_hi:[1,0]
    v_pk_mul_f32 v[106:107], v[106:107], v[126:127] op_sel_hi:[1,0]
    v_pk_mul_f32 v[108:109], v[108:109], v[126:127] op_sel_hi:[1,0]
    v_pk_mul_f32 v[110:111], v[110:111], v[126:127] op_sel_hi:[1,0]
    v_pk_mul_f32 v[112:113], v[112:113], v[126:127] op_sel_hi:[1,0]
    v_pk_mul_f32 v[114:115], v[114:115], v[126:127] op_sel_hi:[1,0]
    v_pk_mul_f32 v[116:117], v[116:117], v[126:127] op_sel_hi:[1,0]
    v_pk_mul_f32 v[118:119], v[118:119], v[126:127] op_sel_hi:[1,0]
    v_pk_mul_f32 v[120:121], v[120:121], v[126:127] op_sel_hi:[1,0]
    v_pk_mul_f32 v[122:123], v[122:123], v[126:127] op_sel_hi:[1,0]
    v_cvt_pk_bf16_f32 v140, v104, v105
    v_cvt_pk_bf16_f32 v141, v106, v107
    v_cvt_pk_bf16_f32 v142, v108, v109
    v_cvt_pk_bf16_f32 v143, v110, v111
    v_cvt_pk_bf16_f32 v144, v112, v113
    v_cvt_pk_bf16_f32 v145, v114, v115
    v_cvt_pk_bf16_f32 v146, v116, v117
    v_cvt_pk_bf16_f32 v147, v118, v119
    v_cvt_pk_bf16_f32 v148, v120, v121
    v_cvt_pk_bf16_f32 v149, v122, v123
    s_waitcnt lgkmcnt(3)
    s_nop 0
    v_lshl_add_u32 v104, v84, 16, v7
    v_bitop3_b32 v105, v84, s58, v7 bitop3:0x6a
    v_lshl_add_u32 v106, v85, 16, v7
    v_bitop3_b32 v107, v85, s58, v7 bitop3:0x6a
    v_lshl_add_u32 v108, v86, 16, v7
    v_bitop3_b32 v109, v86, s58, v7 bitop3:0x6a
    v_lshl_add_u32 v110, v87, 16, v7
    v_bitop3_b32 v111, v87, s58, v7 bitop3:0x6a
    v_lshl_add_u32 v112, v88, 16, v7
    v_bitop3_b32 v113, v88, s58, v7 bitop3:0x6a
    v_lshl_add_u32 v114, v89, 16, v7
    v_bitop3_b32 v115, v89, s58, v7 bitop3:0x6a
    v_lshl_add_u32 v116, v90, 16, v7
    v_bitop3_b32 v117, v90, s58, v7 bitop3:0x6a
    v_lshl_add_u32 v118, v91, 16, v7
    v_bitop3_b32 v119, v91, s58, v7 bitop3:0x6a
    v_lshl_add_u32 v120, v92, 16, v7
    v_bitop3_b32 v121, v92, s58, v7 bitop3:0x6a
    v_lshl_add_u32 v122, v93, 16, v7
    v_bitop3_b32 v123, v93, s58, v7 bitop3:0x6a
    v_max3_f32 v124, v104, v105, v106
    v_max3_f32 v125, v107, v108, v109
    v_max3_f32 v124, v124, v110, v111
    v_max3_f32 v125, v125, v112, v113
    v_max3_f32 v124, v124, v114, v115
    v_max3_f32 v125, v125, v116, v117
    v_max3_f32 v124, v124, v118, v119
    v_max3_f32 v125, v125, v120, v121
    v_max3_f32 v124, v124, v122, v123
    v_max_f32 v124, v124, v125
    v_mul_f32 v124, s60, v124
    v_pk_fma_f32 v[104:105], v[104:105], s[60:61], v[124:125] op_sel_hi:[1,1,0] neg_lo:[0,0,1] neg_hi:[0,0,1]
    v_pk_fma_f32 v[106:107], v[106:107], s[60:61], v[124:125] op_sel_hi:[1,1,0] neg_lo:[0,0,1] neg_hi:[0,0,1]
    v_pk_fma_f32 v[108:109], v[108:109], s[60:61], v[124:125] op_sel_hi:[1,1,0] neg_lo:[0,0,1] neg_hi:[0,0,1]
    v_pk_fma_f32 v[110:111], v[110:111], s[60:61], v[124:125] op_sel_hi:[1,1,0] neg_lo:[0,0,1] neg_hi:[0,0,1]
    v_pk_fma_f32 v[112:113], v[112:113], s[60:61], v[124:125] op_sel_hi:[1,1,0] neg_lo:[0,0,1] neg_hi:[0,0,1]
    v_pk_fma_f32 v[114:115], v[114:115], s[60:61], v[124:125] op_sel_hi:[1,1,0] neg_lo:[0,0,1] neg_hi:[0,0,1]
    v_pk_fma_f32 v[116:117], v[116:117], s[60:61], v[124:125] op_sel_hi:[1,1,0] neg_lo:[0,0,1] neg_hi:[0,0,1]
    v_pk_fma_f32 v[118:119], v[118:119], s[60:61], v[124:125] op_sel_hi:[1,1,0] neg_lo:[0,0,1] neg_hi:[0,0,1]
    v_pk_fma_f32 v[120:121], v[120:121], s[60:61], v[124:125] op_sel_hi:[1,1,0] neg_lo:[0,0,1] neg_hi:[0,0,1]
    v_pk_fma_f32 v[122:123], v[122:123], s[60:61], v[124:125] op_sel_hi:[1,1,0] neg_lo:[0,0,1] neg_hi:[0,0,1]
    v_exp_f32 v104, v104
    v_exp_f32 v105, v105
    v_exp_f32 v106, v106
    v_exp_f32 v107, v107
    v_exp_f32 v108, v108
    v_exp_f32 v109, v109
    v_exp_f32 v110, v110
    v_exp_f32 v111, v111
    v_exp_f32 v112, v112
    v_exp_f32 v113, v113
    v_exp_f32 v114, v114
    v_exp_f32 v115, v115
    v_exp_f32 v116, v116
    v_exp_f32 v117, v117
    v_exp_f32 v118, v118
    v_exp_f32 v119, v119
    v_exp_f32 v120, v120
    v_exp_f32 v121, v121
    v_exp_f32 v122, v122
    v_exp_f32 v123, v123
    v_pk_add_f32 v[126:127], v[104:105], v[106:107]
    v_pk_add_f32 v[124:125], v[108:109], v[110:111]
    v_pk_add_f32 v[126:127], v[126:127], v[112:113]
    v_pk_add_f32 v[124:125], v[124:125], v[114:115]
    v_pk_add_f32 v[126:127], v[126:127], v[116:117]
    v_pk_add_f32 v[124:125], v[124:125], v[118:119]
    v_pk_add_f32 v[126:127], v[126:127], v[120:121]
    v_pk_add_f32 v[124:125], v[124:125], v[122:123]
    v_pk_add_f32 v[126:127], v[126:127], v[124:125]
    v_add_f32 v126, v126, v127
    v_rcp_f32_e64 v126, v126
    s_nop 0
    v_pk_mul_f32 v[104:105], v[104:105], v[126:127] op_sel_hi:[1,0]
    v_pk_mul_f32 v[106:107], v[106:107], v[126:127] op_sel_hi:[1,0]
    v_pk_mul_f32 v[108:109], v[108:109], v[126:127] op_sel_hi:[1,0]
    v_pk_mul_f32 v[110:111], v[110:111], v[126:127] op_sel_hi:[1,0]
    v_pk_mul_f32 v[112:113], v[112:113], v[126:127] op_sel_hi:[1,0]
    v_pk_mul_f32 v[114:115], v[114:115], v[126:127] op_sel_hi:[1,0]
    v_pk_mul_f32 v[116:117], v[116:117], v[126:127] op_sel_hi:[1,0]
    v_pk_mul_f32 v[118:119], v[118:119], v[126:127] op_sel_hi:[1,0]
    v_pk_mul_f32 v[120:121], v[120:121], v[126:127] op_sel_hi:[1,0]
    v_pk_mul_f32 v[122:123], v[122:123], v[126:127] op_sel_hi:[1,0]
    v_cvt_pk_bf16_f32 v152, v104, v105
    v_cvt_pk_bf16_f32 v153, v106, v107
    v_cvt_pk_bf16_f32 v154, v108, v109
    v_cvt_pk_bf16_f32 v155, v110, v111
    v_cvt_pk_bf16_f32 v156, v112, v113
    v_cvt_pk_bf16_f32 v157, v114, v115
    v_cvt_pk_bf16_f32 v158, v116, v117
    v_cvt_pk_bf16_f32 v159, v118, v119
    v_cvt_pk_bf16_f32 v160, v120, v121
    v_cvt_pk_bf16_f32 v161, v122, v123
    s_waitcnt lgkmcnt(0)
    s_nop 0
    v_lshl_add_u32 v104, v94, 16, v7
    v_bitop3_b32 v105, v94, s58, v7 bitop3:0x6a
    v_lshl_add_u32 v106, v95, 16, v7
    v_bitop3_b32 v107, v95, s58, v7 bitop3:0x6a
    v_lshl_add_u32 v108, v96, 16, v7
    v_bitop3_b32 v109, v96, s58, v7 bitop3:0x6a
    v_lshl_add_u32 v110, v97, 16, v7
    v_bitop3_b32 v111, v97, s58, v7 bitop3:0x6a
    v_lshl_add_u32 v112, v98, 16, v7
    v_bitop3_b32 v113, v98, s58, v7 bitop3:0x6a
    v_lshl_add_u32 v114, v99, 16, v7
    v_bitop3_b32 v115, v99, s58, v7 bitop3:0x6a
    v_lshl_add_u32 v116, v100, 16, v7
    v_bitop3_b32 v117, v100, s58, v7 bitop3:0x6a
    v_lshl_add_u32 v118, v101, 16, v7
    v_bitop3_b32 v119, v101, s58, v7 bitop3:0x6a
    v_lshl_add_u32 v120, v102, 16, v7
    v_bitop3_b32 v121, v102, s58, v7 bitop3:0x6a
    v_lshl_add_u32 v122, v103, 16, v7
    v_bitop3_b32 v123, v103, s58, v7 bitop3:0x6a
    v_max3_f32 v124, v104, v105, v106
    v_max3_f32 v125, v107, v108, v109
    v_max3_f32 v124, v124, v110, v111
    v_max3_f32 v125, v125, v112, v113
    v_max3_f32 v124, v124, v114, v115
    v_max3_f32 v125, v125, v116, v117
    v_max3_f32 v124, v124, v118, v119
    v_max3_f32 v125, v125, v120, v121
    v_max3_f32 v124, v124, v122, v123
    v_max_f32 v124, v124, v125
    v_mul_f32 v124, s60, v124
    v_pk_fma_f32 v[104:105], v[104:105], s[60:61], v[124:125] op_sel_hi:[1,1,0] neg_lo:[0,0,1] neg_hi:[0,0,1]
    v_pk_fma_f32 v[106:107], v[106:107], s[60:61], v[124:125] op_sel_hi:[1,1,0] neg_lo:[0,0,1] neg_hi:[0,0,1]
    v_pk_fma_f32 v[108:109], v[108:109], s[60:61], v[124:125] op_sel_hi:[1,1,0] neg_lo:[0,0,1] neg_hi:[0,0,1]
    v_pk_fma_f32 v[110:111], v[110:111], s[60:61], v[124:125] op_sel_hi:[1,1,0] neg_lo:[0,0,1] neg_hi:[0,0,1]
    v_pk_fma_f32 v[112:113], v[112:113], s[60:61], v[124:125] op_sel_hi:[1,1,0] neg_lo:[0,0,1] neg_hi:[0,0,1]
    v_pk_fma_f32 v[114:115], v[114:115], s[60:61], v[124:125] op_sel_hi:[1,1,0] neg_lo:[0,0,1] neg_hi:[0,0,1]
    v_pk_fma_f32 v[116:117], v[116:117], s[60:61], v[124:125] op_sel_hi:[1,1,0] neg_lo:[0,0,1] neg_hi:[0,0,1]
    v_pk_fma_f32 v[118:119], v[118:119], s[60:61], v[124:125] op_sel_hi:[1,1,0] neg_lo:[0,0,1] neg_hi:[0,0,1]
    v_pk_fma_f32 v[120:121], v[120:121], s[60:61], v[124:125] op_sel_hi:[1,1,0] neg_lo:[0,0,1] neg_hi:[0,0,1]
    v_pk_fma_f32 v[122:123], v[122:123], s[60:61], v[124:125] op_sel_hi:[1,1,0] neg_lo:[0,0,1] neg_hi:[0,0,1]
    v_exp_f32 v104, v104
    v_exp_f32 v105, v105
    v_exp_f32 v106, v106
    v_exp_f32 v107, v107
    v_exp_f32 v108, v108
    v_exp_f32 v109, v109
    v_exp_f32 v110, v110
    v_exp_f32 v111, v111
    v_exp_f32 v112, v112
    v_exp_f32 v113, v113
    v_exp_f32 v114, v114
    v_exp_f32 v115, v115
    v_exp_f32 v116, v116
    v_exp_f32 v117, v117
    v_exp_f32 v118, v118
    v_exp_f32 v119, v119
    v_exp_f32 v120, v120
    v_exp_f32 v121, v121
    v_exp_f32 v122, v122
    v_exp_f32 v123, v123
    v_pk_add_f32 v[126:127], v[104:105], v[106:107]
    v_pk_add_f32 v[124:125], v[108:109], v[110:111]
    v_pk_add_f32 v[126:127], v[126:127], v[112:113]
    v_pk_add_f32 v[124:125], v[124:125], v[114:115]
    v_pk_add_f32 v[126:127], v[126:127], v[116:117]
    v_pk_add_f32 v[124:125], v[124:125], v[118:119]
    v_pk_add_f32 v[126:127], v[126:127], v[120:121]
    v_pk_add_f32 v[124:125], v[124:125], v[122:123]
    v_pk_add_f32 v[126:127], v[126:127], v[124:125]
    v_add_f32 v126, v126, v127
    v_rcp_f32_e64 v126, v126
    s_nop 0
    v_pk_mul_f32 v[104:105], v[104:105], v[126:127] op_sel_hi:[1,0]
    v_pk_mul_f32 v[106:107], v[106:107], v[126:127] op_sel_hi:[1,0]
    v_pk_mul_f32 v[108:109], v[108:109], v[126:127] op_sel_hi:[1,0]
    v_pk_mul_f32 v[110:111], v[110:111], v[126:127] op_sel_hi:[1,0]
    v_pk_mul_f32 v[112:113], v[112:113], v[126:127] op_sel_hi:[1,0]
    v_pk_mul_f32 v[114:115], v[114:115], v[126:127] op_sel_hi:[1,0]
    v_pk_mul_f32 v[116:117], v[116:117], v[126:127] op_sel_hi:[1,0]
    v_pk_mul_f32 v[118:119], v[118:119], v[126:127] op_sel_hi:[1,0]
    v_pk_mul_f32 v[120:121], v[120:121], v[126:127] op_sel_hi:[1,0]
    v_pk_mul_f32 v[122:123], v[122:123], v[126:127] op_sel_hi:[1,0]
    v_cvt_pk_bf16_f32 v164, v104, v105
    v_cvt_pk_bf16_f32 v165, v106, v107
    v_cvt_pk_bf16_f32 v166, v108, v109
    v_cvt_pk_bf16_f32 v167, v110, v111
    v_cvt_pk_bf16_f32 v168, v112, v113
    v_cvt_pk_bf16_f32 v169, v114, v115
    v_cvt_pk_bf16_f32 v170, v116, v117
    v_cvt_pk_bf16_f32 v171, v118, v119
    v_cvt_pk_bf16_f32 v172, v120, v121
    v_cvt_pk_bf16_f32 v173, v122, v123
    v_mov_b32 v26, 0
    v_mov_b32 v27, 0
    v_mov_b32 v14, 159752
    s_mov_b32 s101, 0x200000
L_lw_40:
    ds_read_b32 v15, v14
    s_waitcnt lgkmcnt(0)
    v_cmp_le_u32 vcc, 4, v15
    s_cbranch_vccnz L_lwd_41
    s_sub_u32 s101, s101, 1
    s_cmp_eq_u32 s101, 0
    s_cbranch_scc0 L_lw_40
    s_endpgm
L_lwd_41:
    ds_read_b128 v[32:35], v2 offset:0
    ds_read_b128 v[36:39], v2 offset:5120
    ds_read_b128 v[40:43], v2 offset:10240
    ds_read_b128 v[44:47], v2 offset:15360
    ds_read_b128 v[48:51], v2 offset:1024
    ds_read_b128 v[52:55], v2 offset:6144
    ds_read_b128 v[56:59], v2 offset:11264
    ds_read_b128 v[60:63], v2 offset:16384
    ds_read_b128 v[64:67], v2 offset:2048
    ds_read_b128 v[68:71], v2 offset:7168
    ds_read_b128 v[72:75], v2 offset:12288
    ds_read_b128 v[76:79], v2 offset:17408
    ds_read_b128 v[80:83], v2 offset:3072
    ds_read_b128 v[84:87], v2 offset:8192
    ds_read_b128 v[88:91], v2 offset:13312
    ds_read_b128 v[92:95], v2 offset:18432
    ds_read_b128 v[96:99], v2 offset:4096
    ds_read_b128 v[100:103], v2 offset:9216
    ds_read_b128 v[104:107], v2 offset:14336
    ds_read_b128 v[108:111], v2 offset:19456
    s_waitcnt lgkmcnt(15)
    v_pk_add_f32 v[32:33], v[32:33], v[36:37]
    v_pk_add_f32 v[40:41], v[40:41], v[44:45]
    v_pk_add_f32 v[34:35], v[34:35], v[38:39]
    v_pk_add_f32 v[42:43], v[42:43], v[46:47]
    v_pk_add_f32 v[32:33], v[32:33], v[40:41]
    v_pk_add_f32 v[34:35], v[34:35], v[42:43]
    v_cvt_pk_bf16_f32 v16, v32, v33
    v_cvt_pk_bf16_f32 v17, v34, v35
    s_waitcnt lgkmcnt(12)
    s_nop 0
    v_pk_add_f32 v[48:49], v[48:49], v[52:53]
    v_pk_add_f32 v[56:57], v[56:57], v[60:61]
    v_pk_add_f32 v[50:51], v[50:51], v[54:55]
    v_pk_add_f32 v[58:59], v[58:59], v[62:63]
    v_pk_add_f32 v[48:49], v[48:49], v[56:57]
    v_pk_add_f32 v[50:51], v[50:51], v[58:59]
    v_cvt_pk_bf16_f32 v18, v48, v49
    v_cvt_pk_bf16_f32 v19, v50, v51
    s_waitcnt lgkmcnt(8)
    s_nop 0
    v_pk_add_f32 v[64:65], v[64:65], v[68:69]
    v_pk_add_f32 v[72:73], v[72:73], v[76:77]
    v_pk_add_f32 v[66:67], v[66:67], v[70:71]
    v_pk_add_f32 v[74:75], v[74:75], v[78:79]
    v_pk_add_f32 v[64:65], v[64:65], v[72:73]
    v_pk_add_f32 v[66:67], v[66:67], v[74:75]
    v_cvt_pk_bf16_f32 v20, v64, v65
    v_cvt_pk_bf16_f32 v21, v66, v67
    s_waitcnt lgkmcnt(4)
    s_nop 0
    v_pk_add_f32 v[80:81], v[80:81], v[84:85]
    v_pk_add_f32 v[88:89], v[88:89], v[92:93]
    v_pk_add_f32 v[82:83], v[82:83], v[86:87]
    v_pk_add_f32 v[90:91], v[90:91], v[94:95]
    v_pk_add_f32 v[80:81], v[80:81], v[88:89]
    v_pk_add_f32 v[82:83], v[82:83], v[90:91]
    v_cvt_pk_bf16_f32 v22, v80, v81
    v_cvt_pk_bf16_f32 v23, v82, v83
    s_waitcnt lgkmcnt(0)
    v_pk_add_f32 v[96:97], v[96:97], v[100:101]
    v_pk_add_f32 v[104:105], v[104:105], v[108:109]
    v_pk_add_f32 v[98:99], v[98:99], v[102:103]
    v_pk_add_f32 v[106:107], v[106:107], v[110:111]
    v_pk_add_f32 v[96:97], v[96:97], v[104:105]
    v_pk_add_f32 v[98:99], v[98:99], v[106:107]
    v_cvt_pk_bf16_f32 v24, v96, v97
    v_cvt_pk_bf16_f32 v25, v98, v99
    v_mfma_f32_32x32x16_bf16 v[176:191], v[16:19], v[128:131], 0
    v_mfma_f32_32x32x16_bf16 v[176:191], v[20:23], v[132:135], v[176:191]
    v_mfma_f32_32x32x16_bf16 v[176:191], v[24:27], v[136:139], v[176:191]
    v_mfma_f32_32x32x16_bf16 v[192:207], v[16:19], v[140:143], 0
    v_mfma_f32_32x32x16_bf16 v[192:207], v[20:23], v[144:147], v[192:207]
    v_mfma_f32_32x32x16_bf16 v[192:207], v[24:27], v[148:151], v[192:207]
    s_nop 8
    v_add_f32 v10, 0x358637bd, v188
    v_rcp_f32_e64 v10, v10
    v_mfma_f32_32x32x16_bf16 v[208:223], v[16:19], v[152:155], 0
    v_mfma_f32_32x32x16_bf16 v[208:223], v[20:23], v[156:159], v[208:223]
    v_mfma_f32_32x32x16_bf16 v[208:223], v[24:27], v[160:163], v[208:223]
    v_mul_f32 v176, v10, v176
    v_mul_f32 v177, v10, v177
    v_mul_f32 v178, v10, v178
    v_mul_f32 v179, v10, v179
    v_mul_f32 v180, v10, v180
    v_mul_f32 v181, v10, v181
    v_mul_f32 v182, v10, v182
    v_mul_f32 v183, v10, v183
    v_mul_f32 v184, v10, v184
    v_mul_f32 v185, v10, v185
    v_mul_f32 v186, v10, v186
    v_mul_f32 v187, v10, v187
    v_cvt_pk_bf16_f32 v32, v176, v177
    v_cvt_pk_bf16_f32 v33, v178, v179
    v_cvt_pk_bf16_f32 v34, v180, v181
    v_cvt_pk_bf16_f32 v35, v182, v183
    v_cvt_pk_bf16_f32 v36, v184, v185
    v_cvt_pk_bf16_f32 v37, v186, v187
    buffer_store_dwordx4 v[32:35], v2, s[44:47], s54 offen sc1
    s_mov_b32 exec_hi, 0
    buffer_store_dwordx2 v[36:37], v3, s[44:47], s59 offen sc1
    s_mov_b64 exec, -1
    s_add_u32 s54, s54, 40960
    s_add_u32 s59, s59, 40960
    v_add_f32 v10, 0x358637bd, v204
    v_rcp_f32_e64 v10, v10
    v_mfma_f32_32x32x16_bf16 v[224:239], v[16:19], v[164:167], 0
    v_mfma_f32_32x32x16_bf16 v[224:239], v[20:23], v[168:171], v[224:239]
    v_mfma_f32_32x32x16_bf16 v[224:239], v[24:27], v[172:175], v[224:239]
    v_mul_f32 v192, v10, v192
    v_mul_f32 v193, v10, v193
    v_mul_f32 v194, v10, v194
    v_mul_f32 v195, v10, v195
    v_mul_f32 v196, v10, v196
    v_mul_f32 v197, v10, v197
    v_mul_f32 v198, v10, v198
    v_mul_f32 v199, v10, v199
    v_mul_f32 v200, v10, v200
    v_mul_f32 v201, v10, v201
    v_mul_f32 v202, v10, v202
    v_mul_f32 v203, v10, v203
    v_cvt_pk_bf16_f32 v40, v192, v193
    v_cvt_pk_bf16_f32 v41, v194, v195
    v_cvt_pk_bf16_f32 v42, v196, v197
    v_cvt_pk_bf16_f32 v43, v198, v199
    v_cvt_pk_bf16_f32 v44, v200, v201
    v_cvt_pk_bf16_f32 v45, v202, v203
    buffer_store_dwordx4 v[40:43], v2, s[44:47], s54 offen sc1
    s_mov_b32 exec_hi, 0
    buffer_store_dwordx2 v[44:45], v3, s[44:47], s59 offen sc1
    s_mov_b64 exec, -1
    s_add_u32 s54, s54, 40960
    s_add_u32 s59, s59, 40960
    v_add_f32 v10, 0x358637bd, v220
    v_rcp_f32 v10, v10
    s_nop 0
    v_pk_mul_f32 v[208:209], v[208:209], v[10:11] op_sel_hi:[1,0]
    v_pk_mul_f32 v[210:211], v[210:211], v[10:11] op_sel_hi:[1,0]
    v_pk_mul_f32 v[212:213], v[212:213], v[10:11] op_sel_hi:[1,0]
    v_pk_mul_f32 v[214:215], v[214:215], v[10:11] op_sel_hi:[1,0]
    v_pk_mul_f32 v[216:217], v[216:217], v[10:11] op_sel_hi:[1,0]
    v_pk_mul_f32 v[218:219], v[218:219], v[10:11] op_sel_hi:[1,0]
    v_cvt_pk_bf16_f32 v48, v208, v209
    v_cvt_pk_bf16_f32 v49, v210, v211
    v_cvt_pk_bf16_f32 v50, v212, v213
    v_cvt_pk_bf16_f32 v51, v214, v215
    v_cvt_pk_bf16_f32 v52, v216, v217
    v_cvt_pk_bf16_f32 v53, v218, v219
    buffer_store_dwordx4 v[48:51], v2, s[44:47], s54 offen sc1
    s_mov_b32 exec_hi, 0
    buffer_store_dwordx2 v[52:53], v3, s[44:47], s59 offen sc1
    s_mov_b64 exec, -1
    s_add_u32 s54, s54, 40960
    s_add_u32 s59, s59, 40960
    v_add_f32 v10, 0x358637bd, v236
    v_rcp_f32 v10, v10
    s_nop 0
    v_pk_mul_f32 v[224:225], v[224:225], v[10:11] op_sel_hi:[1,0]
    v_pk_mul_f32 v[226:227], v[226:227], v[10:11] op_sel_hi:[1,0]
    v_pk_mul_f32 v[228:229], v[228:229], v[10:11] op_sel_hi:[1,0]
    v_pk_mul_f32 v[230:231], v[230:231], v[10:11] op_sel_hi:[1,0]
    v_pk_mul_f32 v[232:233], v[232:233], v[10:11] op_sel_hi:[1,0]
    v_pk_mul_f32 v[234:235], v[234:235], v[10:11] op_sel_hi:[1,0]
    v_cvt_pk_bf16_f32 v56, v224, v225
    v_cvt_pk_bf16_f32 v57, v226, v227
    v_cvt_pk_bf16_f32 v58, v228, v229
    v_cvt_pk_bf16_f32 v59, v230, v231
    v_cvt_pk_bf16_f32 v60, v232, v233
    v_cvt_pk_bf16_f32 v61, v234, v235
    buffer_store_dwordx4 v[56:59], v2, s[44:47], s54 offen sc1
    s_mov_b32 exec_hi, 0
    buffer_store_dwordx2 v[60:61], v3, s[44:47], s59 offen sc1
    s_mov_b64 exec, -1
    v_mov_b32 v12, s30
    v_mov_b32 v13, s31
    v_lshlrev_b32 v14, 3, v1
    s_waitcnt vmcnt(0)
    s_mov_b64 exec, 0xffff
    buffer_store_dwordx2 v[12:13], v14, s[44:47], s50 offen sc1
    s_mov_b64 exec, -1
    v_mov_b32 v16, 159756
    v_mov_b32 v17, 1
    s_waitcnt lgkmcnt(0)
    s_mov_b64 exec, 1
    ds_add_u32 v16, v17
    s_mov_b64 exec, -1
    s_endpgm
L_q_29:
    s_nop 0
    v_mfma_f32_16x16x32_bf16 v[16:19], v[188:191], v[96:99], 0
    s_mov_b32 s57, 81920
    v_mul_lo_u32 v12, s57, v187
    v_mfma_f32_16x16x32_bf16 v[20:23], v[200:203], v[96:99], 0
    v_lshl_add_u32 v2, v183, 4, v12
    v_lshl_add_u32 v3, v183, 3, v12
    v_mfma_f32_16x16x32_bf16 v[24:27], v[212:215], v[96:99], 0
    s_lshl_b32 s58, s49, 1
    s_add_u32 s58, s58, s52
    v_mfma_f32_16x16x32_bf16 v[28:31], v[224:227], v[96:99], 0
    s_lshl_b32 s59, s50, 1
    s_add_u32 s59, s59, s53
    v_mfma_f32_16x16x32_bf16 v[32:35], v[236:239], v[96:99], 0
    s_lshl_b32 s59, s59, 5
    s_add_u32 s59, s59, s58
    v_mfma_f32_16x16x32_bf16 v[16:19], v[192:195], v[100:103], v[16:19]
    s_lshl_b32 s59, s59, 7
    s_add_u32 s59, s59, 0xf10000
    v_mfma_f32_16x16x32_bf16 v[20:23], v[204:207], v[100:103], v[20:23]
    s_lshl_b32 s57, s50, 8
    s_add_u32 s57, s57, s58
    v_mfma_f32_16x16x32_bf16 v[24:27], v[216:219], v[100:103], v[24:27]
    s_mul_i32 s57, s57, 2560
    v_cvt_pk_bf16_f32 v118, v56, v57
    v_mfma_f32_16x16x32_bf16 v[28:31], v[228:231], v[100:103], v[28:31]
    v_cvt_pk_bf16_f32 v119, v58, v59
    v_cvt_pk_bf16_f32 v120, v60, v61
    v_mfma_f32_16x16x32_bf16 v[32:35], v[240:243], v[100:103], v[32:35]
    v_cvt_pk_bf16_f32 v121, v62, v63
    v_cvt_pk_bf16_f32 v122, v64, v65
    v_mfma_f32_16x16x32_bf16 v[16:19], v[196:199], v[104:107], v[16:19]
    v_cvt_pk_bf16_f32 v123, v66, v67
    v_cvt_pk_bf16_f32 v124, v68, v69
    v_mfma_f32_16x16x32_bf16 v[20:23], v[208:211], v[104:107], v[20:23]
    v_cvt_pk_bf16_f32 v125, v70, v71
    v_cvt_pk_bf16_f32 v126, v72, v73
    v_mfma_f32_16x16x32_bf16 v[24:27], v[220:223], v[104:107], v[24:27]
    v_cvt_pk_bf16_f32 v127, v74, v75
    v_mfma_f32_16x16x32_bf16 v[28:31], v[232:235], v[104:107], v[28:31]
    v_mfma_f32_16x16x32_bf16 v[32:35], v[244:247], v[104:107], v[32:35]
    v_mfma_f32_16x16x32_bf16 v[36:39], v[188:191], v[106:109], 0
    v_cvt_pk_bf16_f32 v128, v76, v77
    v_cvt_pk_bf16_f32 v129, v78, v79
    v_mfma_f32_16x16x32_bf16 v[40:43], v[200:203], v[106:109], 0
    v_cvt_pk_bf16_f32 v130, v80, v81
    v_cvt_pk_bf16_f32 v131, v82, v83
    v_mfma_f32_16x16x32_bf16 v[44:47], v[212:215], v[106:109], 0
    v_cvt_pk_bf16_f32 v132, v84, v85
    v_cvt_pk_bf16_f32 v133, v86, v87
    v_mfma_f32_16x16x32_bf16 v[48:51], v[224:227], v[106:109], 0
    v_cvt_pk_bf16_f32 v134, v88, v89
    v_cvt_pk_bf16_f32 v135, v90, v91
    v_mfma_f32_16x16x32_bf16 v[52:55], v[236:239], v[106:109], 0
    v_cvt_pk_bf16_f32 v136, v92, v93
    v_cvt_pk_bf16_f32 v137, v94, v95
    v_mfma_f32_16x16x32_bf16 v[36:39], v[192:195], v[110:113], v[36:39]
    v_mov_b32 v138, 0x3f803f80
    v_mov_b32 v139, 0x3f803f80
    v_mfma_f32_16x16x32_bf16 v[40:43], v[204:207], v[110:113], v[40:43]
    v_cvt_pk_bf16_f32 v140, v16, v17
    v_cvt_pk_bf16_f32 v141, v18, v19
    v_mfma_f32_16x16x32_bf16 v[44:47], v[216:219], v[110:113], v[44:47]
    v_cvt_pk_bf16_f32 v142, v20, v21
    v_cvt_pk_bf16_f32 v143, v22, v23
    v_mfma_f32_16x16x32_bf16 v[48:51], v[228:231], v[110:113], v[48:51]
    v_cvt_pk_bf16_f32 v144, v24, v25
    v_cvt_pk_bf16_f32 v145, v26, v27
    v_mfma_f32_16x16x32_bf16 v[52:55], v[240:243], v[110:113], v[52:55]
    v_cvt_pk_bf16_f32 v146, v28, v29
    v_cvt_pk_bf16_f32 v147, v30, v31
    v_mfma_f32_16x16x32_bf16 v[36:39], v[196:199], v[114:117], v[36:39]
    v_cvt_pk_bf16_f32 v148, v32, v33
    v_cvt_pk_bf16_f32 v149, v34, v35
    v_mfma_f32_16x16x32_bf16 v[40:43], v[208:211], v[114:117], v[40:43]
    buffer_store_dwordx4 v[140:143], v2, s[44:47], s57 offen offset:0 sc1
    buffer_store_dwordx4 v[144:147], v2, s[44:47], s57 offen offset:512 sc1
    v_mfma_f32_16x16x32_bf16 v[44:47], v[220:223], v[114:117], v[44:47]
    buffer_store_dwordx2 v[148:149], v3, s[44:47], s57 offen offset:1024 sc1
    v_mfma_f32_16x16x32_bf16 v[48:51], v[232:235], v[114:117], v[48:51]
    v_mfma_f32_16x16x32_bf16 v[52:55], v[244:247], v[114:117], v[52:55]
    v_mfma_f32_16x16x32_bf16 v[56:59], v[188:191], v[118:121], 0
    v_mfma_f32_16x16x32_bf16 v[60:63], v[200:203], v[118:121], 0
    v_mfma_f32_16x16x32_bf16 v[64:67], v[212:215], v[118:121], 0
    v_mfma_f32_16x16x32_bf16 v[68:71], v[224:227], v[118:121], 0
    v_mfma_f32_16x16x32_bf16 v[72:75], v[236:239], v[118:121], 0
    v_mfma_f32_16x16x32_bf16 v[56:59], v[192:195], v[122:125], v[56:59]
    v_mfma_f32_16x16x32_bf16 v[60:63], v[204:207], v[122:125], v[60:63]
    v_cvt_pk_bf16_f32 v150, v36, v37
    v_cvt_pk_bf16_f32 v151, v38, v39
    v_mfma_f32_16x16x32_bf16 v[64:67], v[216:219], v[122:125], v[64:67]
    v_cvt_pk_bf16_f32 v152, v40, v41
    v_cvt_pk_bf16_f32 v153, v42, v43
    v_mfma_f32_16x16x32_bf16 v[68:71], v[228:231], v[122:125], v[68:71]
    v_cvt_pk_bf16_f32 v154, v44, v45
    v_cvt_pk_bf16_f32 v155, v46, v47
    v_mfma_f32_16x16x32_bf16 v[72:75], v[240:243], v[122:125], v[72:75]
    v_cvt_pk_bf16_f32 v156, v48, v49
    v_cvt_pk_bf16_f32 v157, v50, v51
    v_mfma_f32_16x16x32_bf16 v[56:59], v[196:199], v[126:129], v[56:59]
    v_cvt_pk_bf16_f32 v158, v52, v53
    v_cvt_pk_bf16_f32 v159, v54, v55
    v_mfma_f32_16x16x32_bf16 v[60:63], v[208:211], v[126:129], v[60:63]
    buffer_store_dwordx4 v[150:153], v2, s[44:47], s57 offen offset:256 sc1
    buffer_store_dwordx4 v[154:157], v2, s[44:47], s57 offen offset:768 sc1
    v_mfma_f32_16x16x32_bf16 v[64:67], v[220:223], v[126:129], v[64:67]
    buffer_store_dwordx2 v[158:159], v3, s[44:47], s57 offen offset:1152 sc1
    v_mfma_f32_16x16x32_bf16 v[68:71], v[232:235], v[126:129], v[68:71]
    v_mfma_f32_16x16x32_bf16 v[72:75], v[244:247], v[126:129], v[72:75]
    v_mfma_f32_16x16x32_bf16 v[76:79], v[188:191], v[128:131], 0
    v_mfma_f32_16x16x32_bf16 v[80:83], v[200:203], v[128:131], 0
    v_mfma_f32_16x16x32_bf16 v[84:87], v[212:215], v[128:131], 0
    v_mfma_f32_16x16x32_bf16 v[88:91], v[224:227], v[128:131], 0
    v_mfma_f32_16x16x32_bf16 v[92:95], v[236:239], v[128:131], 0
    v_mfma_f32_16x16x32_bf16 v[76:79], v[192:195], v[132:135], v[76:79]
    v_mfma_f32_16x16x32_bf16 v[80:83], v[204:207], v[132:135], v[80:83]
    v_cvt_pk_bf16_f32 v160, v56, v57
    v_cvt_pk_bf16_f32 v161, v58, v59
    v_mfma_f32_16x16x32_bf16 v[84:87], v[216:219], v[132:135], v[84:87]
    v_cvt_pk_bf16_f32 v162, v60, v61
    v_cvt_pk_bf16_f32 v163, v62, v63
    v_mfma_f32_16x16x32_bf16 v[88:91], v[228:231], v[132:135], v[88:91]
    v_cvt_pk_bf16_f32 v164, v64, v65
    v_cvt_pk_bf16_f32 v165, v66, v67
    v_mfma_f32_16x16x32_bf16 v[92:95], v[240:243], v[132:135], v[92:95]
    v_cvt_pk_bf16_f32 v166, v68, v69
    v_cvt_pk_bf16_f32 v167, v70, v71
    v_mfma_f32_16x16x32_bf16 v[76:79], v[196:199], v[136:139], v[76:79]
    v_cvt_pk_bf16_f32 v168, v72, v73
    v_cvt_pk_bf16_f32 v169, v74, v75
    v_mfma_f32_16x16x32_bf16 v[80:83], v[208:211], v[136:139], v[80:83]
    buffer_store_dwordx4 v[160:163], v2, s[44:47], s57 offen offset:1280 sc1
    buffer_store_dwordx4 v[164:167], v2, s[44:47], s57 offen offset:1792 sc1
    v_mfma_f32_16x16x32_bf16 v[84:87], v[220:223], v[136:139], v[84:87]
    buffer_store_dwordx2 v[168:169], v3, s[44:47], s57 offen offset:2304 sc1
    v_mfma_f32_16x16x32_bf16 v[88:91], v[232:235], v[136:139], v[88:91]
    v_mfma_f32_16x16x32_bf16 v[92:95], v[244:247], v[136:139], v[92:95]
    v_cvt_pk_bf16_f32 v170, v76, v77
    v_cvt_pk_bf16_f32 v171, v78, v79
    v_cvt_pk_bf16_f32 v172, v80, v81
    v_cvt_pk_bf16_f32 v173, v82, v83
    s_nop 0
    s_nop 0
    v_cvt_pk_bf16_f32 v174, v84, v85
    v_cvt_pk_bf16_f32 v175, v86, v87
    v_cvt_pk_bf16_f32 v176, v88, v89
    v_cvt_pk_bf16_f32 v177, v90, v91
    v_cvt_pk_bf16_f32 v178, v92, v93
    v_cvt_pk_bf16_f32 v179, v94, v95
    buffer_store_dwordx4 v[170:173], v2, s[44:47], s57 offen offset:1536 sc1
    buffer_store_dwordx4 v[174:177], v2, s[44:47], s57 offen offset:2048 sc1
    buffer_store_dwordx2 v[178:179], v3, s[44:47], s57 offen offset:2432 sc1
    s_waitcnt lgkmcnt(0)
    s_cmp_lg_u32 s30, s31
    s_cbranch_scc1 L_hsd_43
    s_mov_b32 s101, 0x10000
    v_mov_b32 v12, 0
L_hs_42:
    global_load_dwordx2 v[10:11], v12, s[26:27] sc1
    s_waitcnt vmcnt(0)
    v_readfirstlane_b32 s30, v10
    v_readfirstlane_b32 s31, v11
    s_nop 3
    s_cmp_lg_u32 s30, s31
    s_cbranch_scc1 L_hsd_43
    s_sleep 8
    s_sub_u32 s101, s101, 1
    s_cmp_eq_u32 s101, 0
    s_cbranch_scc0 L_hs_42
    s_endpgm
L_hsd_43:
    v_mov_b32 v10, s30
    v_mov_b32 v11, s31
    v_lshlrev_b32_e64 v12, 3, v1
    s_waitcnt vmcnt(0)
    s_mov_b64 exec, 0xffff
    buffer_store_dwordx2 v[10:11], v12, s[44:47], s59 offen sc1
    s_mov_b64 exec, -1
    v_mov_b32 v14, 159744
    v_mov_b32 v15, 1
    s_waitcnt lgkmcnt(0)
    s_mov_b64 exec, 1
    ds_add_u32 v14, v15
    s_mov_b64 exec, -1
    s_mov_b32 s101, 0x200000
L_lw_44:
    ds_read_b32 v15, v14
    s_waitcnt lgkmcnt(0)
    v_cmp_le_u32 vcc, 8, v15
    s_cbranch_vccnz L_lwd_45
    s_sleep 2
    s_sub_u32 s101, s101, 1
    s_cmp_eq_u32 s101, 0
    s_cbranch_scc0 L_lw_44
    s_endpgm
L_lwd_45:
    s_setprio 0
    s_cmp_lt_u32 s99, 4
    s_cbranch_scc1 L_wo
    s_cmp_lt_u32 s48, 4
    s_cbranch_scc1 L_post
    s_endpgm
L_b:
    s_cmp_ge_u32 s2, 256
    s_cbranch_scc1 L_exit
    s_mov_b32 s48, s100
    s_cmp_ge_u32 s48, 5
    s_cbranch_scc1 L_help
    s_lshl_b32 s49, s98, 3
    s_add_u32 s49, s49, s99
    s_sub_u32 s49, s49, 24
    s_mul_i32 s49, s49, 5
    s_add_u32 s49, s49, s48
    s_and_b32 s50, s49, 31
    s_lshr_b32 s51, s49, 5
    s_mul_i32 s52, s50, 81920
    s_lshl_b32 s53, s51, 7
    s_add_u32 s52, s52, s53
    v_lshrrev_b32 v2, 3, v1
    v_and_b32 v3, 7, v1
    v_mul_u32_u24 v4, 10240, v2
    v_lshl_add_u32 v4, v3, 4, v4
    v_add_u32_e64 v5, s52, v4
    v_subrev_u32 v6, 3840, v5
    v_subrev_u32 v7, 2560, v5
    v_subrev_u32 v8, 1280, v5
    v_lshlrev_b32 v9, 6, v3
    s_lshl_b32 s54, s51, 9
    s_movk_i32 s55, 5120
    s_waitcnt lgkmcnt(0)
    s_mov_b32 s32, s14
    s_mov_b32 s33, s15
    s_mov_b32 s34, 0x280000
    s_mov_b32 s35, 0x20000
    s_mov_b32 s36, s16
    s_mov_b32 s37, s17
    s_mov_b32 s38, 0x280000
    s_mov_b32 s39, 0x20000
    s_mov_b32 s40, s18
    s_mov_b32 s41, s19
    s_mov_b32 s42, 0x1400
    s_mov_b32 s43, 0x20000
    buffer_load_dwordx4 v[16:19], v9, s[40:43], s54 offen offset:0
    buffer_load_dwordx4 v[20:23], v9, s[40:43], s54 offen offset:16
    buffer_load_dwordx4 v[24:27], v9, s[40:43], s54 offen offset:32
    buffer_load_dwordx4 v[28:31], v9, s[40:43], s54 offen offset:48
    buffer_load_dwordx4 v[32:35], v6, s[32:35], 0 offen
    buffer_load_dwordx4 v[36:39], v7, s[32:35], 0 offen
    buffer_load_dwordx4 v[40:43], v8, s[32:35], 0 offen
    buffer_load_dwordx4 v[64:67], v5, s[32:35], s55 offen offset:1280
    buffer_load_dwordx4 v[68:71], v5, s[32:35], s55 offen offset:2560
    buffer_load_dwordx4 v[72:75], v5, s[32:35], s55 offen offset:3840
    buffer_load_dwordx4 v[44:47], v5, s[32:35], 0 offen offset:0
    buffer_load_dwordx4 v[76:79], v5, s[36:39], 0 offen offset:0
    buffer_load_dwordx4 v[48:51], v5, s[32:35], 0 offen offset:1280
    buffer_load_dwordx4 v[80:83], v5, s[36:39], 0 offen offset:1280
    s_mov_b32 s44, s28
    s_mov_b32 s45, s29
    s_mov_b32 s46, 0x1100000
    s_mov_b32 s47, 0x20000
    s_mul_i32 s56, s48, 8320
    s_add_u32 s56, s56, 70144
    v_mul_u32_u24 v10, 1040, v3
    v_lshl_add_u32 v10, v2, 4, v10
    v_add_u32 v10, s56, v10
    v_lshrrev_b32 v11, 4, v1
    v_lshlrev_b32 v11, 8, v11
    v_and_b32 v12, 3, v1
    v_lshl_add_u32 v11, v12, 6, v11
    v_bfe_u32 v12, v1, 2, 2
    v_lshl_add_u32 v11, v12, 3, v11
    v_add_u32_e64 v11, s56, v11
    v_mul_u32_u24 v12, 4352, v2
    v_lshl_add_u32 v12, v3, 4, v12
    s_mul_i32 s57, s51, 278528
    s_lshl_b32 s58, s50, 7
    s_add_u32 s57, s57, s58
    s_add_u32 s57, s57, 0x740000
    s_mov_b32 s59, 0xffff0000
    s_waitcnt vmcnt(10)
    buffer_load_dwordx4 v[52:55], v5, s[32:35], 0 offen offset:2560
    buffer_load_dwordx4 v[84:87], v5, s[36:39], 0 offen offset:2560
    v_lshlrev_b32 v108, 16, v16
    v_and_b32 v116, s59, v16
    v_lshlrev_b32 v124, 16, v17
    v_and_b32 v132, s59, v17
    v_lshlrev_b32 v109, 16, v18
    v_and_b32 v117, s59, v18
    v_lshlrev_b32 v125, 16, v19
    v_and_b32 v133, s59, v19
    v_lshlrev_b32 v110, 16, v20
    v_and_b32 v118, s59, v20
    v_lshlrev_b32 v126, 16, v21
    v_and_b32 v134, s59, v21
    v_lshlrev_b32 v111, 16, v22
    v_and_b32 v119, s59, v22
    v_lshlrev_b32 v127, 16, v23
    v_and_b32 v135, s59, v23
    v_lshlrev_b32 v112, 16, v24
    v_and_b32 v120, s59, v24
    v_lshlrev_b32 v128, 16, v25
    v_and_b32 v136, s59, v25
    v_lshlrev_b32 v113, 16, v26
    v_and_b32 v121, s59, v26
    v_lshlrev_b32 v129, 16, v27
    v_and_b32 v137, s59, v27
    v_lshlrev_b32 v114, 16, v28
    v_and_b32 v122, s59, v28
    v_lshlrev_b32 v130, 16, v29
    v_and_b32 v138, s59, v29
    v_lshlrev_b32 v115, 16, v30
    v_and_b32 v123, s59, v30
    v_lshlrev_b32 v131, 16, v31
    v_and_b32 v139, s59, v31
    s_waitcnt vmcnt(9)
    buffer_load_dwordx4 v[56:59], v5, s[32:35], 0 offen offset:3840
    buffer_load_dwordx4 v[88:91], v5, s[36:39], 0 offen offset:3840
    v_lshlrev_b32 v140, 16, v32
    v_and_b32 v141, s59, v32
    v_lshlrev_b32 v142, 16, v33
    v_and_b32 v143, s59, v33
    v_lshlrev_b32 v144, 16, v34
    v_and_b32 v145, s59, v34
    v_lshlrev_b32 v146, 16, v35
    v_and_b32 v147, s59, v35
    v_lshlrev_b32 v148, 16, v36
    v_and_b32 v149, s59, v36
    v_lshlrev_b32 v150, 16, v37
    v_and_b32 v151, s59, v37
    v_lshlrev_b32 v152, 16, v38
    v_and_b32 v153, s59, v38
    v_lshlrev_b32 v154, 16, v39
    v_and_b32 v155, s59, v39
    v_lshlrev_b32 v156, 16, v40
    v_and_b32 v157, s59, v40
    v_lshlrev_b32 v158, 16, v41
    v_and_b32 v159, s59, v41
    v_lshlrev_b32 v160, 16, v42
    v_and_b32 v161, s59, v42
    v_lshlrev_b32 v162, 16, v43
    v_and_b32_e64 v163, s59, v43
    s_waitcnt vmcnt(6)
    buffer_load_dwordx4 v[60:63], v5, s[32:35], s55 offen offset:0
    buffer_load_dwordx4 v[92:95], v5, s[36:39], s55 offen offset:0
    v_lshlrev_b32 v164, 16, v44
    v_and_b32 v165, s59, v44
    v_lshlrev_b32 v166, 16, v45
    v_and_b32 v167, s59, v45
    v_lshlrev_b32 v168, 16, v46
    v_and_b32 v169, s59, v46
    v_lshlrev_b32 v170, 16, v47
    v_and_b32 v171, s59, v47
    v_lshlrev_b32 v172, 16, v76
    v_and_b32 v173, s59, v76
    v_lshlrev_b32 v174, 16, v77
    v_and_b32 v175, s59, v77
    v_lshlrev_b32 v176, 16, v78
    v_and_b32 v177, s59, v78
    v_lshlrev_b32 v178, 16, v79
    v_and_b32 v179, s59, v79
    v_pk_mul_f32 v[180:181], v[140:141], v[132:133]
    v_pk_mul_f32 v[182:183], v[142:143], v[134:135]
    v_pk_mul_f32 v[184:185], v[144:145], v[136:137]
    v_pk_mul_f32 v[186:187], v[146:147], v[138:139]
    v_pk_fma_f32 v[180:181], v[148:149], v[124:125], v[180:181]
    v_pk_fma_f32 v[182:183], v[150:151], v[126:127], v[182:183]
    v_pk_fma_f32 v[184:185], v[152:153], v[128:129], v[184:185]
    v_pk_fma_f32 v[186:187], v[154:155], v[130:131], v[186:187]
    v_pk_fma_f32 v[180:181], v[156:157], v[116:117], v[180:181]
    v_pk_fma_f32 v[182:183], v[158:159], v[118:119], v[182:183]
    v_pk_fma_f32 v[184:185], v[160:161], v[120:121], v[184:185]
    v_pk_fma_f32 v[186:187], v[162:163], v[122:123], v[186:187]
    v_pk_fma_f32 v[180:181], v[164:165], v[108:109], v[180:181]
    v_pk_fma_f32 v[182:183], v[166:167], v[110:111], v[182:183]
    v_pk_fma_f32 v[184:185], v[168:169], v[112:113], v[184:185]
    v_pk_fma_f32 v[186:187], v[170:171], v[114:115], v[186:187]
    v_pk_mul_f32 v[180:181], v[180:181], v[172:173]
    v_pk_mul_f32 v[182:183], v[182:183], v[174:175]
    v_pk_mul_f32 v[184:185], v[184:185], v[176:177]
    v_pk_mul_f32 v[186:187], v[186:187], v[178:179]
    s_waitcnt vmcnt(6)
    buffer_load_dwordx4 v[96:99], v5, s[36:39], s55 offen offset:1280
    buffer_load_dwordx4 v[100:103], v5, s[36:39], s55 offen offset:2560
    v_lshlrev_b32 v140, 16, v48
    v_and_b32 v141, s59, v48
    v_lshlrev_b32 v142, 16, v49
    v_and_b32 v143, s59, v49
    v_lshlrev_b32 v144, 16, v50
    v_and_b32 v145, s59, v50
    v_lshlrev_b32 v146, 16, v51
    v_and_b32 v147, s59, v51
    v_lshlrev_b32 v172, 16, v80
    v_and_b32 v173, s59, v80
    v_lshlrev_b32 v174, 16, v81
    v_and_b32 v175, s59, v81
    v_lshlrev_b32 v176, 16, v82
    v_and_b32 v177, s59, v82
    v_lshlrev_b32 v178, 16, v83
    v_and_b32_e64 v179, s59, v83
    v_pk_mul_f32 v[188:189], v[148:149], v[132:133]
    v_pk_mul_f32 v[190:191], v[150:151], v[134:135]
    v_pk_mul_f32 v[192:193], v[152:153], v[136:137]
    v_pk_mul_f32 v[194:195], v[154:155], v[138:139]
    v_pk_fma_f32 v[188:189], v[156:157], v[124:125], v[188:189]
    v_pk_fma_f32 v[190:191], v[158:159], v[126:127], v[190:191]
    v_pk_fma_f32 v[192:193], v[160:161], v[128:129], v[192:193]
    v_pk_fma_f32 v[194:195], v[162:163], v[130:131], v[194:195]
    v_pk_fma_f32 v[188:189], v[164:165], v[116:117], v[188:189]
    v_pk_fma_f32 v[190:191], v[166:167], v[118:119], v[190:191]
    v_pk_fma_f32 v[192:193], v[168:169], v[120:121], v[192:193]
    v_pk_fma_f32 v[194:195], v[170:171], v[122:123], v[194:195]
    v_pk_fma_f32 v[188:189], v[140:141], v[108:109], v[188:189]
    v_pk_fma_f32 v[190:191], v[142:143], v[110:111], v[190:191]
    v_pk_fma_f32 v[192:193], v[144:145], v[112:113], v[192:193]
    v_pk_fma_f32 v[194:195], v[146:147], v[114:115], v[194:195]
    v_pk_mul_f32 v[188:189], v[188:189], v[172:173]
    v_pk_mul_f32 v[190:191], v[190:191], v[174:175]
    v_pk_mul_f32 v[192:193], v[192:193], v[176:177]
    v_pk_mul_f32 v[194:195], v[194:195], v[178:179]
    v_cvt_pk_bf16_f32 v196, v180, v188
    v_cvt_pk_bf16_f32 v200, v181, v189
    v_cvt_pk_bf16_f32 v204, v182, v190
    v_cvt_pk_bf16_f32 v208, v183, v191
    v_cvt_pk_bf16_f32 v212, v184, v192
    v_cvt_pk_bf16_f32 v216, v185, v193
    v_cvt_pk_bf16_f32 v220, v186, v194
    v_cvt_pk_bf16_f32 v224, v187, v195
    s_waitcnt vmcnt(6)
    buffer_load_dwordx4 v[104:107], v5, s[36:39], s55 offen offset:3840
    s_mul_i32 s49, s98, 80
    s_sub_u32 s50, s99, 24
    s_mul_i32 s50, s50, 6
    s_add_u32 s49, s49, s50
    s_add_u32 s49, s49, s48
    s_cmp_ge_u32 s48, 6
    s_cselect_b32 s50, 2, 0
    s_sub_u32 s49, s49, s50
    s_mul_i32 s56, s48, 8768
    s_lshl_b32 s50, s49, 12
    v_lshlrev_b32 v148, 16, v52
    v_and_b32 v149, s59, v52
    v_lshlrev_b32 v150, 16, v53
    v_and_b32 v151, s59, v53
    v_lshlrev_b32 v152, 16, v54
    v_and_b32 v153, s59, v54
    v_lshlrev_b32 v154, 16, v55
    v_and_b32 v155, s59, v55
    v_lshlrev_b32 v172, 16, v84
    v_and_b32 v173, s59, v84
    v_lshlrev_b32 v174, 16, v85
    v_and_b32 v175, s59, v85
    v_lshlrev_b32 v176, 16, v86
    v_and_b32 v177, s59, v86
    v_lshlrev_b32 v178, 16, v87
    v_and_b32_e64 v179, s59, v87
    v_pk_mul_f32 v[180:181], v[156:157], v[132:133]
    v_pk_mul_f32 v[182:183], v[158:159], v[134:135]
    v_pk_mul_f32 v[184:185], v[160:161], v[136:137]
    v_pk_mul_f32 v[186:187], v[162:163], v[138:139]
    v_pk_fma_f32 v[180:181], v[164:165], v[124:125], v[180:181]
    v_pk_fma_f32 v[182:183], v[166:167], v[126:127], v[182:183]
    v_pk_fma_f32 v[184:185], v[168:169], v[128:129], v[184:185]
    v_pk_fma_f32 v[186:187], v[170:171], v[130:131], v[186:187]
    v_pk_fma_f32 v[180:181], v[140:141], v[116:117], v[180:181]
    v_pk_fma_f32 v[182:183], v[142:143], v[118:119], v[182:183]
    v_pk_fma_f32 v[184:185], v[144:145], v[120:121], v[184:185]
    v_pk_fma_f32 v[186:187], v[146:147], v[122:123], v[186:187]
    v_pk_fma_f32 v[180:181], v[148:149], v[108:109], v[180:181]
    v_pk_fma_f32 v[182:183], v[150:151], v[110:111], v[182:183]
    v_pk_fma_f32 v[184:185], v[152:153], v[112:113], v[184:185]
    v_pk_fma_f32 v[186:187], v[154:155], v[114:115], v[186:187]
    v_pk_mul_f32 v[180:181], v[180:181], v[172:173]
    v_pk_mul_f32 v[182:183], v[182:183], v[174:175]
    v_pk_mul_f32 v[184:185], v[184:185], v[176:177]
    v_pk_mul_f32 v[186:187], v[186:187], v[178:179]
    s_waitcnt vmcnt(5)
    v_lshlrev_b32 v156, 16, v56
    v_and_b32 v157, s59, v56
    v_lshlrev_b32 v158, 16, v57
    v_and_b32 v159, s59, v57
    v_lshlrev_b32 v160, 16, v58
    v_and_b32 v161, s59, v58
    v_lshlrev_b32 v162, 16, v59
    v_and_b32 v163, s59, v59
    v_lshlrev_b32 v172, 16, v88
    v_and_b32 v173, s59, v88
    v_lshlrev_b32 v174, 16, v89
    v_and_b32 v175, s59, v89
    v_lshlrev_b32 v176, 16, v90
    v_and_b32 v177, s59, v90
    v_lshlrev_b32 v178, 16, v91
    v_and_b32_e64 v179, s59, v91
    v_pk_mul_f32 v[188:189], v[164:165], v[132:133]
    v_pk_mul_f32 v[190:191], v[166:167], v[134:135]
    v_pk_mul_f32 v[192:193], v[168:169], v[136:137]
    v_pk_mul_f32 v[194:195], v[170:171], v[138:139]
    v_pk_fma_f32 v[188:189], v[140:141], v[124:125], v[188:189]
    v_pk_fma_f32 v[190:191], v[142:143], v[126:127], v[190:191]
    v_pk_fma_f32 v[192:193], v[144:145], v[128:129], v[192:193]
    v_pk_fma_f32 v[194:195], v[146:147], v[130:131], v[194:195]
    v_pk_fma_f32 v[188:189], v[148:149], v[116:117], v[188:189]
    v_pk_fma_f32 v[190:191], v[150:151], v[118:119], v[190:191]
    v_pk_fma_f32 v[192:193], v[152:153], v[120:121], v[192:193]
    v_pk_fma_f32 v[194:195], v[154:155], v[122:123], v[194:195]
    v_pk_fma_f32 v[188:189], v[156:157], v[108:109], v[188:189]
    v_pk_fma_f32 v[190:191], v[158:159], v[110:111], v[190:191]
    v_pk_fma_f32 v[192:193], v[160:161], v[112:113], v[192:193]
    v_pk_fma_f32 v[194:195], v[162:163], v[114:115], v[194:195]
    v_pk_mul_f32 v[188:189], v[188:189], v[172:173]
    v_pk_mul_f32 v[190:191], v[190:191], v[174:175]
    v_pk_mul_f32 v[192:193], v[192:193], v[176:177]
    v_pk_mul_f32 v[194:195], v[194:195], v[178:179]
    v_cvt_pk_bf16_f32 v197, v180, v188
    v_cvt_pk_bf16_f32 v201, v181, v189
    v_cvt_pk_bf16_f32 v205, v182, v190
    v_cvt_pk_bf16_f32 v209, v183, v191
    v_cvt_pk_bf16_f32 v213, v184, v192
    v_cvt_pk_bf16_f32 v217, v185, v193
    v_cvt_pk_bf16_f32 v221, v186, v194
    v_cvt_pk_bf16_f32 v225, v187, v195
    s_waitcnt vmcnt(3)
    v_lshlrev_b32 v164, 16, v60
    v_and_b32 v165, s59, v60
    v_lshlrev_b32 v166, 16, v61
    v_and_b32 v167, s59, v61
    v_lshlrev_b32 v168, 16, v62
    v_and_b32 v169, s59, v62
    v_lshlrev_b32 v170, 16, v63
    v_and_b32 v171, s59, v63
    v_lshlrev_b32 v172, 16, v92
    v_and_b32 v173, s59, v92
    v_lshlrev_b32 v174, 16, v93
    v_and_b32 v175, s59, v93
    v_lshlrev_b32 v176, 16, v94
    v_and_b32 v177, s59, v94
    v_lshlrev_b32 v178, 16, v95
    v_and_b32_e64 v179, s59, v95
    v_pk_mul_f32 v[180:181], v[140:141], v[132:133]
    v_pk_mul_f32 v[182:183], v[142:143], v[134:135]
    v_pk_mul_f32 v[184:185], v[144:145], v[136:137]
    v_pk_mul_f32 v[186:187], v[146:147], v[138:139]
    v_pk_fma_f32 v[180:181], v[148:149], v[124:125], v[180:181]
    v_pk_fma_f32 v[182:183], v[150:151], v[126:127], v[182:183]
    v_pk_fma_f32 v[184:185], v[152:153], v[128:129], v[184:185]
    v_pk_fma_f32 v[186:187], v[154:155], v[130:131], v[186:187]
    v_pk_fma_f32 v[180:181], v[156:157], v[116:117], v[180:181]
    v_pk_fma_f32 v[182:183], v[158:159], v[118:119], v[182:183]
    v_pk_fma_f32 v[184:185], v[160:161], v[120:121], v[184:185]
    v_pk_fma_f32 v[186:187], v[162:163], v[122:123], v[186:187]
    v_pk_fma_f32 v[180:181], v[164:165], v[108:109], v[180:181]
    v_pk_fma_f32 v[182:183], v[166:167], v[110:111], v[182:183]
    v_pk_fma_f32 v[184:185], v[168:169], v[112:113], v[184:185]
    v_pk_fma_f32 v[186:187], v[170:171], v[114:115], v[186:187]
    v_pk_mul_f32 v[180:181], v[180:181], v[172:173]
    v_pk_mul_f32 v[182:183], v[182:183], v[174:175]
    v_pk_mul_f32 v[184:185], v[184:185], v[176:177]
    v_pk_mul_f32 v[186:187], v[186:187], v[178:179]
    s_waitcnt vmcnt(2)
    v_lshlrev_b32 v140, 16, v64
    v_and_b32 v141, s59, v64
    v_lshlrev_b32 v142, 16, v65
    v_and_b32 v143, s59, v65
    v_lshlrev_b32 v144, 16, v66
    v_and_b32 v145, s59, v66
    v_lshlrev_b32 v146, 16, v67
    v_and_b32 v147, s59, v67
    v_lshlrev_b32 v172, 16, v96
    v_and_b32 v173, s59, v96
    v_lshlrev_b32 v174, 16, v97
    v_and_b32 v175, s59, v97
    v_lshlrev_b32 v176, 16, v98
    v_and_b32 v177, s59, v98
    v_lshlrev_b32 v178, 16, v99
    v_and_b32_e64 v179, s59, v99
    v_pk_mul_f32 v[188:189], v[148:149], v[132:133]
    v_pk_mul_f32 v[190:191], v[150:151], v[134:135]
    v_pk_mul_f32 v[192:193], v[152:153], v[136:137]
    v_pk_mul_f32 v[194:195], v[154:155], v[138:139]
    v_pk_fma_f32 v[188:189], v[156:157], v[124:125], v[188:189]
    v_pk_fma_f32 v[190:191], v[158:159], v[126:127], v[190:191]
    v_pk_fma_f32 v[192:193], v[160:161], v[128:129], v[192:193]
    v_pk_fma_f32 v[194:195], v[162:163], v[130:131], v[194:195]
    v_pk_fma_f32 v[188:189], v[164:165], v[116:117], v[188:189]
    v_pk_fma_f32 v[190:191], v[166:167], v[118:119], v[190:191]
    v_pk_fma_f32 v[192:193], v[168:169], v[120:121], v[192:193]
    v_pk_fma_f32 v[194:195], v[170:171], v[122:123], v[194:195]
    v_pk_fma_f32 v[188:189], v[140:141], v[108:109], v[188:189]
    v_pk_fma_f32 v[190:191], v[142:143], v[110:111], v[190:191]
    v_pk_fma_f32 v[192:193], v[144:145], v[112:113], v[192:193]
    v_pk_fma_f32 v[194:195], v[146:147], v[114:115], v[194:195]
    v_pk_mul_f32 v[188:189], v[188:189], v[172:173]
    v_pk_mul_f32 v[190:191], v[190:191], v[174:175]
    v_pk_mul_f32 v[192:193], v[192:193], v[176:177]
    v_pk_mul_f32 v[194:195], v[194:195], v[178:179]
    v_cvt_pk_bf16_f32 v198, v180, v188
    v_cvt_pk_bf16_f32 v202, v181, v189
    v_cvt_pk_bf16_f32 v206, v182, v190
    v_cvt_pk_bf16_f32 v210, v183, v191
    v_cvt_pk_bf16_f32 v214, v184, v192
    v_cvt_pk_bf16_f32 v218, v185, v193
    v_cvt_pk_bf16_f32 v222, v186, v194
    v_cvt_pk_bf16_f32 v226, v187, v195
    s_waitcnt vmcnt(1)
    v_lshlrev_b32 v148, 16, v68
    v_and_b32 v149, s59, v68
    v_lshlrev_b32 v150, 16, v69
    v_and_b32 v151, s59, v69
    v_lshlrev_b32 v152, 16, v70
    v_and_b32 v153, s59, v70
    v_lshlrev_b32 v154, 16, v71
    v_and_b32 v155, s59, v71
    v_lshlrev_b32 v172, 16, v100
    v_and_b32 v173, s59, v100
    v_lshlrev_b32 v174, 16, v101
    v_and_b32 v175, s59, v101
    v_lshlrev_b32 v176, 16, v102
    v_and_b32 v177, s59, v102
    v_lshlrev_b32 v178, 16, v103
    v_and_b32_e64 v179, s59, v103
    v_pk_mul_f32 v[180:181], v[156:157], v[132:133]
    v_pk_mul_f32 v[182:183], v[158:159], v[134:135]
    v_pk_mul_f32 v[184:185], v[160:161], v[136:137]
    v_pk_mul_f32 v[186:187], v[162:163], v[138:139]
    v_pk_fma_f32 v[180:181], v[164:165], v[124:125], v[180:181]
    v_pk_fma_f32 v[182:183], v[166:167], v[126:127], v[182:183]
    v_pk_fma_f32 v[184:185], v[168:169], v[128:129], v[184:185]
    v_pk_fma_f32 v[186:187], v[170:171], v[130:131], v[186:187]
    v_pk_fma_f32 v[180:181], v[140:141], v[116:117], v[180:181]
    v_pk_fma_f32 v[182:183], v[142:143], v[118:119], v[182:183]
    v_pk_fma_f32 v[184:185], v[144:145], v[120:121], v[184:185]
    v_pk_fma_f32 v[186:187], v[146:147], v[122:123], v[186:187]
    v_pk_fma_f32 v[180:181], v[148:149], v[108:109], v[180:181]
    v_pk_fma_f32 v[182:183], v[150:151], v[110:111], v[182:183]
    v_pk_fma_f32 v[184:185], v[152:153], v[112:113], v[184:185]
    v_pk_fma_f32 v[186:187], v[154:155], v[114:115], v[186:187]
    v_pk_mul_f32 v[180:181], v[180:181], v[172:173]
    v_pk_mul_f32 v[182:183], v[182:183], v[174:175]
    v_pk_mul_f32 v[184:185], v[184:185], v[176:177]
    v_pk_mul_f32 v[186:187], v[186:187], v[178:179]
    s_waitcnt vmcnt(0)
    v_lshlrev_b32 v156, 16, v72
    v_and_b32 v157, s59, v72
    v_lshlrev_b32 v158, 16, v73
    v_and_b32 v159, s59, v73
    v_lshlrev_b32 v160, 16, v74
    v_and_b32 v161, s59, v74
    v_lshlrev_b32 v162, 16, v75
    v_and_b32 v163, s59, v75
    v_lshlrev_b32 v172, 16, v104
    v_and_b32 v173, s59, v104
    v_lshlrev_b32 v174, 16, v105
    v_and_b32 v175, s59, v105
    v_lshlrev_b32 v176, 16, v106
    v_and_b32 v177, s59, v106
    v_lshlrev_b32 v178, 16, v107
    v_and_b32_e64 v179, s59, v107
    v_pk_mul_f32 v[188:189], v[164:165], v[132:133]
    v_pk_mul_f32 v[190:191], v[166:167], v[134:135]
    v_pk_mul_f32 v[192:193], v[168:169], v[136:137]
    v_pk_mul_f32 v[194:195], v[170:171], v[138:139]
    v_pk_fma_f32 v[188:189], v[140:141], v[124:125], v[188:189]
    v_pk_fma_f32 v[190:191], v[142:143], v[126:127], v[190:191]
    v_pk_fma_f32 v[192:193], v[144:145], v[128:129], v[192:193]
    v_pk_fma_f32 v[194:195], v[146:147], v[130:131], v[194:195]
    v_pk_fma_f32 v[188:189], v[148:149], v[116:117], v[188:189]
    v_pk_fma_f32 v[190:191], v[150:151], v[118:119], v[190:191]
    v_pk_fma_f32 v[192:193], v[152:153], v[120:121], v[192:193]
    v_pk_fma_f32 v[194:195], v[154:155], v[122:123], v[194:195]
    v_pk_fma_f32 v[188:189], v[156:157], v[108:109], v[188:189]
    v_pk_fma_f32 v[190:191], v[158:159], v[110:111], v[190:191]
    v_pk_fma_f32 v[192:193], v[160:161], v[112:113], v[192:193]
    v_pk_fma_f32 v[194:195], v[162:163], v[114:115], v[194:195]
    v_pk_mul_f32 v[188:189], v[188:189], v[172:173]
    v_pk_mul_f32 v[190:191], v[190:191], v[174:175]
    v_pk_mul_f32 v[192:193], v[192:193], v[176:177]
    v_pk_mul_f32 v[194:195], v[194:195], v[178:179]
    v_cvt_pk_bf16_f32 v199, v180, v188
    v_cvt_pk_bf16_f32 v203, v181, v189
    v_cvt_pk_bf16_f32 v207, v182, v190
    v_cvt_pk_bf16_f32 v211, v183, v191
    v_cvt_pk_bf16_f32 v215, v184, v192
    v_cvt_pk_bf16_f32 v219, v185, v193
    v_cvt_pk_bf16_f32 v223, v186, v194
    v_cvt_pk_bf16_f32 v227, v187, v195
    ds_write_b128 v10, v[196:199] offset:0
    ds_write_b128 v10, v[200:203] offset:128
    ds_write_b128 v10, v[204:207] offset:256
    ds_write_b128 v10, v[208:211] offset:384
    ds_write_b128 v10, v[212:215] offset:512
    ds_write_b128 v10, v[216:219] offset:640
    ds_write_b128 v10, v[220:223] offset:768
    ds_write_b128 v10, v[224:227] offset:896
    s_waitcnt lgkmcnt(0)
    ds_read_b64_tr_b16 v[16:17], v11 offset:0
    ds_read_b64_tr_b16 v[18:19], v11 offset:32
    ds_read_b64_tr_b16 v[20:21], v11 offset:1040
    ds_read_b64_tr_b16 v[22:23], v11 offset:1072
    ds_read_b64_tr_b16 v[24:25], v11 offset:2080
    ds_read_b64_tr_b16 v[26:27], v11 offset:2112
    ds_read_b64_tr_b16 v[28:29], v11 offset:3120
    ds_read_b64_tr_b16 v[30:31], v11 offset:3152
    ds_read_b64_tr_b16 v[32:33], v11 offset:4160
    ds_read_b64_tr_b16 v[34:35], v11 offset:4192
    ds_read_b64_tr_b16 v[36:37], v11 offset:5200
    ds_read_b64_tr_b16 v[38:39], v11 offset:5232
    ds_read_b64_tr_b16 v[40:41], v11 offset:6240
    ds_read_b64_tr_b16 v[42:43], v11 offset:6272
    ds_read_b64_tr_b16 v[44:45], v11 offset:7280
    ds_read_b64_tr_b16 v[46:47], v11 offset:7312
    s_waitcnt lgkmcnt(14)
    buffer_store_dwordx4 v[16:19], v12, s[44:47], s57 offen sc1
    s_add_u32 s57, s57, 34816
    s_waitcnt lgkmcnt(12)
    buffer_store_dwordx4 v[20:23], v12, s[44:47], s57 offen sc1
    s_add_u32 s57, s57, 34816
    s_waitcnt lgkmcnt(10)
    buffer_store_dwordx4 v[24:27], v12, s[44:47], s57 offen sc1
    s_add_u32 s57, s57, 34816
    s_waitcnt lgkmcnt(8)
    buffer_store_dwordx4 v[28:31], v12, s[44:47], s57 offen sc1
    s_add_u32 s57, s57, 34816
    s_waitcnt lgkmcnt(6)
    buffer_store_dwordx4 v[32:35], v12, s[44:47], s57 offen sc1
    s_add_u32 s57, s57, 34816
    s_waitcnt lgkmcnt(4)
    buffer_store_dwordx4 v[36:39], v12, s[44:47], s57 offen sc1
    s_add_u32 s57, s57, 34816
    s_waitcnt lgkmcnt(2)
    buffer_store_dwordx4 v[40:43], v12, s[44:47], s57 offen sc1
    s_add_u32 s57, s57, 34816
    s_waitcnt lgkmcnt(0)
    buffer_store_dwordx4 v[44:47], v12, s[44:47], s57 offen sc1
    s_branch L_bconv
L_help:
    s_setprio 3
    s_waitcnt lgkmcnt(0)
    s_mov_b32 s44, s28
    s_mov_b32 s45, s29
    s_mov_b32 s46, 0x1100000
    s_mov_b32 s47, 0x20000
    s_mov_b32 s40, s26
    s_mov_b32 s41, s27
    s_mov_b32 s42, 0x100
    s_mov_b32 s43, 0x20000
    s_cmp_eq_u32 s2, 192
    s_cbranch_scc0 L_nz_46
    s_cmp_eq_u32 s48, 5
    s_cbranch_scc0 L_nz_46
    s_mov_b32 s57, 0xf50040
    s_mov_b64 exec, 1
    buffer_load_dword v4, off, s[44:47], s57 sc1
    s_waitcnt vmcnt(0)
    v_add_u32 v4, 1, v4
    v_not_b32_e64 v5, v4
    buffer_store_dwordx2 v[4:5], off, s[40:43], 0 sc1
    buffer_store_dword v4, off, s[44:47], s57 sc1
    s_mov_b64 exec, -1
L_nz_46:
    s_cmp_eq_u32 s48, 6
    s_cbranch_scc0 L_npf_47
    s_getpc_b64 s[50:51]
L_pc:
    s_sub_u32 s50, s50, L_pc-concat_heads__linear_kernel_hedgehog__ssm_conv_h3__prompt_kernel
    s_subb_u32 s51, s51, 0
    s_sub_u32 s52, s99, 24
    s_lshl_b32 s52, s52, 13
    v_lshl_add_u32 v2, v1, 7, s52
    v_min_u32 v2, L_code_end-concat_heads__linear_kernel_hedgehog__ssm_conv_h3__prompt_kernel-4, v2
    global_load_dword v24, v2, s[50:51]
L_npf_47:
    s_cmp_eq_u32 s48, 7
    s_cbranch_scc0 L_bw_48
    s_sub_u32 s61, s99, 24
    s_mul_i32 s60, s98, 80
    s_mul_i32 s61, s61, 6
    s_add_u32 s60, s60, s61
    s_add_u32 s61, s60, 5
    s_lshr_b32 s52, s60, 6
    s_mul_i32 s52, s52, 419431
    s_lshr_b32 s52, s52, 16
    s_lshr_b32 s53, s61, 6
    s_mul_i32 s53, s53, 419431
    s_add_u32 s53, s53, 406324
    s_lshr_b32 s53, s53, 16
    v_lshrrev_b32 v12, 2, v1
    v_add_u32 v12, s52, v12
    v_min_u32 v12, s53, v12
    v_lshlrev_b32_e64 v12, 7, v12
    s_mov_b32 s52, 0xf30000
    buffer_load_dword v26, v12, s[44:47], s52 offen sc1
    s_lshl_b32 s57, s98, 4
    s_sub_u32 s58, s57, 16
    v_min_u32 v12, 47, v1
    v_add_u32 v12, s58, v12
    v_max_i32 v12, 0, v12
    v_min_u32 v12, 127, v12
    v_lshlrev_b32 v12, 7, v12
    s_mov_b32 s58, 0xf3a000
    buffer_load_dword v27, v12, s[44:47], s58 offen sc1
L_bw_48:
    s_sub_u32 s61, s99, 24
    s_lshl_b32 s60, s61, 1
    s_add_u32 s60, s60, s48
    s_sub_u32 s60, s60, 6
    s_xor_b32 s61, s61, 20
    s_cmp_eq_u32 s48, 5
    s_cselect_b32 s60, s61, s60
    s_lshl_b32 s60, s60, 3
    s_add_u32 s60, s60, s98
    s_cmp_ge_u32 s60, 160
    s_cbranch_scc1 L_nw_49_a
    s_mov_b32 s36, s10
    s_mov_b32 s37, s11
    s_mov_b32 s38, 0xc8000
    s_mov_b32 s39, 0x20000
    s_lshr_b32 s61, s60, 3
    s_and_b32 s62, s60, 7
    s_mul_i32 s53, s62, 102400
    s_lshl_b32 s54, s61, 6
    s_add_u32 s53, s53, s54
    v_lshrrev_b32 v2, 2, v1
    v_and_b32 v3, 3, v1
    v_mul_u32_u24 v4, 1280, v2
    v_lshl_add_u32 v4, v3, 4, v4
    s_mul_i32 s56, s48, 8768
    s_add_u32 m0, s56, 0
    s_nop 0
    buffer_load_dwordx4 v4, s[36:39], s53 offen lds
    s_add_u32 s53, s53, 20480
    s_add_u32 m0, s56, 1024
    s_nop 0
    buffer_load_dwordx4 v4, s[36:39], s53 offen lds
    s_add_u32 s53, s53, 20480
    s_add_u32 m0, s56, 2048
    s_nop 0
    buffer_load_dwordx4 v4, s[36:39], s53 offen lds
    s_add_u32 s53, s53, 20480
    s_add_u32 m0, s56, 3072
    s_nop 0
    buffer_load_dwordx4 v4, s[36:39], s53 offen lds
    s_add_u32 s53, s53, 20480
    s_add_u32 m0, s56, 4096
    s_nop 0
    buffer_load_dwordx4 v4, s[36:39], s53 offen lds
    s_add_u32 s53, s53, 20480
L_nw_49_a:
    s_and_b32 s50, s98, 3
    s_lshr_b32 s51, s98, 2
    s_and_b32 s52, s99, 3
    s_lshl_b32 s53, s50, 1
    s_add_u32 s53, s53, s51
    s_lshl_b32 s53, s53, 2
    s_add_u32 s53, s53, s52
    s_mul_i32 s53, s53, 81920
    s_lshl_b32 s50, s50, 2
    s_add_u32 s50, s50, s52
    s_mul_i32 s52, s50, 52
    s_lshr_b32 s52, s52, 8
    s_add_u32 s52, s52, s51
    s_mul_i32 s52, s52, 640
    s_lshl_b32 s51, s50, 7
    s_add_u32 s52, s52, s51
    s_cmp_eq_u32 s50, 15
    s_cselect_b32 s52, 0x258000, s52
    s_cmp_lt_u32 s99, 28
    s_cselect_b32 s51, s53, s52
    s_cselect_b64 s[32:33], s[4:5], s[6:7]
    s_mov_b32 s53, 0x258000
    s_cselect_b32 s34, 0x280000, s53
    s_mov_b32 s35, 0x20000
    s_movk_i32 s53, 3840
    s_cselect_b32 s52, 1280, s53
    s_mov_b32 s53, 245760
    s_cselect_b32 s53, 128, s53
    v_mul_u32_u24 v2, s52, v1
    s_sub_u32 s50, s48, 5
    s_lshl_b32 s50, s50, 2
    s_lshr_b32 s54, 0xf72, s50
    s_and_b32 s54, s54, 15
    s_mul_i32 s52, s54, s53
    s_cmp_ge_u32 s54, 10
    s_cselect_b32 s52, 0x1000000, s52
    s_add_u32 s52, s52, s51
    buffer_load_dword v30, v2, s[32:35], s52 offen
L_pme_50:
    s_lshl_b32 s50, s48, 3
    s_add_u32 s50, s50, s99
    s_sub_u32 s50, s50, 64
    s_cmp_ge_u32 s50, 20
    s_cselect_b32 s53, 0x1000000, 0
    s_lshr_b32 s51, s50, 1
    s_and_b32 s50, s50, 1
    s_cmp_ge_u32 s51, 5
    s_cselect_b32 s52, 640, 0
    s_lshl_b32 s51, s51, 7
    s_add_u32 s51, s51, s52
    s_lshr_b32 s52, s98, 2
    s_mul_i32 s52, s52, 640
    s_add_u32 s51, s51, s52
    s_add_u32 s51, s51, s53
    s_add_u32 s51, s51, 1280
    s_mul_i32 s50, s50, 5
    s_mov_b32 s32, s6
    s_mov_b32 s33, s7
    s_mov_b32 s34, 0x258000
    s_mov_b32 s35, 0x20000
    v_mul_u32_u24 v2, 3840, v1
    s_add_u32 s52, s50, 3
    s_sub_u32 s53, s52, 10
    s_cselect_b32 s52, s52, s53
    s_mul_i32 s52, s52, 245760
    s_add_u32 s52, s52, s51
    buffer_load_dword v33, v2, s[32:35], s52 offen
    s_add_u32 s52, s50, 4
    s_sub_u32 s53, s52, 10
    s_cselect_b32 s52, s52, s53
    s_mul_i32 s52, s52, 245760
    s_add_u32 s52, s52, s51
    buffer_load_dword v34, v2, s[32:35], s52 offen
L_ng_51:
    s_cmp_ge_u32 s60, 160
    s_cbranch_scc1 L_nw_49
    v_bfe_u32 v10, v1, 2, 2
    v_lshrrev_b32 v11, 5, v1
    v_and_b32 v12, 1, v1
    v_lshlrev_b32_e64 v12, 5, v12
    v_bfe_u32 v13, v1, 4, 1
    v_lshl_add_u32 v12, v13, 4, v12
    v_bfe_u32 v13, v1, 1, 1
    v_lshl_add_u32 v12, v13, 3, v12
    v_lshl_add_u32 v12, v10, 6, v12
    v_add_u32_e64 v12, s56, v12
    v_lshl_add_u32 v13, v11, 8, v12
    v_mul_u32_u24 v14, 2560, v11
    v_add_u32 v14, v14, v12
    v_lshlrev_b32 v2, 4, v1
    s_mul_i32 s53, s61, 40960
    s_add_u32 s53, s53, 0x280000
    s_lshl_b32 s54, s62, 10
    s_add_u32 s54, s54, s53
    s_add_u32 s54, s54, 32768
    s_lshl_b32 s62, s62, 12
    s_add_u32 s53, s53, s62
    s_lshl_b32 s55, s60, 7
    s_add_u32 s55, s55, 0xf40000
    s_waitcnt vmcnt(3)
    ds_read_b64_tr_b16 v[40:41], v13 offset:0
    ds_read_b64_tr_b16 v[42:43], v13 offset:512
    ds_read_b64_tr_b16 v[44:45], v13 offset:1280
    ds_read_b64_tr_b16 v[46:47], v13 offset:1792
    ds_read_b64_tr_b16 v[48:49], v13 offset:2560
    ds_read_b64_tr_b16 v[50:51], v13 offset:3072
    ds_read_b64_tr_b16 v[52:53], v13 offset:3840
    ds_read_b64_tr_b16 v[54:55], v13 offset:4352
    ds_read_b64_tr_b16 v[56:57], v14 offset:1024
    ds_read_b64_tr_b16 v[58:59], v14 offset:2304
    s_waitcnt lgkmcnt(0)
    buffer_store_dwordx4 v[40:43], v2, s[44:47], s53 offen offset:0 sc1
    buffer_store_dwordx4 v[44:47], v2, s[44:47], s53 offen offset:1024 sc1
    buffer_store_dwordx4 v[48:51], v2, s[44:47], s53 offen offset:2048 sc1
    buffer_store_dwordx4 v[52:55], v2, s[44:47], s53 offen offset:3072 sc1
    buffer_store_dwordx4 v[56:59], v2, s[44:47], s54 offen sc1
    s_mov_b64 s[30:31], 0
    s_waitcnt lgkmcnt(0)
    s_cmp_lg_u32 s30, s31
    s_cbranch_scc1 L_hsd_53
    s_mov_b32 s101, 0x10000
    v_mov_b32 v10, 0
L_hs_52:
    global_load_dwordx2 v[8:9], v10, s[26:27] sc1
    s_waitcnt vmcnt(0)
    v_readfirstlane_b32 s30, v8
    v_readfirstlane_b32 s31, v9
    s_nop 3
    s_cmp_lg_u32 s30, s31
    s_cbranch_scc1 L_hsd_53
    s_sleep 8
    s_sub_u32 s101, s101, 1
    s_cmp_eq_u32 s101, 0
    s_cbranch_scc0 L_hs_52
    s_endpgm
L_hsd_53:
    v_mov_b32 v8, s30
    v_mov_b32 v9, s31
    v_lshlrev_b32_e64 v10, 3, v1
    s_waitcnt vmcnt(0)
    s_mov_b64 exec, 0xffff
    buffer_store_dwordx2 v[8:9], v10, s[44:47], s55 offen sc1
    s_mov_b64 exec, -1
L_nw_49:
    s_setprio 0
    s_mul_i32 s49, s98, 80
    s_sub_u32 s50, s99, 24
    s_mul_i32 s50, s50, 6
    s_add_u32 s49, s49, s50
    s_add_u32 s49, s49, s48
    s_cmp_ge_u32 s48, 6
    s_cselect_b32 s50, 2, 0
    s_sub_u32 s49, s49, s50
    s_mul_i32 s56, s48, 8768
    s_lshl_b32 s50, s49, 12
    v_mov_b32 v4, 112000
    v_mov_b32_e64 v5, 0
    ds_write_b32 v4, v5
    ds_write_b32 v4, v5 offset:512
L_bconv:
    v_lshlrev_b32_e64 v2, 4, v1
    s_lshl_b32 s52, s49, 1
    s_and_b32 s52, s52, 0xfffffffc
    s_load_dword s55, s[22:23], s52
    s_load_dword s54, s[20:21], s50
    s_mul_i32 s51, s49, 4352
    s_add_u32 s51, s51, 0x740000
    v_mov_b32 v4, 0
    v_mov_b32 v5, 0
    v_mov_b32 v6, 0
    v_mov_b32 v7, 0
    v_add_u32 v3, s56, v2
    s_mov_b64 exec, 0xf
    ds_write_b128 v3, v[4:7]
    s_mov_b32 exec_lo, -1
    ds_write_b128 v3, v[4:7] offset:4160
    s_mov_b64 exec, -1
    v_and_b32 v11, 3, v1
    v_lshrrev_b32 v10, 4, v1
    v_bfe_u32 v12, v1, 2, 2
    v_lshlrev_b32 v8, 4, v11
    v_lshl_add_u32 v8, v10, 6, v8
    v_lshlrev_b32 v9, 3, v12
    v_sub_u32 v8, v8, v9
    s_add_u32 s57, s56, 32
    v_add_u32 v8, s57, v8
    v_sub_u32 v9, v11, v10
    v_lshlrev_b32_e64 v9, 6, v9
    v_lshl_add_u32 v9, v12, 4, v9
    s_add_u32 s57, s56, 4672
    v_add_u32 v9, s57, v9
    v_mov_b32 v13, 0xffff
    v_cmp_eq_u32 vcc, 0, v1
    s_nop 1
    v_cndmask_b32 v16, 0, v13, vcc
    v_cmp_eq_u32 vcc, 4, v1
    s_nop 1
    v_cndmask_b32 v17, 0, v13, vcc
    v_cmp_eq_u32 vcc, 8, v1
    s_nop 1
    v_cndmask_b32 v18, 0, v13, vcc
    v_cmp_eq_u32 vcc, 12, v1
    s_nop 1
    v_cndmask_b32 v19, 0, v13, vcc
    v_add_u32 v13, 3, v11
    v_and_b32 v13, 3, v13
    v_lshl_add_u32 v13, v12, 2, v13
    v_add_u32 v13, 48, v13
    v_subrev_u32 v14, 16, v1
    v_cmp_gt_u32 vcc, 16, v1
    s_nop 1
    v_cndmask_b32 v14, v14, v13, vcc
    v_lshlrev_b32 v14, 2, v14
    s_mov_b32 s58, 0x1111
    s_mov_b32 s59, 0
    s_sub_u32 s61, s99, 24
    s_lshl_b32 s62, s98, 3
    s_add_u32 s62, s62, s61
    s_lshl_b32 s62, s62, 7
    s_add_u32 s62, s62, 0xf30000
    s_mul_i32 s60, s98, 80
    s_mul_i32 s61, s61, 6
    s_add_u32 s60, s60, s61
    s_add_u32 s61, s60, 5
    s_lshr_b32 s52, s60, 6
    s_mul_i32 s52, s52, 419431
    s_lshr_b32 s52, s52, 16
    s_lshr_b32 s53, s61, 6
    s_mul_i32 s53, s53, 419431
    s_add_u32 s53, s53, 406324
    s_lshr_b32 s53, s53, 16
    v_lshrrev_b32 v12, 2, v1
    v_add_u32 v12, s52, v12
    v_min_u32 v12, s53, v12
    v_lshlrev_b32 v12, 7, v12
    s_mov_b32 s52, 0xf30000
    s_waitcnt vmcnt(0) lgkmcnt(0)
    s_barrier
    s_cmp_eq_u32 s48, 7
    s_cbranch_scc0 L_hd_54
    v_mov_b32 v22, s30
    v_mov_b32 v23, s31
    v_lshlrev_b32_e64 v24, 3, v1
    s_waitcnt vmcnt(0)
    s_mov_b64 exec, 0xffff
    buffer_store_dwordx2 v[22:23], v24, s[44:47], s62 offen sc1
    s_mov_b64 exec, -1
L_hd_54:
    s_barrier
    s_mov_b32 s40, s20
    s_mov_b32 s41, s21
    s_mov_b32 s42, 0x280000
    s_mov_b32 s43, 0x20000
    v_lshlrev_b32 v2, 4, v1
    s_lshl_b32 s50, s49, 12
    s_add_u32 m0, s56, 64
    s_nop 0
    buffer_load_dwordx4 v2, s[40:43], s50 offen offset:0 nt lds
    buffer_load_dwordx4 v2, s[40:43], s50 offen offset:1024 nt lds
    buffer_load_dwordx4 v2, s[40:43], s50 offen offset:2048 nt lds
    buffer_load_dwordx4 v2, s[40:43], s50 offen offset:3072 nt lds
    s_cmp_eq_u32 s48, 7
    s_cbranch_scc0 L_n7_55
    s_mov_b32 s101, 0x10000
L_poll_56:
    buffer_load_dwordx2 v[26:27], v12, s[44:47], s52 offen sc1
    s_waitcnt vmcnt(0)
    v_cmp_eq_u64 vcc, s[30:31], v[26:27]
    s_nop 0
    s_cmp_eq_u64 vcc, -1
    s_cbranch_scc1 L_polld_57
    s_sleep 4
    s_sub_u32 s101, s101, 1
    s_cmp_eq_u32 s101, 0
    s_cbranch_scc0 L_poll_56
    s_endpgm
L_polld_57:
L_n7_55:
    s_barrier
    s_add_u32 m0, s56, 4672
    s_nop 0
    buffer_load_dwordx4 v2, s[44:47], s51 offen offset:0 sc1 lds
    buffer_load_dwordx4 v2, s[44:47], s51 offen offset:1024 sc1 lds
    buffer_load_dwordx4 v2, s[44:47], s51 offen offset:2048 sc1 lds
    buffer_load_dwordx4 v2, s[44:47], s51 offen offset:3072 sc1 lds
    s_waitcnt vmcnt(4)
    s_cmp_ge_u32 s48, 4
    s_cbranch_scc0 L_cb
    s_setprio 1
    s_branch L_cb
L_conv:
    s_waitcnt lgkmcnt(0)
    s_cmp_lg_u32 s30, s31
    s_cbranch_scc1 L_hsd_60
    s_mov_b32 s101, 0x10000
    v_mov_b32 v24, 0
L_hs_59:
    global_load_dwordx2 v[22:23], v24, s[26:27] sc1
    s_waitcnt vmcnt(0)
    v_readfirstlane_b32 s30, v22
    v_readfirstlane_b32 s31, v23
    s_nop 3
    s_cmp_lg_u32 s30, s31
    s_cbranch_scc1 L_hsd_60
    s_sleep 8
    s_sub_u32 s101, s101, 1
    s_cmp_eq_u32 s101, 0
    s_cbranch_scc0 L_hs_59
    s_endpgm
L_hsd_60:
    s_mov_b32 s40, s20
    s_mov_b32 s41, s21
    s_mov_b32 s42, 0x280000
    s_mov_b32 s43, 0x20000
    v_lshlrev_b32 v2, 4, v1
    s_lshl_b32 s50, s49, 12
    s_add_u32 m0, s56, 64
    s_nop 0
    buffer_load_dwordx4 v2, s[40:43], s50 offen offset:0 nt lds
    buffer_load_dwordx4 v2, s[40:43], s50 offen offset:1024 nt lds
    buffer_load_dwordx4 v2, s[40:43], s50 offen offset:2048 nt lds
    buffer_load_dwordx4 v2, s[40:43], s50 offen offset:3072 nt lds
    s_barrier
    v_mov_b32 v22, 159744
    s_mov_b32 s101, 0x200000
L_lw_61:
    ds_read_b32 v23, v22
    s_waitcnt lgkmcnt(0)
    v_cmp_le_u32 vcc, 4, v23
    s_cbranch_vccnz L_lwd_62
    s_sleep 2
    s_sub_u32 s101, s101, 1
    s_cmp_eq_u32 s101, 0
    s_cbranch_scc0 L_lw_61
    s_endpgm
L_lwd_62:
    buffer_load_dwordx2 v[22:23], v12, s[44:47], s52 offen sc1
    s_waitcnt vmcnt(0)
    v_cmp_eq_u64 vcc, s[30:31], v[22:23]
    s_nop 0
    s_cmp_eq_u64 vcc, -1
    s_cbranch_scc1 L_cx_63
    s_mov_b32 s101, 0x10000
L_poll_64:
    buffer_load_dwordx2 v[22:23], v12, s[44:47], s52 offen sc1
    s_waitcnt vmcnt(0)
    v_cmp_eq_u64 vcc, s[30:31], v[22:23]
    s_nop 0
    s_cmp_eq_u64 vcc, -1
    s_cbranch_scc1 L_polld_65
    s_sleep 8
    s_sub_u32 s101, s101, 1
    s_cmp_eq_u32 s101, 0
    s_cbranch_scc0 L_poll_64
    s_endpgm
L_polld_65:
L_cx_63:
    s_add_u32 m0, s56, 4672
    s_nop 0
    buffer_load_dwordx4 v2, s[44:47], s51 offen offset:0 sc1 lds
    buffer_load_dwordx4 v2, s[44:47], s51 offen offset:1024 sc1 lds
    buffer_load_dwordx4 v2, s[44:47], s51 offen offset:2048 sc1 lds
    buffer_load_dwordx4 v2, s[44:47], s51 offen offset:3072 sc1 lds
    v_mov_b32 v22, 159744
    v_mov_b32 v23, 1
    s_waitcnt lgkmcnt(0)
    s_mov_b64 exec, 1
    ds_add_u32 v22, v23
    s_mov_b64 exec, -1
    s_waitcnt vmcnt(4)
L_cb:
    s_waitcnt lgkmcnt(0)
    s_lshl_b32 s54, s54, 16
    s_lshl_b32 s53, s55, 16
    s_and_b32 s55, s55, 0xffff0000
    s_bitcmp1_b32 s49, 0
    s_cselect_b32 s53, s55, s53
    v_mov_b32 v15, s54
    v_add_f32_e64 v15, s53, v15
    v_cvt_pk_bf16_f32 v15, v15, v15
    ds_read_b64_tr_b16 v[64:65], v8 offset:32
    ds_read_b64_tr_b16 v[66:67], v8 offset:0
    ds_read_b64_tr_b16 v[68:69], v8 offset:40
    ds_read_b64_tr_b16 v[70:71], v8 offset:8
    ds_read_b64_tr_b16 v[72:73], v8 offset:288
    ds_read_b64_tr_b16 v[74:75], v8 offset:256
    ds_read_b64_tr_b16 v[76:77], v8 offset:296
    ds_read_b64_tr_b16 v[78:79], v8 offset:264
    ds_read_b64_tr_b16 v[80:81], v8 offset:544
    ds_read_b64_tr_b16 v[82:83], v8 offset:512
    ds_read_b64_tr_b16 v[84:85], v8 offset:552
    ds_read_b64_tr_b16 v[86:87], v8 offset:520
    ds_read_b64_tr_b16 v[88:89], v8 offset:800
    ds_read_b64_tr_b16 v[90:91], v8 offset:768
    ds_read_b64_tr_b16 v[92:93], v8 offset:808
    ds_read_b64_tr_b16 v[94:95], v8 offset:776
    ds_read_b64_tr_b16 v[96:97], v8 offset:1056
    ds_read_b64_tr_b16 v[98:99], v8 offset:1024
    ds_read_b64_tr_b16 v[100:101], v8 offset:1064
    ds_read_b64_tr_b16 v[102:103], v8 offset:1032
    ds_read_b64_tr_b16 v[104:105], v8 offset:1312
    ds_read_b64_tr_b16 v[106:107], v8 offset:1280
    ds_read_b64_tr_b16 v[108:109], v8 offset:1320
    ds_read_b64_tr_b16 v[110:111], v8 offset:1288
    ds_read_b64_tr_b16 v[112:113], v8 offset:1568
    ds_read_b64_tr_b16 v[114:115], v8 offset:1536
    ds_read_b64_tr_b16 v[116:117], v8 offset:1576
    ds_read_b64_tr_b16 v[118:119], v8 offset:1544
    ds_read_b64_tr_b16 v[120:121], v8 offset:1824
    ds_read_b64_tr_b16 v[122:123], v8 offset:1792
    ds_read_b64_tr_b16 v[124:125], v8 offset:1832
    ds_read_b64_tr_b16 v[126:127], v8 offset:1800
    ds_read_b64_tr_b16 v[128:129], v8 offset:2080
    ds_read_b64_tr_b16 v[130:131], v8 offset:2048
    ds_read_b64_tr_b16 v[132:133], v8 offset:2088
    ds_read_b64_tr_b16 v[134:135], v8 offset:2056
    ds_read_b64_tr_b16 v[136:137], v8 offset:2336
    ds_read_b64_tr_b16 v[138:139], v8 offset:2304
    ds_read_b64_tr_b16 v[140:141], v8 offset:2344
    ds_read_b64_tr_b16 v[142:143], v8 offset:2312
    ds_read_b64_tr_b16 v[144:145], v8 offset:2592
    ds_read_b64_tr_b16 v[146:147], v8 offset:2560
    ds_read_b64_tr_b16 v[148:149], v8 offset:2600
    ds_read_b64_tr_b16 v[150:151], v8 offset:2568
    ds_read_b64_tr_b16 v[152:153], v8 offset:2848
    ds_read_b64_tr_b16 v[154:155], v8 offset:2816
    ds_read_b64_tr_b16 v[156:157], v8 offset:2856
    ds_read_b64_tr_b16 v[158:159], v8 offset:2824
    ds_read_b64_tr_b16 v[160:161], v8 offset:3104
    ds_read_b64_tr_b16 v[162:163], v8 offset:3072
    ds_read_b64_tr_b16 v[164:165], v8 offset:3112
    ds_read_b64_tr_b16 v[166:167], v8 offset:3080
    ds_read_b64_tr_b16 v[168:169], v8 offset:3360
    ds_read_b64_tr_b16 v[170:171], v8 offset:3328
    ds_read_b64_tr_b16 v[172:173], v8 offset:3368
    ds_read_b64_tr_b16 v[174:175], v8 offset:3336
    ds_read_b64_tr_b16 v[176:177], v8 offset:3616
    ds_read_b64_tr_b16 v[178:179], v8 offset:3584
    ds_read_b64_tr_b16 v[180:181], v8 offset:3624
    ds_read_b64_tr_b16 v[182:183], v8 offset:3592
    ds_read_b64_tr_b16 v[184:185], v8 offset:3872
    ds_read_b64_tr_b16 v[186:187], v8 offset:3840
    ds_read_b64_tr_b16 v[188:189], v8 offset:3880
    ds_read_b64_tr_b16 v[190:191], v8 offset:3848
    s_waitcnt lgkmcnt(15)
    v_bfi_b32 v64, v16, v15, v64
    v_lshlrev_b32 v16, 16, v16
    v_bfi_b32 v68, v16, v15, v68
    v_bfi_b32 v65, v17, v15, v65
    v_lshlrev_b32_e64 v17, 16, v17
    v_bfi_b32 v69, v17, v15, v69
    v_bfi_b32 v66, v18, v15, v66
    v_lshlrev_b32_e64 v18, 16, v18
    v_bfi_b32 v70, v18, v15, v70
    v_bfi_b32 v67, v19, v15, v67
    v_lshlrev_b32 v19, 16, v19
    v_bfi_b32 v71, v19, v15, v71
    s_waitcnt lgkmcnt(0)
    s_add_u32 s51, s51, 0x300000
    v_mov_b32 v22, 0
    s_waitcnt vmcnt(0)
    s_cmp_ge_u32 s48, 6
    s_cbranch_scc1 L_second
    ds_read_b128 v[192:195], v9 offset:0
    ds_read_b128 v[196:199], v9 offset:256
    ds_read_b128 v[200:203], v9 offset:512
    ds_read_b128 v[204:207], v9 offset:768
    ds_read_b128 v[208:211], v9 offset:1024
    ds_read_b128 v[212:215], v9 offset:1280
    ds_read_b128 v[216:219], v9 offset:1536
    ds_read_b128 v[220:223], v9 offset:1792
    ds_read_b128 v[224:227], v9 offset:2048
    ds_read_b128 v[228:231], v9 offset:2304
    ds_read_b128 v[232:235], v9 offset:2560
    ds_read_b128 v[236:239], v9 offset:2816
    ds_read_b128 v[240:243], v9 offset:3072
    ds_read_b128 v[244:247], v9 offset:3328
    ds_read_b128 v[248:251], v9 offset:3584
    ds_read_b128 v[252:255], v9 offset:3840
    s_waitcnt lgkmcnt(15)
    v_mfma_f32_16x16x32_bf16 v[32:35], v[64:67], v[192:195], 0
    v_mfma_f32_16x16x32_bf16 v[36:39], v[68:71], v[192:195], 0
    v_mfma_f32_16x16x32_bf16 v[40:43], v[72:75], v[192:195], 0
    v_mfma_f32_16x16x32_bf16 v[44:47], v[76:79], v[192:195], 0
    s_waitcnt lgkmcnt(14)
    v_mfma_f32_16x16x32_bf16 v[40:43], v[64:67], v[196:199], v[40:43]
    v_mfma_f32_16x16x32_bf16 v[44:47], v[68:71], v[196:199], v[44:47]
    v_mfma_f32_16x16x32_bf16 v[48:51], v[80:83], v[192:195], 0
    v_mov_b32_e64 v20, 0
    v_add_f32_dpp v32, v33, v32 row_shr:4 row_mask:0xf bank_mask:0xf
    v_mfma_f32_16x16x32_bf16 v[52:55], v[84:87], v[192:195], 0
    v_add_f32_dpp v36, v37, v36 row_shr:4 row_mask:0xf bank_mask:0xf
    v_add_f32_dpp v20, v37, v20 row_shl:12 row_mask:0xf bank_mask:0xf
    v_mfma_f32_16x16x32_bf16 v[48:51], v[72:75], v[196:199], v[48:51]
    v_add_f32_dpp v32, v34, v32 row_shr:8 row_mask:0xf bank_mask:0xf
    v_add_f32_dpp v36, v38, v36 row_shr:8 row_mask:0xf bank_mask:0xf
    v_mfma_f32_16x16x32_bf16 v[52:55], v[76:79], v[196:199], v[52:55]
    v_add_f32_dpp v20, v38, v20 row_shl:8 row_mask:0xf bank_mask:0xf
    v_add_f32_dpp v32, v35, v32 row_shr:12 row_mask:0xf bank_mask:0xf
    s_waitcnt lgkmcnt(13)
    v_mfma_f32_16x16x32_bf16 v[48:51], v[64:67], v[200:203], v[48:51]
    v_add_f32_dpp v36, v39, v36 row_shr:12 row_mask:0xf bank_mask:0xf
    v_add_f32_dpp v20, v39, v20 row_shl:4 row_mask:0xf bank_mask:0xf
    v_mfma_f32_16x16x32_bf16 v[52:55], v[68:71], v[200:203], v[52:55]
    ds_bpermute_b32 v21, v14, v20
    v_add_f32_dpp v36, v33, v36 row_shl:12 row_mask:0xf bank_mask:0xf
    v_mfma_f32_16x16x32_bf16 v[56:59], v[88:91], v[192:195], 0
    s_nop 0
    v_add_f32_dpp v36, v34, v36 row_shl:8 row_mask:0xf bank_mask:0xf
    v_mfma_f32_16x16x32_bf16 v[60:63], v[92:95], v[192:195], 0
    s_nop 0
    v_add_f32_dpp v36, v35, v36 row_shl:4 row_mask:0xf bank_mask:0xf
    v_mfma_f32_16x16x32_bf16 v[56:59], v[80:83], v[196:199], v[56:59]
    s_waitcnt lgkmcnt(0)
    v_cndmask_b32 v23, v21, v22, s[58:59]
    v_mfma_f32_16x16x32_bf16 v[60:63], v[84:87], v[196:199], v[60:63]
    v_add_f32_e64 v32, v32, v23
    v_cvt_pk_bf16_f32 v24, v32, v36
    v_mfma_f32_16x16x32_bf16 v[56:59], v[72:75], v[200:203], v[56:59]
    v_mov_b32_e64 v20, 0
    v_add_f32_dpp v40, v41, v40 row_shr:4 row_mask:0xf bank_mask:0xf
    v_mfma_f32_16x16x32_bf16 v[60:63], v[76:79], v[200:203], v[60:63]
    v_add_f32_dpp v44, v45, v44 row_shr:4 row_mask:0xf bank_mask:0xf
    v_add_f32_dpp v20, v45, v20 row_shl:12 row_mask:0xf bank_mask:0xf
    v_mfma_f32_16x16x32_bf16 v[56:59], v[64:67], v[204:207], v[56:59]
    v_add_f32_dpp v40, v42, v40 row_shr:8 row_mask:0xf bank_mask:0xf
    v_add_f32_dpp v44, v46, v44 row_shr:8 row_mask:0xf bank_mask:0xf
    v_mfma_f32_16x16x32_bf16 v[60:63], v[68:71], v[204:207], v[60:63]
    v_add_f32_dpp v20, v46, v20 row_shl:8 row_mask:0xf bank_mask:0xf
    v_add_f32_dpp v40, v43, v40 row_shr:12 row_mask:0xf bank_mask:0xf
    v_mfma_f32_16x16x32_bf16 v[32:35], v[96:99], v[192:195], 0
    v_add_f32_dpp v44, v47, v44 row_shr:12 row_mask:0xf bank_mask:0xf
    v_add_f32_dpp v20, v47, v20 row_shl:4 row_mask:0xf bank_mask:0xf
    v_mfma_f32_16x16x32_bf16 v[36:39], v[100:103], v[192:195], 0
    ds_bpermute_b32 v22, v14, v20
    v_add_f32_dpp v44, v41, v44 row_shl:12 row_mask:0xf bank_mask:0xf
    v_mfma_f32_16x16x32_bf16 v[32:35], v[88:91], v[196:199], v[32:35]
    s_nop 0
    v_add_f32_dpp v44, v42, v44 row_shl:8 row_mask:0xf bank_mask:0xf
    v_mfma_f32_16x16x32_bf16 v[36:39], v[92:95], v[196:199], v[36:39]
    s_nop 0
    v_add_f32_dpp v44, v43, v44 row_shl:4 row_mask:0xf bank_mask:0xf
    v_mfma_f32_16x16x32_bf16 v[32:35], v[80:83], v[200:203], v[32:35]
    s_waitcnt lgkmcnt(0)
    v_cndmask_b32 v23, v22, v21, s[58:59]
    v_mfma_f32_16x16x32_bf16 v[36:39], v[84:87], v[200:203], v[36:39]
    v_add_f32 v40, v40, v23
    v_cvt_pk_bf16_f32 v25, v40, v44
    v_mfma_f32_16x16x32_bf16 v[32:35], v[72:75], v[204:207], v[32:35]
    v_mov_b32_e64 v20, 0
    v_add_f32_dpp v48, v49, v48 row_shr:4 row_mask:0xf bank_mask:0xf
    v_mfma_f32_16x16x32_bf16 v[36:39], v[76:79], v[204:207], v[36:39]
    v_add_f32_dpp v52, v53, v52 row_shr:4 row_mask:0xf bank_mask:0xf
    v_add_f32_dpp v20, v53, v20 row_shl:12 row_mask:0xf bank_mask:0xf
    v_mfma_f32_16x16x32_bf16 v[32:35], v[64:67], v[208:211], v[32:35]
    v_add_f32_dpp v48, v50, v48 row_shr:8 row_mask:0xf bank_mask:0xf
    v_add_f32_dpp v52, v54, v52 row_shr:8 row_mask:0xf bank_mask:0xf
    v_mfma_f32_16x16x32_bf16 v[36:39], v[68:71], v[208:211], v[36:39]
    v_add_f32_dpp v20, v54, v20 row_shl:8 row_mask:0xf bank_mask:0xf
    v_add_f32_dpp v48, v51, v48 row_shr:12 row_mask:0xf bank_mask:0xf
    v_mfma_f32_16x16x32_bf16 v[40:43], v[104:107], v[192:195], 0
    v_add_f32_dpp v52, v55, v52 row_shr:12 row_mask:0xf bank_mask:0xf
    v_add_f32_dpp v20, v55, v20 row_shl:4 row_mask:0xf bank_mask:0xf
    v_mfma_f32_16x16x32_bf16 v[44:47], v[108:111], v[192:195], 0
    ds_bpermute_b32 v21, v14, v20
    v_add_f32_dpp v52, v49, v52 row_shl:12 row_mask:0xf bank_mask:0xf
    v_mfma_f32_16x16x32_bf16 v[40:43], v[96:99], v[196:199], v[40:43]
    s_nop 0
    v_add_f32_dpp v52, v50, v52 row_shl:8 row_mask:0xf bank_mask:0xf
    v_mfma_f32_16x16x32_bf16 v[44:47], v[100:103], v[196:199], v[44:47]
    s_nop 0
    v_add_f32_dpp v52, v51, v52 row_shl:4 row_mask:0xf bank_mask:0xf
    v_mfma_f32_16x16x32_bf16 v[40:43], v[88:91], v[200:203], v[40:43]
    s_waitcnt lgkmcnt(0)
    v_cndmask_b32 v23, v21, v22, s[58:59]
    v_mfma_f32_16x16x32_bf16 v[44:47], v[92:95], v[200:203], v[44:47]
    v_add_f32 v48, v48, v23
    v_cvt_pk_bf16_f32 v26, v48, v52
    v_mfma_f32_16x16x32_bf16 v[40:43], v[80:83], v[204:207], v[40:43]
    v_mov_b32_e64 v20, 0
    v_add_f32_dpp v56, v57, v56 row_shr:4 row_mask:0xf bank_mask:0xf
    v_mfma_f32_16x16x32_bf16 v[44:47], v[84:87], v[204:207], v[44:47]
    v_add_f32_dpp v60, v61, v60 row_shr:4 row_mask:0xf bank_mask:0xf
    v_add_f32_dpp v20, v61, v20 row_shl:12 row_mask:0xf bank_mask:0xf
    v_mfma_f32_16x16x32_bf16 v[40:43], v[72:75], v[208:211], v[40:43]
    v_add_f32_dpp v56, v58, v56 row_shr:8 row_mask:0xf bank_mask:0xf
    v_add_f32_dpp v60, v62, v60 row_shr:8 row_mask:0xf bank_mask:0xf
    v_mfma_f32_16x16x32_bf16 v[44:47], v[76:79], v[208:211], v[44:47]
    v_add_f32_dpp v20, v62, v20 row_shl:8 row_mask:0xf bank_mask:0xf
    v_add_f32_dpp v56, v59, v56 row_shr:12 row_mask:0xf bank_mask:0xf
    v_mfma_f32_16x16x32_bf16 v[40:43], v[64:67], v[212:215], v[40:43]
    v_add_f32_dpp v60, v63, v60 row_shr:12 row_mask:0xf bank_mask:0xf
    v_add_f32_dpp v20, v63, v20 row_shl:4 row_mask:0xf bank_mask:0xf
    v_mfma_f32_16x16x32_bf16 v[44:47], v[68:71], v[212:215], v[44:47]
    ds_bpermute_b32 v22, v14, v20
    v_add_f32_dpp v60, v57, v60 row_shl:12 row_mask:0xf bank_mask:0xf
    v_mfma_f32_16x16x32_bf16 v[48:51], v[112:115], v[192:195], 0
    s_nop 0
    v_add_f32_dpp v60, v58, v60 row_shl:8 row_mask:0xf bank_mask:0xf
    v_mfma_f32_16x16x32_bf16 v[52:55], v[116:119], v[192:195], 0
    s_nop 0
    v_add_f32_dpp v60, v59, v60 row_shl:4 row_mask:0xf bank_mask:0xf
    v_mfma_f32_16x16x32_bf16 v[48:51], v[104:107], v[196:199], v[48:51]
    s_waitcnt lgkmcnt(0)
    v_cndmask_b32 v23, v22, v21, s[58:59]
    v_mfma_f32_16x16x32_bf16 v[52:55], v[108:111], v[196:199], v[52:55]
    v_add_f32 v56, v56, v23
    v_cvt_pk_bf16_f32 v27, v56, v60
    v_mfma_f32_16x16x32_bf16 v[48:51], v[96:99], v[200:203], v[48:51]
    buffer_store_dwordx4 v[24:27], v2, s[44:47], s51 offen offset:0 sc1
    v_mov_b32_e64 v20, 0
    v_mfma_f32_16x16x32_bf16 v[52:55], v[100:103], v[200:203], v[52:55]
    v_add_f32_dpp v32, v33, v32 row_shr:4 row_mask:0xf bank_mask:0xf
    v_add_f32_dpp v36, v37, v36 row_shr:4 row_mask:0xf bank_mask:0xf
    v_mfma_f32_16x16x32_bf16 v[48:51], v[88:91], v[204:207], v[48:51]
    v_add_f32_dpp v20, v37, v20 row_shl:12 row_mask:0xf bank_mask:0xf
    v_add_f32_dpp v32, v34, v32 row_shr:8 row_mask:0xf bank_mask:0xf
    v_mfma_f32_16x16x32_bf16 v[52:55], v[92:95], v[204:207], v[52:55]
    v_add_f32_dpp v36, v38, v36 row_shr:8 row_mask:0xf bank_mask:0xf
    v_add_f32_dpp v20, v38, v20 row_shl:8 row_mask:0xf bank_mask:0xf
    v_mfma_f32_16x16x32_bf16 v[48:51], v[80:83], v[208:211], v[48:51]
    v_add_f32_dpp v32, v35, v32 row_shr:12 row_mask:0xf bank_mask:0xf
    v_add_f32_dpp v36, v39, v36 row_shr:12 row_mask:0xf bank_mask:0xf
    v_mfma_f32_16x16x32_bf16 v[52:55], v[84:87], v[208:211], v[52:55]
    v_add_f32_dpp v20, v39, v20 row_shl:4 row_mask:0xf bank_mask:0xf
    ds_bpermute_b32 v21, v14, v20
    v_mfma_f32_16x16x32_bf16 v[48:51], v[72:75], v[212:215], v[48:51]
    v_add_f32_dpp v36, v33, v36 row_shl:12 row_mask:0xf bank_mask:0xf
    v_mfma_f32_16x16x32_bf16 v[52:55], v[76:79], v[212:215], v[52:55]
    s_nop 0
    v_add_f32_dpp v36, v34, v36 row_shl:8 row_mask:0xf bank_mask:0xf
    v_mfma_f32_16x16x32_bf16 v[48:51], v[64:67], v[216:219], v[48:51]
    s_nop 0
    v_add_f32_dpp v36, v35, v36 row_shl:4 row_mask:0xf bank_mask:0xf
    s_waitcnt lgkmcnt(0)
    v_mfma_f32_16x16x32_bf16 v[52:55], v[68:71], v[216:219], v[52:55]
    v_cndmask_b32 v23, v21, v22, s[58:59]
    v_add_f32 v32, v32, v23
    v_mfma_f32_16x16x32_bf16 v[56:59], v[120:123], v[192:195], 0
    v_cvt_pk_bf16_f32 v28, v32, v36
    v_mov_b32_e64 v20, 0
    v_mfma_f32_16x16x32_bf16 v[60:63], v[124:127], v[192:195], 0
    v_add_f32_dpp v40, v41, v40 row_shr:4 row_mask:0xf bank_mask:0xf
    v_add_f32_dpp v44, v45, v44 row_shr:4 row_mask:0xf bank_mask:0xf
    v_mfma_f32_16x16x32_bf16 v[56:59], v[112:115], v[196:199], v[56:59]
    v_add_f32_dpp v20, v45, v20 row_shl:12 row_mask:0xf bank_mask:0xf
    v_add_f32_dpp v40, v42, v40 row_shr:8 row_mask:0xf bank_mask:0xf
    v_mfma_f32_16x16x32_bf16 v[60:63], v[116:119], v[196:199], v[60:63]
    v_add_f32_dpp v44, v46, v44 row_shr:8 row_mask:0xf bank_mask:0xf
    v_add_f32_dpp v20, v46, v20 row_shl:8 row_mask:0xf bank_mask:0xf
    v_mfma_f32_16x16x32_bf16 v[56:59], v[104:107], v[200:203], v[56:59]
    v_add_f32_dpp v40, v43, v40 row_shr:12 row_mask:0xf bank_mask:0xf
    v_add_f32_dpp v44, v47, v44 row_shr:12 row_mask:0xf bank_mask:0xf
    v_mfma_f32_16x16x32_bf16 v[60:63], v[108:111], v[200:203], v[60:63]
    v_add_f32_dpp v20, v47, v20 row_shl:4 row_mask:0xf bank_mask:0xf
    ds_bpermute_b32 v22, v14, v20
    v_mfma_f32_16x16x32_bf16 v[56:59], v[96:99], v[204:207], v[56:59]
    v_add_f32_dpp v44, v41, v44 row_shl:12 row_mask:0xf bank_mask:0xf
    v_mfma_f32_16x16x32_bf16 v[60:63], v[100:103], v[204:207], v[60:63]
    v_mfma_f32_16x16x32_bf16 v[56:59], v[88:91], v[208:211], v[56:59]
    v_add_f32_dpp v44, v42, v44 row_shl:8 row_mask:0xf bank_mask:0xf
    v_mfma_f32_16x16x32_bf16 v[60:63], v[92:95], v[208:211], v[60:63]
    v_mfma_f32_16x16x32_bf16 v[56:59], v[80:83], v[212:215], v[56:59]
    v_add_f32_dpp v44, v43, v44 row_shl:4 row_mask:0xf bank_mask:0xf
    v_mfma_f32_16x16x32_bf16 v[60:63], v[84:87], v[212:215], v[60:63]
    s_waitcnt lgkmcnt(0)
    v_mfma_f32_16x16x32_bf16 v[56:59], v[72:75], v[216:219], v[56:59]
    v_cndmask_b32 v23, v22, v21, s[58:59]
    v_mfma_f32_16x16x32_bf16 v[60:63], v[76:79], v[216:219], v[60:63]
    v_add_f32 v40, v40, v23
    v_mfma_f32_16x16x32_bf16 v[56:59], v[64:67], v[220:223], v[56:59]
    v_cvt_pk_bf16_f32 v29, v40, v44
    v_mfma_f32_16x16x32_bf16 v[60:63], v[68:71], v[220:223], v[60:63]
    v_mov_b32_e64 v20, 0
    v_mfma_f32_16x16x32_bf16 v[32:35], v[128:131], v[192:195], 0
    v_add_f32_dpp v48, v49, v48 row_shr:4 row_mask:0xf bank_mask:0xf
    v_add_f32_dpp v52, v53, v52 row_shr:4 row_mask:0xf bank_mask:0xf
    v_mfma_f32_16x16x32_bf16 v[36:39], v[132:135], v[192:195], 0
    v_add_f32_dpp v20, v53, v20 row_shl:12 row_mask:0xf bank_mask:0xf
    v_add_f32_dpp v48, v50, v48 row_shr:8 row_mask:0xf bank_mask:0xf
    v_mfma_f32_16x16x32_bf16 v[32:35], v[120:123], v[196:199], v[32:35]
    v_add_f32_dpp v52, v54, v52 row_shr:8 row_mask:0xf bank_mask:0xf
    v_mfma_f32_16x16x32_bf16 v[36:39], v[124:127], v[196:199], v[36:39]
    v_add_f32_dpp v20, v54, v20 row_shl:8 row_mask:0xf bank_mask:0xf
    v_mfma_f32_16x16x32_bf16 v[32:35], v[112:115], v[200:203], v[32:35]
    v_add_f32_dpp v48, v51, v48 row_shr:12 row_mask:0xf bank_mask:0xf
    v_mfma_f32_16x16x32_bf16 v[36:39], v[116:119], v[200:203], v[36:39]
    v_add_f32_dpp v52, v55, v52 row_shr:12 row_mask:0xf bank_mask:0xf
    v_mfma_f32_16x16x32_bf16 v[32:35], v[104:107], v[204:207], v[32:35]
    v_add_f32_dpp v20, v55, v20 row_shl:4 row_mask:0xf bank_mask:0xf
    v_mfma_f32_16x16x32_bf16 v[36:39], v[108:111], v[204:207], v[36:39]
    ds_bpermute_b32 v21, v14, v20
    v_mfma_f32_16x16x32_bf16 v[32:35], v[96:99], v[208:211], v[32:35]
    v_add_f32_dpp v52, v49, v52 row_shl:12 row_mask:0xf bank_mask:0xf
    v_mfma_f32_16x16x32_bf16 v[36:39], v[100:103], v[208:211], v[36:39]
    v_mfma_f32_16x16x32_bf16 v[32:35], v[88:91], v[212:215], v[32:35]
    v_add_f32_dpp v52, v50, v52 row_shl:8 row_mask:0xf bank_mask:0xf
    v_mfma_f32_16x16x32_bf16 v[36:39], v[92:95], v[212:215], v[36:39]
    v_mfma_f32_16x16x32_bf16 v[32:35], v[80:83], v[216:219], v[32:35]
    v_add_f32_dpp v52, v51, v52 row_shl:4 row_mask:0xf bank_mask:0xf
    v_mfma_f32_16x16x32_bf16 v[36:39], v[84:87], v[216:219], v[36:39]
    s_waitcnt lgkmcnt(0)
    v_mfma_f32_16x16x32_bf16 v[32:35], v[72:75], v[220:223], v[32:35]
    v_cndmask_b32 v23, v21, v22, s[58:59]
    v_mfma_f32_16x16x32_bf16 v[36:39], v[76:79], v[220:223], v[36:39]
    v_add_f32 v48, v48, v23
    v_mfma_f32_16x16x32_bf16 v[32:35], v[64:67], v[224:227], v[32:35]
    v_cvt_pk_bf16_f32 v30, v48, v52
    v_mfma_f32_16x16x32_bf16 v[36:39], v[68:71], v[224:227], v[36:39]
    v_mov_b32_e64 v20, 0
    v_mfma_f32_16x16x32_bf16 v[40:43], v[136:139], v[192:195], 0
    v_add_f32_dpp v56, v57, v56 row_shr:4 row_mask:0xf bank_mask:0xf
    v_add_f32_dpp v60, v61, v60 row_shr:4 row_mask:0xf bank_mask:0xf
    v_mfma_f32_16x16x32_bf16 v[44:47], v[140:143], v[192:195], 0
    v_add_f32_dpp v20, v61, v20 row_shl:12 row_mask:0xf bank_mask:0xf
    v_mfma_f32_16x16x32_bf16 v[40:43], v[128:131], v[196:199], v[40:43]
    v_add_f32_dpp v56, v58, v56 row_shr:8 row_mask:0xf bank_mask:0xf
    v_mfma_f32_16x16x32_bf16 v[44:47], v[132:135], v[196:199], v[44:47]
    v_add_f32_dpp v60, v62, v60 row_shr:8 row_mask:0xf bank_mask:0xf
    v_mfma_f32_16x16x32_bf16 v[40:43], v[120:123], v[200:203], v[40:43]
    v_add_f32_dpp v20, v62, v20 row_shl:8 row_mask:0xf bank_mask:0xf
    v_mfma_f32_16x16x32_bf16 v[44:47], v[124:127], v[200:203], v[44:47]
    v_add_f32_dpp v56, v59, v56 row_shr:12 row_mask:0xf bank_mask:0xf
    v_mfma_f32_16x16x32_bf16 v[40:43], v[112:115], v[204:207], v[40:43]
    v_add_f32_dpp v60, v63, v60 row_shr:12 row_mask:0xf bank_mask:0xf
    v_mfma_f32_16x16x32_bf16 v[44:47], v[116:119], v[204:207], v[44:47]
    v_add_f32_dpp v20, v63, v20 row_shl:4 row_mask:0xf bank_mask:0xf
    v_mfma_f32_16x16x32_bf16 v[40:43], v[104:107], v[208:211], v[40:43]
    ds_bpermute_b32 v22, v14, v20
    v_mfma_f32_16x16x32_bf16 v[44:47], v[108:111], v[208:211], v[44:47]
    v_add_f32_dpp v60, v57, v60 row_shl:12 row_mask:0xf bank_mask:0xf
    v_mfma_f32_16x16x32_bf16 v[40:43], v[96:99], v[212:215], v[40:43]
    v_mfma_f32_16x16x32_bf16 v[44:47], v[100:103], v[212:215], v[44:47]
    v_add_f32_dpp v60, v58, v60 row_shl:8 row_mask:0xf bank_mask:0xf
    v_mfma_f32_16x16x32_bf16 v[40:43], v[88:91], v[216:219], v[40:43]
    v_mfma_f32_16x16x32_bf16 v[44:47], v[92:95], v[216:219], v[44:47]
    v_add_f32_dpp v60, v59, v60 row_shl:4 row_mask:0xf bank_mask:0xf
    v_mfma_f32_16x16x32_bf16 v[40:43], v[80:83], v[220:223], v[40:43]
    s_waitcnt lgkmcnt(0)
    v_mfma_f32_16x16x32_bf16 v[44:47], v[84:87], v[220:223], v[44:47]
    v_cndmask_b32 v23, v22, v21, s[58:59]
    v_mfma_f32_16x16x32_bf16 v[40:43], v[72:75], v[224:227], v[40:43]
    v_add_f32 v56, v56, v23
    v_mfma_f32_16x16x32_bf16 v[44:47], v[76:79], v[224:227], v[44:47]
    v_cvt_pk_bf16_f32 v31, v56, v60
    v_mfma_f32_16x16x32_bf16 v[40:43], v[64:67], v[228:231], v[40:43]
    buffer_store_dwordx4 v[28:31], v2, s[44:47], s51 offen offset:1024 sc1
    v_mfma_f32_16x16x32_bf16 v[44:47], v[68:71], v[228:231], v[44:47]
    v_mov_b32_e64 v20, 0
    v_mfma_f32_16x16x32_bf16 v[48:51], v[144:147], v[192:195], 0
    v_add_f32_dpp v32, v33, v32 row_shr:4 row_mask:0xf bank_mask:0xf
    v_mfma_f32_16x16x32_bf16 v[52:55], v[148:151], v[192:195], 0
    v_add_f32_dpp v36, v37, v36 row_shr:4 row_mask:0xf bank_mask:0xf
    v_mfma_f32_16x16x32_bf16 v[48:51], v[136:139], v[196:199], v[48:51]
    v_add_f32_dpp v20, v37, v20 row_shl:12 row_mask:0xf bank_mask:0xf
    v_mfma_f32_16x16x32_bf16 v[52:55], v[140:143], v[196:199], v[52:55]
    v_add_f32_dpp v32, v34, v32 row_shr:8 row_mask:0xf bank_mask:0xf
    v_mfma_f32_16x16x32_bf16 v[48:51], v[128:131], v[200:203], v[48:51]
    v_add_f32_dpp v36, v38, v36 row_shr:8 row_mask:0xf bank_mask:0xf
    v_mfma_f32_16x16x32_bf16 v[52:55], v[132:135], v[200:203], v[52:55]
    v_add_f32_dpp v20, v38, v20 row_shl:8 row_mask:0xf bank_mask:0xf
    v_mfma_f32_16x16x32_bf16 v[48:51], v[120:123], v[204:207], v[48:51]
    v_add_f32_dpp v32, v35, v32 row_shr:12 row_mask:0xf bank_mask:0xf
    v_mfma_f32_16x16x32_bf16 v[52:55], v[124:127], v[204:207], v[52:55]
    v_add_f32_dpp v36, v39, v36 row_shr:12 row_mask:0xf bank_mask:0xf
    v_mfma_f32_16x16x32_bf16 v[48:51], v[112:115], v[208:211], v[48:51]
    v_add_f32_dpp v20, v39, v20 row_shl:4 row_mask:0xf bank_mask:0xf
    v_mfma_f32_16x16x32_bf16 v[52:55], v[116:119], v[208:211], v[52:55]
    ds_bpermute_b32 v21, v14, v20
    v_mfma_f32_16x16x32_bf16 v[48:51], v[104:107], v[212:215], v[48:51]
    v_add_f32_dpp v36, v33, v36 row_shl:12 row_mask:0xf bank_mask:0xf
    v_mfma_f32_16x16x32_bf16 v[52:55], v[108:111], v[212:215], v[52:55]
    v_mfma_f32_16x16x32_bf16 v[48:51], v[96:99], v[216:219], v[48:51]
    v_add_f32_dpp v36, v34, v36 row_shl:8 row_mask:0xf bank_mask:0xf
    v_mfma_f32_16x16x32_bf16 v[52:55], v[100:103], v[216:219], v[52:55]
    v_mfma_f32_16x16x32_bf16 v[48:51], v[88:91], v[220:223], v[48:51]
    v_add_f32_dpp v36, v35, v36 row_shl:4 row_mask:0xf bank_mask:0xf
    v_mfma_f32_16x16x32_bf16 v[52:55], v[92:95], v[220:223], v[52:55]
    s_waitcnt lgkmcnt(0)
    v_mfma_f32_16x16x32_bf16 v[48:51], v[80:83], v[224:227], v[48:51]
    v_cndmask_b32 v23, v21, v22, s[58:59]
    v_mfma_f32_16x16x32_bf16 v[52:55], v[84:87], v[224:227], v[52:55]
    v_add_f32 v32, v32, v23
    v_mfma_f32_16x16x32_bf16 v[48:51], v[72:75], v[228:231], v[48:51]
    v_cvt_pk_bf16_f32 v24, v32, v36
    v_mfma_f32_16x16x32_bf16 v[52:55], v[76:79], v[228:231], v[52:55]
    v_mov_b32_e64 v20, 0
    v_mfma_f32_16x16x32_bf16 v[48:51], v[64:67], v[232:235], v[48:51]
    v_add_f32_dpp v40, v41, v40 row_shr:4 row_mask:0xf bank_mask:0xf
    v_mfma_f32_16x16x32_bf16 v[52:55], v[68:71], v[232:235], v[52:55]
    v_add_f32_dpp v44, v45, v44 row_shr:4 row_mask:0xf bank_mask:0xf
    v_mfma_f32_16x16x32_bf16 v[56:59], v[152:155], v[192:195], 0
    v_add_f32_dpp v20, v45, v20 row_shl:12 row_mask:0xf bank_mask:0xf
    v_add_f32_dpp v40, v42, v40 row_shr:8 row_mask:0xf bank_mask:0xf
    v_mfma_f32_16x16x32_bf16 v[60:63], v[156:159], v[192:195], 0
    v_add_f32_dpp v44, v46, v44 row_shr:8 row_mask:0xf bank_mask:0xf
    v_add_f32_dpp v20, v46, v20 row_shl:8 row_mask:0xf bank_mask:0xf
    v_mfma_f32_16x16x32_bf16 v[56:59], v[144:147], v[196:199], v[56:59]
    v_add_f32_dpp v40, v43, v40 row_shr:12 row_mask:0xf bank_mask:0xf
    v_add_f32_dpp v44, v47, v44 row_shr:12 row_mask:0xf bank_mask:0xf
    v_mfma_f32_16x16x32_bf16 v[60:63], v[148:151], v[196:199], v[60:63]
    v_add_f32_dpp v20, v47, v20 row_shl:4 row_mask:0xf bank_mask:0xf
    ds_bpermute_b32 v22, v14, v20
    v_mfma_f32_16x16x32_bf16 v[56:59], v[136:139], v[200:203], v[56:59]
    v_add_f32_dpp v44, v41, v44 row_shl:12 row_mask:0xf bank_mask:0xf
    v_mfma_f32_16x16x32_bf16 v[60:63], v[140:143], v[200:203], v[60:63]
    s_nop 0
    v_add_f32_dpp v44, v42, v44 row_shl:8 row_mask:0xf bank_mask:0xf
    v_mfma_f32_16x16x32_bf16 v[56:59], v[128:131], v[204:207], v[56:59]
    s_nop 0
    v_add_f32_dpp v44, v43, v44 row_shl:4 row_mask:0xf bank_mask:0xf
    s_waitcnt lgkmcnt(0)
    v_mfma_f32_16x16x32_bf16 v[60:63], v[132:135], v[204:207], v[60:63]
    v_cndmask_b32 v23, v22, v21, s[58:59]
    v_add_f32 v40, v40, v23
    v_mfma_f32_16x16x32_bf16 v[56:59], v[120:123], v[208:211], v[56:59]
    v_cvt_pk_bf16_f32 v25, v40, v44
    v_mov_b32_e64 v20, 0
    v_mfma_f32_16x16x32_bf16 v[60:63], v[124:127], v[208:211], v[60:63]
    v_add_f32_dpp v48, v49, v48 row_shr:4 row_mask:0xf bank_mask:0xf
    v_add_f32_dpp v52, v53, v52 row_shr:4 row_mask:0xf bank_mask:0xf
    v_mfma_f32_16x16x32_bf16 v[56:59], v[112:115], v[212:215], v[56:59]
    v_add_f32_dpp v20, v53, v20 row_shl:12 row_mask:0xf bank_mask:0xf
    v_add_f32_dpp v48, v50, v48 row_shr:8 row_mask:0xf bank_mask:0xf
    v_mfma_f32_16x16x32_bf16 v[60:63], v[116:119], v[212:215], v[60:63]
    v_add_f32_dpp v52, v54, v52 row_shr:8 row_mask:0xf bank_mask:0xf
    v_add_f32_dpp v20, v54, v20 row_shl:8 row_mask:0xf bank_mask:0xf
    v_mfma_f32_16x16x32_bf16 v[56:59], v[104:107], v[216:219], v[56:59]
    v_add_f32_dpp v48, v51, v48 row_shr:12 row_mask:0xf bank_mask:0xf
    v_add_f32_dpp v52, v55, v52 row_shr:12 row_mask:0xf bank_mask:0xf
    v_mfma_f32_16x16x32_bf16 v[60:63], v[108:111], v[216:219], v[60:63]
    v_add_f32_dpp v20, v55, v20 row_shl:4 row_mask:0xf bank_mask:0xf
    ds_bpermute_b32 v21, v14, v20
    v_mfma_f32_16x16x32_bf16 v[56:59], v[96:99], v[220:223], v[56:59]
    v_add_f32_dpp v52, v49, v52 row_shl:12 row_mask:0xf bank_mask:0xf
    v_mfma_f32_16x16x32_bf16 v[60:63], v[100:103], v[220:223], v[60:63]
    v_mfma_f32_16x16x32_bf16 v[56:59], v[88:91], v[224:227], v[56:59]
    v_add_f32_dpp v52, v50, v52 row_shl:8 row_mask:0xf bank_mask:0xf
    v_mfma_f32_16x16x32_bf16 v[60:63], v[92:95], v[224:227], v[60:63]
    v_mfma_f32_16x16x32_bf16 v[56:59], v[80:83], v[228:231], v[56:59]
    v_add_f32_dpp v52, v51, v52 row_shl:4 row_mask:0xf bank_mask:0xf
    v_mfma_f32_16x16x32_bf16 v[60:63], v[84:87], v[228:231], v[60:63]
    s_waitcnt lgkmcnt(0)
    v_mfma_f32_16x16x32_bf16 v[56:59], v[72:75], v[232:235], v[56:59]
    v_cndmask_b32 v23, v21, v22, s[58:59]
    v_mfma_f32_16x16x32_bf16 v[60:63], v[76:79], v[232:235], v[60:63]
    v_add_f32 v48, v48, v23
    v_mfma_f32_16x16x32_bf16 v[56:59], v[64:67], v[236:239], v[56:59]
    v_cvt_pk_bf16_f32 v26, v48, v52
    v_mfma_f32_16x16x32_bf16 v[60:63], v[68:71], v[236:239], v[60:63]
    s_cmp_ge_u32 s48, 4
    s_cbranch_scc1 L_first
    v_mfma_f32_16x16x32_bf16 v[32:35], v[160:163], v[192:195], 0
    v_mfma_f32_16x16x32_bf16 v[36:39], v[164:167], v[192:195], 0
    v_mfma_f32_16x16x32_bf16 v[32:35], v[152:155], v[196:199], v[32:35]
    v_mfma_f32_16x16x32_bf16 v[36:39], v[156:159], v[196:199], v[36:39]
    v_mfma_f32_16x16x32_bf16 v[32:35], v[144:147], v[200:203], v[32:35]
    v_mfma_f32_16x16x32_bf16 v[36:39], v[148:151], v[200:203], v[36:39]
    v_mov_b32_e64 v20, 0
    v_mfma_f32_16x16x32_bf16 v[32:35], v[136:139], v[204:207], v[32:35]
    v_add_f32_dpp v56, v57, v56 row_shr:4 row_mask:0xf bank_mask:0xf
    v_mfma_f32_16x16x32_bf16 v[36:39], v[140:143], v[204:207], v[36:39]
    v_add_f32_dpp v60, v61, v60 row_shr:4 row_mask:0xf bank_mask:0xf
    v_mfma_f32_16x16x32_bf16 v[32:35], v[128:131], v[208:211], v[32:35]
    v_add_f32_dpp v20, v61, v20 row_shl:12 row_mask:0xf bank_mask:0xf
    v_mfma_f32_16x16x32_bf16 v[36:39], v[132:135], v[208:211], v[36:39]
    v_add_f32_dpp v56, v58, v56 row_shr:8 row_mask:0xf bank_mask:0xf
    v_mfma_f32_16x16x32_bf16 v[32:35], v[120:123], v[212:215], v[32:35]
    v_add_f32_dpp v60, v62, v60 row_shr:8 row_mask:0xf bank_mask:0xf
    v_mfma_f32_16x16x32_bf16 v[36:39], v[124:127], v[212:215], v[36:39]
    v_add_f32_dpp v20, v62, v20 row_shl:8 row_mask:0xf bank_mask:0xf
    v_mfma_f32_16x16x32_bf16 v[32:35], v[112:115], v[216:219], v[32:35]
    v_add_f32_dpp v56, v59, v56 row_shr:12 row_mask:0xf bank_mask:0xf
    v_mfma_f32_16x16x32_bf16 v[36:39], v[116:119], v[216:219], v[36:39]
    v_add_f32_dpp v60, v63, v60 row_shr:12 row_mask:0xf bank_mask:0xf
    v_mfma_f32_16x16x32_bf16 v[32:35], v[104:107], v[220:223], v[32:35]
    v_add_f32_dpp v20, v63, v20 row_shl:4 row_mask:0xf bank_mask:0xf
    v_mfma_f32_16x16x32_bf16 v[36:39], v[108:111], v[220:223], v[36:39]
    ds_bpermute_b32 v22, v14, v20
    v_mfma_f32_16x16x32_bf16 v[32:35], v[96:99], v[224:227], v[32:35]
    v_add_f32_dpp v60, v57, v60 row_shl:12 row_mask:0xf bank_mask:0xf
    v_mfma_f32_16x16x32_bf16 v[36:39], v[100:103], v[224:227], v[36:39]
    v_mfma_f32_16x16x32_bf16 v[32:35], v[88:91], v[228:231], v[32:35]
    v_add_f32_dpp v60, v58, v60 row_shl:8 row_mask:0xf bank_mask:0xf
    v_mfma_f32_16x16x32_bf16 v[36:39], v[92:95], v[228:231], v[36:39]
    v_mfma_f32_16x16x32_bf16 v[32:35], v[80:83], v[232:235], v[32:35]
    v_add_f32_dpp v60, v59, v60 row_shl:4 row_mask:0xf bank_mask:0xf
    v_mfma_f32_16x16x32_bf16 v[36:39], v[84:87], v[232:235], v[36:39]
    s_waitcnt lgkmcnt(0)
    v_mfma_f32_16x16x32_bf16 v[32:35], v[72:75], v[236:239], v[32:35]
    v_cndmask_b32 v23, v22, v21, s[58:59]
    v_mfma_f32_16x16x32_bf16 v[36:39], v[76:79], v[236:239], v[36:39]
    v_add_f32 v56, v56, v23
    v_mfma_f32_16x16x32_bf16 v[32:35], v[64:67], v[240:243], v[32:35]
    v_cvt_pk_bf16_f32 v27, v56, v60
    v_mfma_f32_16x16x32_bf16 v[36:39], v[68:71], v[240:243], v[36:39]
    buffer_store_dwordx4 v[24:27], v2, s[44:47], s51 offen offset:2048 sc1
    v_mfma_f32_16x16x32_bf16 v[40:43], v[168:171], v[192:195], 0
    v_mfma_f32_16x16x32_bf16 v[44:47], v[172:175], v[192:195], 0
    v_mfma_f32_16x16x32_bf16 v[40:43], v[160:163], v[196:199], v[40:43]
    v_mfma_f32_16x16x32_bf16 v[44:47], v[164:167], v[196:199], v[44:47]
    v_mfma_f32_16x16x32_bf16 v[40:43], v[152:155], v[200:203], v[40:43]
    v_mfma_f32_16x16x32_bf16 v[44:47], v[156:159], v[200:203], v[44:47]
    v_mov_b32_e64 v20, 0
    v_mfma_f32_16x16x32_bf16 v[40:43], v[144:147], v[204:207], v[40:43]
    v_add_f32_dpp v32, v33, v32 row_shr:4 row_mask:0xf bank_mask:0xf
    v_mfma_f32_16x16x32_bf16 v[44:47], v[148:151], v[204:207], v[44:47]
    v_add_f32_dpp v36, v37, v36 row_shr:4 row_mask:0xf bank_mask:0xf
    v_mfma_f32_16x16x32_bf16 v[40:43], v[136:139], v[208:211], v[40:43]
    v_add_f32_dpp v20, v37, v20 row_shl:12 row_mask:0xf bank_mask:0xf
    v_mfma_f32_16x16x32_bf16 v[44:47], v[140:143], v[208:211], v[44:47]
    v_add_f32_dpp v32, v34, v32 row_shr:8 row_mask:0xf bank_mask:0xf
    v_mfma_f32_16x16x32_bf16 v[40:43], v[128:131], v[212:215], v[40:43]
    v_add_f32_dpp v36, v38, v36 row_shr:8 row_mask:0xf bank_mask:0xf
    v_mfma_f32_16x16x32_bf16 v[44:47], v[132:135], v[212:215], v[44:47]
    v_add_f32_dpp v20, v38, v20 row_shl:8 row_mask:0xf bank_mask:0xf
    v_mfma_f32_16x16x32_bf16 v[40:43], v[120:123], v[216:219], v[40:43]
    v_add_f32_dpp v32, v35, v32 row_shr:12 row_mask:0xf bank_mask:0xf
    v_mfma_f32_16x16x32_bf16 v[44:47], v[124:127], v[216:219], v[44:47]
    v_add_f32_dpp v36, v39, v36 row_shr:12 row_mask:0xf bank_mask:0xf
    v_mfma_f32_16x16x32_bf16 v[40:43], v[112:115], v[220:223], v[40:43]
    v_add_f32_dpp v20, v39, v20 row_shl:4 row_mask:0xf bank_mask:0xf
    v_mfma_f32_16x16x32_bf16 v[44:47], v[116:119], v[220:223], v[44:47]
    ds_bpermute_b32 v21, v14, v20
    v_mfma_f32_16x16x32_bf16 v[40:43], v[104:107], v[224:227], v[40:43]
    v_add_f32_dpp v36, v33, v36 row_shl:12 row_mask:0xf bank_mask:0xf
    v_mfma_f32_16x16x32_bf16 v[44:47], v[108:111], v[224:227], v[44:47]
    v_mfma_f32_16x16x32_bf16 v[40:43], v[96:99], v[228:231], v[40:43]
    v_add_f32_dpp v36, v34, v36 row_shl:8 row_mask:0xf bank_mask:0xf
    v_mfma_f32_16x16x32_bf16 v[44:47], v[100:103], v[228:231], v[44:47]
    v_mfma_f32_16x16x32_bf16 v[40:43], v[88:91], v[232:235], v[40:43]
    v_add_f32_dpp v36, v35, v36 row_shl:4 row_mask:0xf bank_mask:0xf
    v_mfma_f32_16x16x32_bf16 v[44:47], v[92:95], v[232:235], v[44:47]
    s_waitcnt lgkmcnt(0)
    v_mfma_f32_16x16x32_bf16 v[40:43], v[80:83], v[236:239], v[40:43]
    v_cndmask_b32 v23, v21, v22, s[58:59]
    v_mfma_f32_16x16x32_bf16 v[44:47], v[84:87], v[236:239], v[44:47]
    v_add_f32 v32, v32, v23
    v_mfma_f32_16x16x32_bf16 v[40:43], v[72:75], v[240:243], v[40:43]
    v_cvt_pk_bf16_f32 v28, v32, v36
    v_mfma_f32_16x16x32_bf16 v[44:47], v[76:79], v[240:243], v[44:47]
    v_mfma_f32_16x16x32_bf16 v[40:43], v[64:67], v[244:247], v[40:43]
    v_mfma_f32_16x16x32_bf16 v[44:47], v[68:71], v[244:247], v[44:47]
    v_mfma_f32_16x16x32_bf16 v[48:51], v[176:179], v[192:195], 0
    v_mfma_f32_16x16x32_bf16 v[52:55], v[180:183], v[192:195], 0
    v_mfma_f32_16x16x32_bf16 v[48:51], v[168:171], v[196:199], v[48:51]
    v_mfma_f32_16x16x32_bf16 v[52:55], v[172:175], v[196:199], v[52:55]
    v_mfma_f32_16x16x32_bf16 v[48:51], v[160:163], v[200:203], v[48:51]
    v_mfma_f32_16x16x32_bf16 v[52:55], v[164:167], v[200:203], v[52:55]
    v_mov_b32_e64 v20, 0
    v_mfma_f32_16x16x32_bf16 v[48:51], v[152:155], v[204:207], v[48:51]
    v_add_f32_dpp v40, v41, v40 row_shr:4 row_mask:0xf bank_mask:0xf
    v_mfma_f32_16x16x32_bf16 v[52:55], v[156:159], v[204:207], v[52:55]
    v_add_f32_dpp v44, v45, v44 row_shr:4 row_mask:0xf bank_mask:0xf
    v_mfma_f32_16x16x32_bf16 v[48:51], v[144:147], v[208:211], v[48:51]
    v_add_f32_dpp v20, v45, v20 row_shl:12 row_mask:0xf bank_mask:0xf
    v_mfma_f32_16x16x32_bf16 v[52:55], v[148:151], v[208:211], v[52:55]
    v_add_f32_dpp v40, v42, v40 row_shr:8 row_mask:0xf bank_mask:0xf
    v_mfma_f32_16x16x32_bf16 v[48:51], v[136:139], v[212:215], v[48:51]
    v_add_f32_dpp v44, v46, v44 row_shr:8 row_mask:0xf bank_mask:0xf
    v_mfma_f32_16x16x32_bf16 v[52:55], v[140:143], v[212:215], v[52:55]
    v_add_f32_dpp v20, v46, v20 row_shl:8 row_mask:0xf bank_mask:0xf
    v_mfma_f32_16x16x32_bf16 v[48:51], v[128:131], v[216:219], v[48:51]
    v_add_f32_dpp v40, v43, v40 row_shr:12 row_mask:0xf bank_mask:0xf
    v_mfma_f32_16x16x32_bf16 v[52:55], v[132:135], v[216:219], v[52:55]
    v_add_f32_dpp v44, v47, v44 row_shr:12 row_mask:0xf bank_mask:0xf
    v_mfma_f32_16x16x32_bf16 v[48:51], v[120:123], v[220:223], v[48:51]
    v_add_f32_dpp v20, v47, v20 row_shl:4 row_mask:0xf bank_mask:0xf
    v_mfma_f32_16x16x32_bf16 v[52:55], v[124:127], v[220:223], v[52:55]
    ds_bpermute_b32 v22, v14, v20
    v_mfma_f32_16x16x32_bf16 v[48:51], v[112:115], v[224:227], v[48:51]
    v_add_f32_dpp v44, v41, v44 row_shl:12 row_mask:0xf bank_mask:0xf
    v_mfma_f32_16x16x32_bf16 v[52:55], v[116:119], v[224:227], v[52:55]
    v_mfma_f32_16x16x32_bf16 v[48:51], v[104:107], v[228:231], v[48:51]
    v_add_f32_dpp v44, v42, v44 row_shl:8 row_mask:0xf bank_mask:0xf
    v_mfma_f32_16x16x32_bf16 v[52:55], v[108:111], v[228:231], v[52:55]
    v_mfma_f32_16x16x32_bf16 v[48:51], v[96:99], v[232:235], v[48:51]
    v_add_f32_dpp v44, v43, v44 row_shl:4 row_mask:0xf bank_mask:0xf
    v_mfma_f32_16x16x32_bf16 v[52:55], v[100:103], v[232:235], v[52:55]
    s_waitcnt lgkmcnt(0)
    v_mfma_f32_16x16x32_bf16 v[48:51], v[88:91], v[236:239], v[48:51]
    v_cndmask_b32 v23, v22, v21, s[58:59]
    v_mfma_f32_16x16x32_bf16 v[52:55], v[92:95], v[236:239], v[52:55]
    v_add_f32 v40, v40, v23
    v_mfma_f32_16x16x32_bf16 v[48:51], v[80:83], v[240:243], v[48:51]
    v_cvt_pk_bf16_f32 v29, v40, v44
    v_mfma_f32_16x16x32_bf16 v[52:55], v[84:87], v[240:243], v[52:55]
    v_mfma_f32_16x16x32_bf16 v[48:51], v[72:75], v[244:247], v[48:51]
    v_mfma_f32_16x16x32_bf16 v[52:55], v[76:79], v[244:247], v[52:55]
    v_mfma_f32_16x16x32_bf16 v[48:51], v[64:67], v[248:251], v[48:51]
    v_mfma_f32_16x16x32_bf16 v[52:55], v[68:71], v[248:251], v[52:55]
    v_mfma_f32_16x16x32_bf16 v[56:59], v[184:187], v[192:195], 0
    v_mfma_f32_16x16x32_bf16 v[60:63], v[188:191], v[192:195], 0
    v_mfma_f32_16x16x32_bf16 v[56:59], v[176:179], v[196:199], v[56:59]
    v_mfma_f32_16x16x32_bf16 v[60:63], v[180:183], v[196:199], v[60:63]
    v_mfma_f32_16x16x32_bf16 v[56:59], v[168:171], v[200:203], v[56:59]
    v_mfma_f32_16x16x32_bf16 v[60:63], v[172:175], v[200:203], v[60:63]
    v_mov_b32_e64 v20, 0
    v_mfma_f32_16x16x32_bf16 v[56:59], v[160:163], v[204:207], v[56:59]
    v_add_f32_dpp v48, v49, v48 row_shr:4 row_mask:0xf bank_mask:0xf
    v_mfma_f32_16x16x32_bf16 v[60:63], v[164:167], v[204:207], v[60:63]
    v_add_f32_dpp v52, v53, v52 row_shr:4 row_mask:0xf bank_mask:0xf
    v_mfma_f32_16x16x32_bf16 v[56:59], v[152:155], v[208:211], v[56:59]
    v_add_f32_dpp v20, v53, v20 row_shl:12 row_mask:0xf bank_mask:0xf
    v_mfma_f32_16x16x32_bf16 v[60:63], v[156:159], v[208:211], v[60:63]
    v_add_f32_dpp v48, v50, v48 row_shr:8 row_mask:0xf bank_mask:0xf
    v_mfma_f32_16x16x32_bf16 v[56:59], v[144:147], v[212:215], v[56:59]
    v_add_f32_dpp v52, v54, v52 row_shr:8 row_mask:0xf bank_mask:0xf
    v_mfma_f32_16x16x32_bf16 v[60:63], v[148:151], v[212:215], v[60:63]
    v_add_f32_dpp v20, v54, v20 row_shl:8 row_mask:0xf bank_mask:0xf
    v_mfma_f32_16x16x32_bf16 v[56:59], v[136:139], v[216:219], v[56:59]
    v_add_f32_dpp v48, v51, v48 row_shr:12 row_mask:0xf bank_mask:0xf
    v_mfma_f32_16x16x32_bf16 v[60:63], v[140:143], v[216:219], v[60:63]
    v_add_f32_dpp v52, v55, v52 row_shr:12 row_mask:0xf bank_mask:0xf
    v_mfma_f32_16x16x32_bf16 v[56:59], v[128:131], v[220:223], v[56:59]
    v_add_f32_dpp v20, v55, v20 row_shl:4 row_mask:0xf bank_mask:0xf
    v_mfma_f32_16x16x32_bf16 v[60:63], v[132:135], v[220:223], v[60:63]
    ds_bpermute_b32 v21, v14, v20
    v_mfma_f32_16x16x32_bf16 v[56:59], v[120:123], v[224:227], v[56:59]
    v_add_f32_dpp v52, v49, v52 row_shl:12 row_mask:0xf bank_mask:0xf
    v_mfma_f32_16x16x32_bf16 v[60:63], v[124:127], v[224:227], v[60:63]
    v_mfma_f32_16x16x32_bf16 v[56:59], v[112:115], v[228:231], v[56:59]
    v_add_f32_dpp v52, v50, v52 row_shl:8 row_mask:0xf bank_mask:0xf
    v_mfma_f32_16x16x32_bf16 v[60:63], v[116:119], v[228:231], v[60:63]
    v_mfma_f32_16x16x32_bf16 v[56:59], v[104:107], v[232:235], v[56:59]
    v_add_f32_dpp v52, v51, v52 row_shl:4 row_mask:0xf bank_mask:0xf
    v_mfma_f32_16x16x32_bf16 v[60:63], v[108:111], v[232:235], v[60:63]
    s_waitcnt lgkmcnt(0)
    v_mfma_f32_16x16x32_bf16 v[56:59], v[96:99], v[236:239], v[56:59]
    v_cndmask_b32 v23, v21, v22, s[58:59]
    v_mfma_f32_16x16x32_bf16 v[60:63], v[100:103], v[236:239], v[60:63]
    v_add_f32 v48, v48, v23
    v_mfma_f32_16x16x32_bf16 v[56:59], v[88:91], v[240:243], v[56:59]
    v_cvt_pk_bf16_f32 v30, v48, v52
    v_mfma_f32_16x16x32_bf16 v[60:63], v[92:95], v[240:243], v[60:63]
    v_mfma_f32_16x16x32_bf16 v[56:59], v[80:83], v[244:247], v[56:59]
    v_mfma_f32_16x16x32_bf16 v[60:63], v[84:87], v[244:247], v[60:63]
    v_mfma_f32_16x16x32_bf16 v[56:59], v[72:75], v[248:251], v[56:59]
    v_mfma_f32_16x16x32_bf16 v[60:63], v[76:79], v[248:251], v[60:63]
    v_mfma_f32_16x16x32_bf16 v[56:59], v[64:67], v[252:255], v[56:59]
    v_mfma_f32_16x16x32_bf16 v[60:63], v[68:71], v[252:255], v[60:63]
    v_mov_b32 v20, 0
    s_nop 5
    v_add_f32_dpp v56, v57, v56 row_shr:4 row_mask:0xf bank_mask:0xf
    v_add_f32_dpp v60, v61, v60 row_shr:4 row_mask:0xf bank_mask:0xf
    v_add_f32_dpp v20, v61, v20 row_shl:12 row_mask:0xf bank_mask:0xf
    v_add_f32_dpp v56, v58, v56 row_shr:8 row_mask:0xf bank_mask:0xf
    v_add_f32_dpp v60, v62, v60 row_shr:8 row_mask:0xf bank_mask:0xf
    v_add_f32_dpp v20, v62, v20 row_shl:8 row_mask:0xf bank_mask:0xf
    v_add_f32_dpp v56, v59, v56 row_shr:12 row_mask:0xf bank_mask:0xf
    v_add_f32_dpp v60, v63, v60 row_shr:12 row_mask:0xf bank_mask:0xf
    v_add_f32_dpp v20, v63, v20 row_shl:4 row_mask:0xf bank_mask:0xf
    ds_bpermute_b32 v22, v14, v20
    v_add_f32_dpp v60, v57, v60 row_shl:12 row_mask:0xf bank_mask:0xf
    s_nop 1
    v_add_f32_dpp v60, v58, v60 row_shl:8 row_mask:0xf bank_mask:0xf
    s_nop 1
    v_add_f32_dpp v60, v59, v60 row_shl:4 row_mask:0xf bank_mask:0xf
    s_waitcnt lgkmcnt(0)
    v_cndmask_b32 v23, v22, v21, s[58:59]
    v_add_f32 v56, v56, v23
    v_cvt_pk_bf16_f32 v31, v56, v60
    buffer_store_dwordx4 v[28:31], v2, s[44:47], s51 offen offset:3072 sc1
    s_branch L_cdone
L_first:
    s_waitcnt lgkmcnt(0)
    s_nop 6
    v_mov_b32 v20, 0
    v_add_f32_dpp v56, v57, v56 row_shr:4 row_mask:0xf bank_mask:0xf
    v_add_f32_dpp v60, v61, v60 row_shr:4 row_mask:0xf bank_mask:0xf
    v_add_f32_dpp v20, v61, v20 row_shl:12 row_mask:0xf bank_mask:0xf
    v_add_f32_dpp v56, v58, v56 row_shr:8 row_mask:0xf bank_mask:0xf
    v_add_f32_dpp v60, v62, v60 row_shr:8 row_mask:0xf bank_mask:0xf
    v_add_f32_dpp v20, v62, v20 row_shl:8 row_mask:0xf bank_mask:0xf
    v_add_f32_dpp v56, v59, v56 row_shr:12 row_mask:0xf bank_mask:0xf
    v_add_f32_dpp v60, v63, v60 row_shr:12 row_mask:0xf bank_mask:0xf
    v_add_f32_dpp v20, v63, v20 row_shl:4 row_mask:0xf bank_mask:0xf
    ds_bpermute_b32 v22, v14, v20
    v_add_f32_dpp v60, v57, v60 row_shl:12 row_mask:0xf bank_mask:0xf
    s_nop 1
    v_add_f32_dpp v60, v58, v60 row_shl:8 row_mask:0xf bank_mask:0xf
    s_nop 1
    v_add_f32_dpp v60, v59, v60 row_shl:4 row_mask:0xf bank_mask:0xf
    s_waitcnt lgkmcnt(0)
    v_cndmask_b32 v23, v22, v21, s[58:59]
    v_add_f32 v56, v56, v23
    v_cvt_pk_bf16_f32 v27, v56, v60
    buffer_store_dwordx4 v[24:27], v2, s[44:47], s51 offen offset:2048 sc1
    s_and_b32 s52, s48, 1
    s_lshl_b32 s52, s52, 9
    s_add_u32 s52, s52, 111744
    v_lshl_add_u32 v10, v1, 2, s52
    ds_write_b32 v10, v22
    s_add_u32 s52, s52, 256
    v_mov_b32 v10, s52
    v_mov_b32 v11, 1
    s_waitcnt lgkmcnt(0)
    s_mov_b64 exec, 1
    ds_add_u32 v10, v11
    s_mov_b64 exec, -1
    s_branch L_cdone
L_second:
    ds_read_b128 v[192:195], v9 offset:0
    ds_read_b128 v[196:199], v9 offset:256
    ds_read_b128 v[200:203], v9 offset:512
    ds_read_b128 v[204:207], v9 offset:768
    ds_read_b128 v[208:211], v9 offset:1024
    ds_read_b128 v[212:215], v9 offset:1280
    ds_read_b128 v[216:219], v9 offset:1536
    ds_read_b128 v[220:223], v9 offset:1792
    ds_read_b128 v[224:227], v9 offset:2048
    ds_read_b128 v[228:231], v9 offset:2304
    ds_read_b128 v[232:235], v9 offset:2560
    ds_read_b128 v[236:239], v9 offset:2816
    ds_read_b128 v[240:243], v9 offset:3072
    ds_read_b128 v[244:247], v9 offset:3328
    ds_read_b128 v[248:251], v9 offset:3584
    ds_read_b128 v[252:255], v9 offset:3840
    s_waitcnt lgkmcnt(15)
    v_mfma_f32_16x16x32_bf16 v[32:35], v[160:163], v[192:195], 0
    v_mfma_f32_16x16x32_bf16 v[36:39], v[164:167], v[192:195], 0
    s_waitcnt lgkmcnt(14)
    v_mfma_f32_16x16x32_bf16 v[32:35], v[152:155], v[196:199], v[32:35]
    v_mfma_f32_16x16x32_bf16 v[36:39], v[156:159], v[196:199], v[36:39]
    s_waitcnt lgkmcnt(13)
    v_mfma_f32_16x16x32_bf16 v[32:35], v[144:147], v[200:203], v[32:35]
    v_mfma_f32_16x16x32_bf16 v[36:39], v[148:151], v[200:203], v[36:39]
    s_waitcnt lgkmcnt(12)
    v_mfma_f32_16x16x32_bf16 v[32:35], v[136:139], v[204:207], v[32:35]
    v_mfma_f32_16x16x32_bf16 v[36:39], v[140:143], v[204:207], v[36:39]
    s_waitcnt lgkmcnt(11)
    v_mfma_f32_16x16x32_bf16 v[32:35], v[128:131], v[208:211], v[32:35]
    v_mfma_f32_16x16x32_bf16 v[36:39], v[132:135], v[208:211], v[36:39]
    s_waitcnt lgkmcnt(10)
    v_mfma_f32_16x16x32_bf16 v[32:35], v[120:123], v[212:215], v[32:35]
    v_mfma_f32_16x16x32_bf16 v[36:39], v[124:127], v[212:215], v[36:39]
    s_waitcnt lgkmcnt(9)
    v_mfma_f32_16x16x32_bf16 v[32:35], v[112:115], v[216:219], v[32:35]
    v_mfma_f32_16x16x32_bf16 v[36:39], v[116:119], v[216:219], v[36:39]
    s_waitcnt lgkmcnt(8)
    v_mfma_f32_16x16x32_bf16 v[32:35], v[104:107], v[220:223], v[32:35]
    v_mfma_f32_16x16x32_bf16 v[36:39], v[108:111], v[220:223], v[36:39]
    s_waitcnt lgkmcnt(7)
    v_mfma_f32_16x16x32_bf16 v[32:35], v[96:99], v[224:227], v[32:35]
    v_mfma_f32_16x16x32_bf16 v[36:39], v[100:103], v[224:227], v[36:39]
    s_waitcnt lgkmcnt(6)
    v_mfma_f32_16x16x32_bf16 v[32:35], v[88:91], v[228:231], v[32:35]
    v_mfma_f32_16x16x32_bf16 v[36:39], v[92:95], v[228:231], v[36:39]
    s_waitcnt lgkmcnt(5)
    v_mfma_f32_16x16x32_bf16 v[32:35], v[80:83], v[232:235], v[32:35]
    v_mfma_f32_16x16x32_bf16 v[36:39], v[84:87], v[232:235], v[36:39]
    s_waitcnt lgkmcnt(4)
    v_mfma_f32_16x16x32_bf16 v[32:35], v[72:75], v[236:239], v[32:35]
    v_mfma_f32_16x16x32_bf16 v[36:39], v[76:79], v[236:239], v[36:39]
    s_waitcnt lgkmcnt(3)
    v_mfma_f32_16x16x32_bf16 v[32:35], v[64:67], v[240:243], v[32:35]
    v_mfma_f32_16x16x32_bf16 v[36:39], v[68:71], v[240:243], v[36:39]
    v_mfma_f32_16x16x32_bf16 v[40:43], v[168:171], v[192:195], 0
    v_mfma_f32_16x16x32_bf16 v[44:47], v[172:175], v[192:195], 0
    v_mfma_f32_16x16x32_bf16 v[40:43], v[160:163], v[196:199], v[40:43]
    v_mfma_f32_16x16x32_bf16 v[44:47], v[164:167], v[196:199], v[44:47]
    v_mfma_f32_16x16x32_bf16 v[40:43], v[152:155], v[200:203], v[40:43]
    v_mfma_f32_16x16x32_bf16 v[44:47], v[156:159], v[200:203], v[44:47]
    v_mov_b32 v20, 0
    v_mfma_f32_16x16x32_bf16 v[40:43], v[144:147], v[204:207], v[40:43]
    v_add_f32_dpp v32, v33, v32 row_shr:4 row_mask:0xf bank_mask:0xf
    v_mfma_f32_16x16x32_bf16 v[44:47], v[148:151], v[204:207], v[44:47]
    v_add_f32_dpp v36, v37, v36 row_shr:4 row_mask:0xf bank_mask:0xf
    v_mfma_f32_16x16x32_bf16 v[40:43], v[136:139], v[208:211], v[40:43]
    v_add_f32_dpp v20, v37, v20 row_shl:12 row_mask:0xf bank_mask:0xf
    v_mfma_f32_16x16x32_bf16 v[44:47], v[140:143], v[208:211], v[44:47]
    v_add_f32_dpp v32, v34, v32 row_shr:8 row_mask:0xf bank_mask:0xf
    v_mfma_f32_16x16x32_bf16 v[40:43], v[128:131], v[212:215], v[40:43]
    v_add_f32_dpp v36, v38, v36 row_shr:8 row_mask:0xf bank_mask:0xf
    v_mfma_f32_16x16x32_bf16 v[44:47], v[132:135], v[212:215], v[44:47]
    v_add_f32_dpp v20, v38, v20 row_shl:8 row_mask:0xf bank_mask:0xf
    v_mfma_f32_16x16x32_bf16 v[40:43], v[120:123], v[216:219], v[40:43]
    v_add_f32_dpp v32, v35, v32 row_shr:12 row_mask:0xf bank_mask:0xf
    v_mfma_f32_16x16x32_bf16 v[44:47], v[124:127], v[216:219], v[44:47]
    v_add_f32_dpp v36, v39, v36 row_shr:12 row_mask:0xf bank_mask:0xf
    v_mfma_f32_16x16x32_bf16 v[40:43], v[112:115], v[220:223], v[40:43]
    v_add_f32_dpp v20, v39, v20 row_shl:4 row_mask:0xf bank_mask:0xf
    v_mfma_f32_16x16x32_bf16 v[44:47], v[116:119], v[220:223], v[44:47]
    ds_bpermute_b32 v21, v14, v20
    v_mfma_f32_16x16x32_bf16 v[40:43], v[104:107], v[224:227], v[40:43]
    v_add_f32_dpp v36, v33, v36 row_shl:12 row_mask:0xf bank_mask:0xf
    v_mfma_f32_16x16x32_bf16 v[44:47], v[108:111], v[224:227], v[44:47]
    v_mfma_f32_16x16x32_bf16 v[40:43], v[96:99], v[228:231], v[40:43]
    v_add_f32_dpp v36, v34, v36 row_shl:8 row_mask:0xf bank_mask:0xf
    v_mfma_f32_16x16x32_bf16 v[44:47], v[100:103], v[228:231], v[44:47]
    v_mfma_f32_16x16x32_bf16 v[40:43], v[88:91], v[232:235], v[40:43]
    v_add_f32_dpp v36, v35, v36 row_shl:4 row_mask:0xf bank_mask:0xf
    v_mfma_f32_16x16x32_bf16 v[44:47], v[92:95], v[232:235], v[44:47]
    s_waitcnt lgkmcnt(0)
    v_mfma_f32_16x16x32_bf16 v[40:43], v[80:83], v[236:239], v[40:43]
    v_cndmask_b32 v23, v21, v22, s[58:59]
    v_mfma_f32_16x16x32_bf16 v[44:47], v[84:87], v[236:239], v[44:47]
    v_add_f32 v32, v32, v23
    v_mfma_f32_16x16x32_bf16 v[40:43], v[72:75], v[240:243], v[40:43]
    v_mov_b32 v4, v32
    v_mfma_f32_16x16x32_bf16 v[44:47], v[76:79], v[240:243], v[44:47]
    v_mov_b32 v5, v36
    v_mfma_f32_16x16x32_bf16 v[40:43], v[64:67], v[244:247], v[40:43]
    v_mfma_f32_16x16x32_bf16 v[44:47], v[68:71], v[244:247], v[44:47]
    v_mfma_f32_16x16x32_bf16 v[48:51], v[176:179], v[192:195], 0
    v_mfma_f32_16x16x32_bf16 v[52:55], v[180:183], v[192:195], 0
    v_mfma_f32_16x16x32_bf16 v[48:51], v[168:171], v[196:199], v[48:51]
    v_mfma_f32_16x16x32_bf16 v[52:55], v[172:175], v[196:199], v[52:55]
    v_mfma_f32_16x16x32_bf16 v[48:51], v[160:163], v[200:203], v[48:51]
    v_mfma_f32_16x16x32_bf16 v[52:55], v[164:167], v[200:203], v[52:55]
    v_mov_b32_e64 v20, 0
    v_mfma_f32_16x16x32_bf16 v[48:51], v[152:155], v[204:207], v[48:51]
    v_add_f32_dpp v40, v41, v40 row_shr:4 row_mask:0xf bank_mask:0xf
    v_mfma_f32_16x16x32_bf16 v[52:55], v[156:159], v[204:207], v[52:55]
    v_add_f32_dpp v44, v45, v44 row_shr:4 row_mask:0xf bank_mask:0xf
    v_mfma_f32_16x16x32_bf16 v[48:51], v[144:147], v[208:211], v[48:51]
    v_add_f32_dpp v20, v45, v20 row_shl:12 row_mask:0xf bank_mask:0xf
    v_mfma_f32_16x16x32_bf16 v[52:55], v[148:151], v[208:211], v[52:55]
    v_add_f32_dpp v40, v42, v40 row_shr:8 row_mask:0xf bank_mask:0xf
    v_mfma_f32_16x16x32_bf16 v[48:51], v[136:139], v[212:215], v[48:51]
    v_add_f32_dpp v44, v46, v44 row_shr:8 row_mask:0xf bank_mask:0xf
    v_mfma_f32_16x16x32_bf16 v[52:55], v[140:143], v[212:215], v[52:55]
    v_add_f32_dpp v20, v46, v20 row_shl:8 row_mask:0xf bank_mask:0xf
    v_mfma_f32_16x16x32_bf16 v[48:51], v[128:131], v[216:219], v[48:51]
    v_add_f32_dpp v40, v43, v40 row_shr:12 row_mask:0xf bank_mask:0xf
    v_mfma_f32_16x16x32_bf16 v[52:55], v[132:135], v[216:219], v[52:55]
    v_add_f32_dpp v44, v47, v44 row_shr:12 row_mask:0xf bank_mask:0xf
    v_mfma_f32_16x16x32_bf16 v[48:51], v[120:123], v[220:223], v[48:51]
    v_add_f32_dpp v20, v47, v20 row_shl:4 row_mask:0xf bank_mask:0xf
    v_mfma_f32_16x16x32_bf16 v[52:55], v[124:127], v[220:223], v[52:55]
    ds_bpermute_b32 v22, v14, v20
    v_mfma_f32_16x16x32_bf16 v[48:51], v[112:115], v[224:227], v[48:51]
    v_add_f32_dpp v44, v41, v44 row_shl:12 row_mask:0xf bank_mask:0xf
    v_mfma_f32_16x16x32_bf16 v[52:55], v[116:119], v[224:227], v[52:55]
    v_mfma_f32_16x16x32_bf16 v[48:51], v[104:107], v[228:231], v[48:51]
    v_add_f32_dpp v44, v42, v44 row_shl:8 row_mask:0xf bank_mask:0xf
    v_mfma_f32_16x16x32_bf16 v[52:55], v[108:111], v[228:231], v[52:55]
    v_mfma_f32_16x16x32_bf16 v[48:51], v[96:99], v[232:235], v[48:51]
    v_add_f32_dpp v44, v43, v44 row_shl:4 row_mask:0xf bank_mask:0xf
    v_mfma_f32_16x16x32_bf16 v[52:55], v[100:103], v[232:235], v[52:55]
    s_waitcnt lgkmcnt(0)
    v_mfma_f32_16x16x32_bf16 v[48:51], v[88:91], v[236:239], v[48:51]
    v_cndmask_b32 v23, v22, v21, s[58:59]
    v_mfma_f32_16x16x32_bf16 v[52:55], v[92:95], v[236:239], v[52:55]
    v_add_f32 v40, v40, v23
    v_mfma_f32_16x16x32_bf16 v[48:51], v[80:83], v[240:243], v[48:51]
    v_cvt_pk_bf16_f32 v29, v40, v44
    v_mfma_f32_16x16x32_bf16 v[52:55], v[84:87], v[240:243], v[52:55]
    v_mfma_f32_16x16x32_bf16 v[48:51], v[72:75], v[244:247], v[48:51]
    v_mfma_f32_16x16x32_bf16 v[52:55], v[76:79], v[244:247], v[52:55]
    v_mfma_f32_16x16x32_bf16 v[48:51], v[64:67], v[248:251], v[48:51]
    v_mfma_f32_16x16x32_bf16 v[52:55], v[68:71], v[248:251], v[52:55]
    v_mfma_f32_16x16x32_bf16 v[56:59], v[184:187], v[192:195], 0
    v_mfma_f32_16x16x32_bf16 v[60:63], v[188:191], v[192:195], 0
    v_mfma_f32_16x16x32_bf16 v[56:59], v[176:179], v[196:199], v[56:59]
    v_mfma_f32_16x16x32_bf16 v[60:63], v[180:183], v[196:199], v[60:63]
    v_mfma_f32_16x16x32_bf16 v[56:59], v[168:171], v[200:203], v[56:59]
    v_mfma_f32_16x16x32_bf16 v[60:63], v[172:175], v[200:203], v[60:63]
    v_mov_b32_e64 v20, 0
    v_mfma_f32_16x16x32_bf16 v[56:59], v[160:163], v[204:207], v[56:59]
    v_add_f32_dpp v48, v49, v48 row_shr:4 row_mask:0xf bank_mask:0xf
    v_mfma_f32_16x16x32_bf16 v[60:63], v[164:167], v[204:207], v[60:63]
    v_add_f32_dpp v52, v53, v52 row_shr:4 row_mask:0xf bank_mask:0xf
    v_mfma_f32_16x16x32_bf16 v[56:59], v[152:155], v[208:211], v[56:59]
    v_add_f32_dpp v20, v53, v20 row_shl:12 row_mask:0xf bank_mask:0xf
    v_mfma_f32_16x16x32_bf16 v[60:63], v[156:159], v[208:211], v[60:63]
    v_add_f32_dpp v48, v50, v48 row_shr:8 row_mask:0xf bank_mask:0xf
    v_mfma_f32_16x16x32_bf16 v[56:59], v[144:147], v[212:215], v[56:59]
    v_add_f32_dpp v52, v54, v52 row_shr:8 row_mask:0xf bank_mask:0xf
    v_mfma_f32_16x16x32_bf16 v[60:63], v[148:151], v[212:215], v[60:63]
    v_add_f32_dpp v20, v54, v20 row_shl:8 row_mask:0xf bank_mask:0xf
    v_mfma_f32_16x16x32_bf16 v[56:59], v[136:139], v[216:219], v[56:59]
    v_add_f32_dpp v48, v51, v48 row_shr:12 row_mask:0xf bank_mask:0xf
    v_mfma_f32_16x16x32_bf16 v[60:63], v[140:143], v[216:219], v[60:63]
    v_add_f32_dpp v52, v55, v52 row_shr:12 row_mask:0xf bank_mask:0xf
    v_mfma_f32_16x16x32_bf16 v[56:59], v[128:131], v[220:223], v[56:59]
    v_add_f32_dpp v20, v55, v20 row_shl:4 row_mask:0xf bank_mask:0xf
    v_mfma_f32_16x16x32_bf16 v[60:63], v[132:135], v[220:223], v[60:63]
    ds_bpermute_b32 v21, v14, v20
    v_mfma_f32_16x16x32_bf16 v[56:59], v[120:123], v[224:227], v[56:59]
    v_add_f32_dpp v52, v49, v52 row_shl:12 row_mask:0xf bank_mask:0xf
    v_mfma_f32_16x16x32_bf16 v[60:63], v[124:127], v[224:227], v[60:63]
    v_mfma_f32_16x16x32_bf16 v[56:59], v[112:115], v[228:231], v[56:59]
    v_add_f32_dpp v52, v50, v52 row_shl:8 row_mask:0xf bank_mask:0xf
    v_mfma_f32_16x16x32_bf16 v[60:63], v[116:119], v[228:231], v[60:63]
    v_mfma_f32_16x16x32_bf16 v[56:59], v[104:107], v[232:235], v[56:59]
    v_add_f32_dpp v52, v51, v52 row_shl:4 row_mask:0xf bank_mask:0xf
    v_mfma_f32_16x16x32_bf16 v[60:63], v[108:111], v[232:235], v[60:63]
    s_waitcnt lgkmcnt(0)
    v_mfma_f32_16x16x32_bf16 v[56:59], v[96:99], v[236:239], v[56:59]
    v_cndmask_b32 v23, v21, v22, s[58:59]
    v_mfma_f32_16x16x32_bf16 v[60:63], v[100:103], v[236:239], v[60:63]
    v_add_f32 v48, v48, v23
    v_mfma_f32_16x16x32_bf16 v[56:59], v[88:91], v[240:243], v[56:59]
    v_cvt_pk_bf16_f32 v30, v48, v52
    v_mfma_f32_16x16x32_bf16 v[60:63], v[92:95], v[240:243], v[60:63]
    v_mfma_f32_16x16x32_bf16 v[56:59], v[80:83], v[244:247], v[56:59]
    v_mfma_f32_16x16x32_bf16 v[60:63], v[84:87], v[244:247], v[60:63]
    v_mfma_f32_16x16x32_bf16 v[56:59], v[72:75], v[248:251], v[56:59]
    v_mfma_f32_16x16x32_bf16 v[60:63], v[76:79], v[248:251], v[60:63]
    v_mfma_f32_16x16x32_bf16 v[56:59], v[64:67], v[252:255], v[56:59]
    v_mfma_f32_16x16x32_bf16 v[60:63], v[68:71], v[252:255], v[60:63]
    v_mov_b32 v20, 0
    s_nop 5
    v_add_f32_dpp v56, v57, v56 row_shr:4 row_mask:0xf bank_mask:0xf
    v_add_f32_dpp v60, v61, v60 row_shr:4 row_mask:0xf bank_mask:0xf
    v_add_f32_dpp v20, v61, v20 row_shl:12 row_mask:0xf bank_mask:0xf
    v_add_f32_dpp v56, v58, v56 row_shr:8 row_mask:0xf bank_mask:0xf
    v_add_f32_dpp v60, v62, v60 row_shr:8 row_mask:0xf bank_mask:0xf
    v_add_f32_dpp v20, v62, v20 row_shl:8 row_mask:0xf bank_mask:0xf
    v_add_f32_dpp v56, v59, v56 row_shr:12 row_mask:0xf bank_mask:0xf
    v_add_f32_dpp v60, v63, v60 row_shr:12 row_mask:0xf bank_mask:0xf
    v_add_f32_dpp v20, v63, v20 row_shl:4 row_mask:0xf bank_mask:0xf
    ds_bpermute_b32 v22, v14, v20
    v_add_f32_dpp v60, v57, v60 row_shl:12 row_mask:0xf bank_mask:0xf
    s_nop 1
    v_add_f32_dpp v60, v58, v60 row_shl:8 row_mask:0xf bank_mask:0xf
    s_nop 1
    v_add_f32_dpp v60, v59, v60 row_shl:4 row_mask:0xf bank_mask:0xf
    s_waitcnt lgkmcnt(0)
    v_cndmask_b32 v23, v22, v21, s[58:59]
    v_add_f32 v56, v56, v23
    v_cvt_pk_bf16_f32 v31, v56, v60
    s_and_b32 s52, s48, 1
    s_lshl_b32 s52, s52, 9
    s_add_u32 s52, s52, 111744
    v_lshl_add_u32 v12, v1, 2, s52
    s_add_u32 s52, s52, 256
    v_mov_b32_e64 v10, s52
    s_mov_b32 s101, 0x200000
L_lw_66:
    ds_read_b32 v11, v10
    s_waitcnt lgkmcnt(0)
    v_cmp_le_u32 vcc, 1, v11
    s_cbranch_vccnz L_lwd_67
    s_sleep 2
    s_sub_u32 s101, s101, 1
    s_cmp_eq_u32 s101, 0
    s_cbranch_scc0 L_lw_66
    s_endpgm
L_lwd_67:
    ds_read_b32 v23, v12
    s_waitcnt lgkmcnt(0)
    v_cndmask_b32 v23, 0, v23, s[58:59]
    v_add_f32 v4, v4, v23
    v_cvt_pk_bf16_f32 v28, v4, v5
    buffer_store_dwordx4 v[28:31], v2, s[44:47], s51 offen offset:3072 sc1
L_cdone:
    s_waitcnt vmcnt(0)
    s_cmp_ge_u32 s99, 24
    s_cbranch_scc1 L_bdone
    v_mov_b32 v10, 159756
    v_mov_b32 v11, 1
    s_mov_b64 exec, 1
    ds_add_rtn_u32 v12, v10, v11
    s_mov_b64 exec, -1
    s_lshl_b32 s52, s98, 4
    s_add_u32 s52, s52, s99
    s_lshl_b32 s52, s52, 7
    s_add_u32 s52, s52, 0xf3a400
    s_waitcnt lgkmcnt(0)
    v_readfirstlane_b32 s53, v12
    s_nop 0
    s_cmp_eq_u32 s53, 3
    s_cbranch_scc0 L_bend
    v_mov_b32 v10, s30
    v_mov_b32 v11, s31
    v_lshlrev_b32 v12, 3, v1
    s_waitcnt vmcnt(0)
    s_mov_b64 exec, 0xffff
    buffer_store_dwordx2 v[10:11], v12, s[44:47], s52 offen sc1
    s_mov_b64 exec, -1
    s_branch L_bend
L_bdone:
    s_cmp_lt_u32 s48, 5
    s_cbranch_scc1 L_bend
L_post:
    s_setprio 0
    s_and_b32 s48, s48, 3
    s_mul_i32 s50, s99, 3
    s_sub_u32 s50, s50, 73
    s_lshl_b32 s51, s99, 2
    s_add_u32 s51, s51, 8
    s_cmp_ge_u32 s99, 24
    s_cselect_b32 s50, s50, s51
    s_mul_i32 s49, s98, 40
    s_add_u32 s49, s49, s50
    s_add_u32 s49, s49, s48
    s_and_b32 s50, s49, 31
    s_lshr_b32 s51, s49, 5
    v_lshrrev_b32 v2, 3, v1
    v_and_b32 v3, 7, v1
    v_mul_u32_u24 v4, 4352, v2
    v_lshl_add_u32 v4, v3, 4, v4
    s_mul_i32 s52, s51, 278528
    s_lshl_b32 s53, s50, 7
    s_add_u32 s52, s52, s53
    s_add_u32 s52, s52, 0xa40000
    s_mul_i32 s56, s48, 8320
    s_add_u32 s56, s56, 70144
    s_lshr_b32 s54, s50, 3
    s_lshl_b32 s54, s54, 9
    s_bfe_u32 s55, s50, 0x20001
    s_lshl_b32 s55, s55, 3
    s_add_u32 s54, s54, s55
    s_and_b32 s55, s50, 1
    s_lshl_b32 s55, s55, 1
    s_add_u32 s54, s54, s55
    v_and_b32 v5, 3, v2
    v_lshrrev_b32_e64 v6, 2, v2
    v_lshl_add_u32 v5, v5, 5, v6
    v_mul_u32_u24 v6, 1280, v5
    v_lshlrev_b32_e64 v7, 1, v6
    v_lshl_add_u32 v6, v3, 4, v6
    v_lshl_add_u32 v7, v3, 4, v7
    s_mul_i32 s54, s54, 1280
    s_lshl_b32 s53, s51, 7
    s_lshl_b32 s55, s54, 1
    s_add_u32 s54, s54, s53
    s_add_u32 s55, s55, s53
    s_add_u32 s55, s55, 1280
    s_mov_b32 s32, s12
    s_mov_b32 s33, s13
    s_mov_b32 s34, 0x280000
    s_mov_b32 s35, 0x20000
    s_mov_b32 s36, s24
    s_mov_b32 s37, s25
    s_mov_b32 s38, 0x500000
    s_mov_b32 s39, 0x20000
    s_add_u32 s57, s54, 0
    buffer_load_dwordx4 v[16:19], v6, s[32:35], s57 offen nt
    s_add_u32 s57, s54, 5120
    buffer_load_dwordx4 v[20:23], v6, s[32:35], s57 offen nt
    s_add_u32 s57, s54, 163840
    buffer_load_dwordx4 v[24:27], v6, s[32:35], s57 offen nt
    s_add_u32 s57, s54, 168960
    buffer_load_dwordx4 v[28:31], v6, s[32:35], s57 offen nt
    s_add_u32 s57, s54, 327680
    buffer_load_dwordx4 v[32:35], v6, s[32:35], s57 offen nt
    s_add_u32 s57, s54, 332800
    buffer_load_dwordx4 v[36:39], v6, s[32:35], s57 offen nt
    s_add_u32 s57, s54, 491520
    buffer_load_dwordx4 v[40:43], v6, s[32:35], s57 offen nt
    s_add_u32 s57, s54, 496640
    buffer_load_dwordx4 v[44:47], v6, s[32:35], s57 offen nt
    s_mov_b32 s59, 0xffff0000
    s_waitcnt vmcnt(0)
    v_lshlrev_b32 v128, 16, v16
    v_and_b32 v129, s59, v16
    v_lshlrev_b32 v130, 16, v17
    v_and_b32 v131, s59, v17
    v_lshlrev_b32 v132, 16, v18
    v_and_b32 v133, s59, v18
    v_lshlrev_b32 v134, 16, v19
    v_and_b32 v135, s59, v19
    v_lshlrev_b32 v136, 16, v20
    v_and_b32 v137, s59, v20
    v_lshlrev_b32 v138, 16, v21
    v_and_b32 v139, s59, v21
    v_lshlrev_b32 v140, 16, v22
    v_and_b32 v141, s59, v22
    v_lshlrev_b32 v142, 16, v23
    v_and_b32 v143, s59, v23
    v_lshlrev_b32 v144, 16, v24
    v_and_b32 v145, s59, v24
    v_lshlrev_b32 v146, 16, v25
    v_and_b32 v147, s59, v25
    v_lshlrev_b32 v148, 16, v26
    v_and_b32 v149, s59, v26
    v_lshlrev_b32 v150, 16, v27
    v_and_b32 v151, s59, v27
    v_lshlrev_b32 v152, 16, v28
    v_and_b32 v153, s59, v28
    v_lshlrev_b32 v154, 16, v29
    v_and_b32 v155, s59, v29
    v_lshlrev_b32 v156, 16, v30
    v_and_b32 v157, s59, v30
    v_lshlrev_b32 v158, 16, v31
    v_and_b32 v159, s59, v31
    v_lshlrev_b32 v160, 16, v32
    v_and_b32 v161, s59, v32
    v_lshlrev_b32 v162, 16, v33
    v_and_b32 v163, s59, v33
    v_lshlrev_b32 v164, 16, v34
    v_and_b32 v165, s59, v34
    v_lshlrev_b32 v166, 16, v35
    v_and_b32 v167, s59, v35
    v_lshlrev_b32 v168, 16, v36
    v_and_b32 v169, s59, v36
    v_lshlrev_b32 v170, 16, v37
    v_and_b32 v171, s59, v37
    v_lshlrev_b32 v172, 16, v38
    v_and_b32 v173, s59, v38
    v_lshlrev_b32 v174, 16, v39
    v_and_b32 v175, s59, v39
    v_lshlrev_b32 v176, 16, v40
    v_and_b32 v177, s59, v40
    v_lshlrev_b32 v178, 16, v41
    v_and_b32 v179, s59, v41
    v_lshlrev_b32 v180, 16, v42
    v_and_b32 v181, s59, v42
    v_lshlrev_b32 v182, 16, v43
    v_and_b32 v183, s59, v43
    v_lshlrev_b32 v184, 16, v44
    v_and_b32 v185, s59, v44
    v_lshlrev_b32 v186, 16, v45
    v_and_b32 v187, s59, v45
    v_lshlrev_b32 v188, 16, v46
    v_and_b32 v189, s59, v46
    v_lshlrev_b32 v190, 16, v47
    v_and_b32 v191, s59, v47
    s_lshl_b32 s57, s98, 4
    s_sub_u32 s58, s57, 16
    v_min_u32 v12, 47, v1
    v_add_u32 v12, s58, v12
    v_max_i32 v12, 0, v12
    v_min_u32 v12, 127, v12
    v_lshlrev_b32 v12, 7, v12
    s_add_u32 s57, s57, s99
    s_lshl_b32 s57, s57, 7
    s_add_u32 s57, s57, 0xf39400
    s_mov_b32 s58, 0xf3a000
    s_cmp_ge_u32 s99, 24
    s_cbranch_scc0 L_pq_69
    s_barrier
    s_cmp_eq_u32 s48, 3
    s_cbranch_scc0 L_p7_68
    v_mov_b32 v8, s30
    v_mov_b32 v9, s31
    v_lshlrev_b32_e64 v10, 3, v1
    s_waitcnt vmcnt(0)
    s_mov_b64 exec, 0xffff
    buffer_store_dwordx2 v[8:9], v10, s[44:47], s57 offen sc1
    s_mov_b64 exec, -1
    s_mov_b32 s101, 0x10000
L_poll_71:
    buffer_load_dwordx2 v[14:15], v12, s[44:47], s58 offen sc1
    s_waitcnt vmcnt(0)
    v_cmp_eq_u64 vcc, s[30:31], v[14:15]
    s_nop 0
    s_cmp_eq_u64 vcc, -1
    s_cbranch_scc1 L_polld_72
    s_sleep 4
    s_sub_u32 s101, s101, 1
    s_cmp_eq_u32 s101, 0
    s_cbranch_scc0 L_poll_71
    s_endpgm
L_polld_72:
L_p7_68:
    s_barrier
    s_branch L_pd_70
L_pq_69:
    s_barrier
    s_cmp_eq_u32 s48, 0
    s_cbranch_scc0 L_p7_68
    s_mov_b32 s101, 0x10000
L_poll_73:
    buffer_load_dwordx2 v[14:15], v12, s[44:47], s58 offen sc1
    s_waitcnt vmcnt(0)
    v_cmp_eq_u64 vcc, s[30:31], v[14:15]
    s_nop 0
    s_cmp_eq_u64 vcc, -1
    s_cbranch_scc1 L_polld_74
    s_sleep 4
    s_sub_u32 s101, s101, 1
    s_cmp_eq_u32 s101, 0
    s_cbranch_scc0 L_poll_73
    s_endpgm
L_polld_74:
    s_branch L_p7_68
L_pd_70:
    v_xor_b32 v8, 0, v4
    s_add_u32 m0, s56, 0
    s_nop 0
    buffer_load_dwordx4 v8, s[44:47], s52 offen sc1 lds
    s_add_u32 s52, s52, 34816
    v_xor_b32 v8, 16, v4
    s_add_u32 m0, s56, 1024
    s_nop 0
    buffer_load_dwordx4 v8, s[44:47], s52 offen sc1 lds
    s_add_u32 s52, s52, 34816
    v_xor_b32 v8, 32, v4
    s_add_u32 m0, s56, 2048
    s_nop 0
    buffer_load_dwordx4 v8, s[44:47], s52 offen sc1 lds
    s_add_u32 s52, s52, 34816
    v_xor_b32 v8, 48, v4
    s_add_u32 m0, s56, 3072
    s_nop 0
    buffer_load_dwordx4 v8, s[44:47], s52 offen sc1 lds
    s_add_u32 s52, s52, 34816
    v_xor_b32 v8, 64, v4
    s_add_u32 m0, s56, 4096
    s_nop 0
    buffer_load_dwordx4 v8, s[44:47], s52 offen sc1 lds
    s_add_u32 s52, s52, 34816
    v_xor_b32 v8, 80, v4
    s_add_u32 m0, s56, 5120
    s_nop 0
    buffer_load_dwordx4 v8, s[44:47], s52 offen sc1 lds
    s_add_u32 s52, s52, 34816
    v_xor_b32 v8, 96, v4
    s_add_u32 m0, s56, 6144
    s_nop 0
    buffer_load_dwordx4 v8, s[44:47], s52 offen sc1 lds
    s_add_u32 s52, s52, 34816
    v_xor_b32 v8, 112, v4
    s_add_u32 m0, s56, 7168
    s_nop 0
    buffer_load_dwordx4 v8, s[44:47], s52 offen sc1 lds
    v_xor_b32 v8, v2, v3
    v_lshlrev_b32 v8, 4, v8
    v_lshl_add_u32 v8, v3, 10, v8
    v_add_u32_e64 v8, s56, v8
    s_waitcnt vmcnt(0)
    ds_read_b128 v[48:51], v8 offset:0
    ds_read_b128 v[52:55], v8 offset:128
    ds_read_b128 v[56:59], v8 offset:256
    ds_read_b128 v[60:63], v8 offset:384
    ds_read_b128 v[64:67], v8 offset:512
    ds_read_b128 v[68:71], v8 offset:640
    ds_read_b128 v[72:75], v8 offset:768
    ds_read_b128 v[76:79], v8 offset:896
    s_waitcnt lgkmcnt(0)
    v_lshlrev_b32 v80, 16, v48
    v_lshlrev_b32 v81, 16, v52
    v_lshlrev_b32 v82, 16, v56
    v_lshlrev_b32 v83, 16, v60
    v_lshlrev_b32 v84, 16, v64
    v_lshlrev_b32 v85, 16, v68
    v_lshlrev_b32 v86, 16, v72
    v_lshlrev_b32_e64 v87, 16, v76
    v_pk_mul_f32 v[80:81], v[80:81], v[128:129]
    v_pk_mul_f32 v[82:83], v[82:83], v[130:131]
    v_pk_mul_f32 v[84:85], v[84:85], v[132:133]
    v_pk_mul_f32 v[86:87], v[86:87], v[134:135]
    v_cvt_pk_bf16_f32 v96, v80, v81
    v_cvt_pk_bf16_f32 v97, v82, v83
    v_cvt_pk_bf16_f32 v98, v84, v85
    v_cvt_pk_bf16_f32 v99, v86, v87
    s_add_u32 s57, s55, 0
    buffer_store_dwordx4 v[96:99], v7, s[36:39], s57 offen sc1 nt
    v_and_b32 v80, s59, v48
    v_and_b32 v81, s59, v52
    v_and_b32 v82, s59, v56
    v_and_b32 v83, s59, v60
    v_and_b32 v84, s59, v64
    v_and_b32 v85, s59, v68
    v_and_b32 v86, s59, v72
    v_and_b32_e64 v87, s59, v76
    v_pk_mul_f32 v[80:81], v[80:81], v[136:137]
    v_pk_mul_f32 v[82:83], v[82:83], v[138:139]
    v_pk_mul_f32 v[84:85], v[84:85], v[140:141]
    v_pk_mul_f32 v[86:87], v[86:87], v[142:143]
    v_cvt_pk_bf16_f32 v100, v80, v81
    v_cvt_pk_bf16_f32 v101, v82, v83
    v_cvt_pk_bf16_f32 v102, v84, v85
    v_cvt_pk_bf16_f32 v103, v86, v87
    s_add_u32 s57, s55, 10240
    buffer_store_dwordx4 v[100:103], v7, s[36:39], s57 offen sc1 nt
    v_lshlrev_b32 v80, 16, v49
    v_lshlrev_b32 v81, 16, v53
    v_lshlrev_b32 v82, 16, v57
    v_lshlrev_b32 v83, 16, v61
    v_lshlrev_b32 v84, 16, v65
    v_lshlrev_b32 v85, 16, v69
    v_lshlrev_b32 v86, 16, v73
    v_lshlrev_b32 v87, 16, v77
    v_pk_mul_f32 v[80:81], v[80:81], v[144:145]
    v_pk_mul_f32 v[82:83], v[82:83], v[146:147]
    v_pk_mul_f32 v[84:85], v[84:85], v[148:149]
    v_pk_mul_f32 v[86:87], v[86:87], v[150:151]
    v_cvt_pk_bf16_f32 v104, v80, v81
    v_cvt_pk_bf16_f32 v105, v82, v83
    v_cvt_pk_bf16_f32 v106, v84, v85
    v_cvt_pk_bf16_f32 v107, v86, v87
    s_add_u32 s57, s55, 327680
    buffer_store_dwordx4 v[104:107], v7, s[36:39], s57 offen sc1 nt
    v_and_b32 v80, s59, v49
    v_and_b32 v81, s59, v53
    v_and_b32 v82, s59, v57
    v_and_b32 v83, s59, v61
    v_and_b32 v84, s59, v65
    v_and_b32 v85, s59, v69
    v_and_b32 v86, s59, v73
    v_and_b32 v87, s59, v77
    v_pk_mul_f32 v[80:81], v[80:81], v[152:153]
    v_pk_mul_f32 v[82:83], v[82:83], v[154:155]
    v_pk_mul_f32 v[84:85], v[84:85], v[156:157]
    v_pk_mul_f32 v[86:87], v[86:87], v[158:159]
    v_cvt_pk_bf16_f32 v108, v80, v81
    v_cvt_pk_bf16_f32 v109, v82, v83
    v_cvt_pk_bf16_f32 v110, v84, v85
    v_cvt_pk_bf16_f32 v111, v86, v87
    s_add_u32 s57, s55, 337920
    buffer_store_dwordx4 v[108:111], v7, s[36:39], s57 offen sc1 nt
    v_lshlrev_b32 v80, 16, v50
    v_lshlrev_b32 v81, 16, v54
    v_lshlrev_b32 v82, 16, v58
    v_lshlrev_b32 v83, 16, v62
    v_lshlrev_b32 v84, 16, v66
    v_lshlrev_b32 v85, 16, v70
    v_lshlrev_b32 v86, 16, v74
    v_lshlrev_b32 v87, 16, v78
    v_pk_mul_f32 v[80:81], v[80:81], v[160:161]
    v_pk_mul_f32 v[82:83], v[82:83], v[162:163]
    v_pk_mul_f32 v[84:85], v[84:85], v[164:165]
    v_pk_mul_f32 v[86:87], v[86:87], v[166:167]
    v_cvt_pk_bf16_f32 v112, v80, v81
    v_cvt_pk_bf16_f32 v113, v82, v83
    v_cvt_pk_bf16_f32 v114, v84, v85
    v_cvt_pk_bf16_f32 v115, v86, v87
    s_add_u32 s57, s55, 655360
    buffer_store_dwordx4 v[112:115], v7, s[36:39], s57 offen sc1 nt
    v_and_b32 v80, s59, v50
    v_and_b32 v81, s59, v54
    v_and_b32 v82, s59, v58
    v_and_b32 v83, s59, v62
    v_and_b32 v84, s59, v66
    v_and_b32 v85, s59, v70
    v_and_b32 v86, s59, v74
    v_and_b32 v87, s59, v78
    v_pk_mul_f32 v[80:81], v[80:81], v[168:169]
    v_pk_mul_f32 v[82:83], v[82:83], v[170:171]
    v_pk_mul_f32 v[84:85], v[84:85], v[172:173]
    v_pk_mul_f32 v[86:87], v[86:87], v[174:175]
    v_cvt_pk_bf16_f32 v116, v80, v81
    v_cvt_pk_bf16_f32 v117, v82, v83
    v_cvt_pk_bf16_f32 v118, v84, v85
    v_cvt_pk_bf16_f32 v119, v86, v87
    s_add_u32 s57, s55, 665600
    buffer_store_dwordx4 v[116:119], v7, s[36:39], s57 offen sc1 nt
    v_lshlrev_b32 v80, 16, v51
    v_lshlrev_b32 v81, 16, v55
    v_lshlrev_b32 v82, 16, v59
    v_lshlrev_b32 v83, 16, v63
    v_lshlrev_b32 v84, 16, v67
    v_lshlrev_b32 v85, 16, v71
    v_lshlrev_b32 v86, 16, v75
    v_lshlrev_b32 v87, 16, v79
    v_pk_mul_f32 v[80:81], v[80:81], v[176:177]
    v_pk_mul_f32 v[82:83], v[82:83], v[178:179]
    v_pk_mul_f32 v[84:85], v[84:85], v[180:181]
    v_pk_mul_f32 v[86:87], v[86:87], v[182:183]
    v_cvt_pk_bf16_f32 v120, v80, v81
    v_cvt_pk_bf16_f32 v121, v82, v83
    v_cvt_pk_bf16_f32 v122, v84, v85
    v_cvt_pk_bf16_f32 v123, v86, v87
    s_add_u32 s57, s55, 983040
    buffer_store_dwordx4 v[120:123], v7, s[36:39], s57 offen sc1 nt
    v_and_b32 v80, s59, v51
    v_and_b32 v81, s59, v55
    v_and_b32 v82, s59, v59
    v_and_b32 v83, s59, v63
    v_and_b32 v84, s59, v67
    v_and_b32 v85, s59, v71
    v_and_b32 v86, s59, v75
    v_and_b32 v87, s59, v79
    v_pk_mul_f32 v[80:81], v[80:81], v[184:185]
    v_pk_mul_f32 v[82:83], v[82:83], v[186:187]
    v_pk_mul_f32 v[84:85], v[84:85], v[188:189]
    v_pk_mul_f32 v[86:87], v[86:87], v[190:191]
    v_cvt_pk_bf16_f32 v124, v80, v81
    v_cvt_pk_bf16_f32 v125, v82, v83
    v_cvt_pk_bf16_f32 v126, v84, v85
    v_cvt_pk_bf16_f32 v127, v86, v87
    s_add_u32 s57, s55, 993280
    buffer_store_dwordx4 v[124:127], v7, s[36:39], s57 offen sc1 nt
L_bend:
    s_endpgm
L_exit:
    s_endpgm
L_code_end:
.section .rodata,"a"
.p2align 6
.amdhsa_kernel concat_heads__linear_kernel_hedgehog__ssm_conv_h3__prompt_kernel
  .amdhsa_next_free_vgpr 256
  .amdhsa_next_free_sgpr 102
  .amdhsa_accum_offset 256
  .amdhsa_group_segment_fixed_size 0
  .amdhsa_kernarg_size 104
  .amdhsa_user_sgpr_count 2
  .amdhsa_user_sgpr_kernarg_segment_ptr 1
  .amdhsa_system_sgpr_workgroup_id_x 1
.end_amdhsa_kernel
```
